```python
import torch

def _softmax(x, axis=-1):
    return torch.softmax(x, dim=axis)
def _gelu(x):
    return torch.nn.functional.gelu(x, approximate="tanh")
def _silu(x):
    return torch.nn.functional.silu(x)
def _sigmoid(x):
    return torch.sigmoid(x)
def _layernorm(x, axis=-1, eps=1e-5):
    m = x.mean(dim=axis, keepdim=True)
    v = x.var(dim=axis, keepdim=True, unbiased=False)
    return (x - m) / torch.sqrt(v + eps)
def _scatter_add(tgt, idx, src, axis=0):
    return tgt.clone().index_add_(axis, idx, src)
def _segment_sum(src, seg, n):
    out = torch.zeros((n,) + src.shape[1:], dtype=src.dtype)
    return out.index_add_(0, seg, src)
def _pad(x, pw):
    flat = tuple(v for pair in reversed(pw) for v in pair)
    return torch.nn.functional.pad(x, flat)

kernel_name = 'recurrent_scan__mha_block_cached__swiglu_ffn__decode'

def setup_inputs():

    _w = (lambda a: (lambda t: t.to(torch.bfloat16) if t.is_floating_point() else t)(torch.as_tensor(a)))
    def _A_setup():
        B, Sq, D = 2, 1, 576
        H, Sk, Dh = 32, 8192, 128
        return {
            "x": _w((lambda *s: torch.randn(*s, dtype=torch.bfloat16) * 0.05)(B, Sq, D)),
            "k_cache": _w((lambda *s: torch.randn(*s, dtype=torch.bfloat16) * 1.6)(B, H, Sk, Dh)),
            "v_cache": _w((lambda *s: torch.randn(*s, dtype=torch.bfloat16) * 0.2)(B, H, Sk, Dh)),
            "wq": _w((lambda *s: torch.randn(*s, dtype=torch.bfloat16) * 1.6)(D, H * Dh) * (D ** -0.5)),
            "wo": _w((lambda *s: torch.randn(*s, dtype=torch.bfloat16) * 0.2)(H * Dh, D) * ((H * Dh) ** -0.5)),
        }
    _A_in = _A_setup()

    def _B_setup():
        B, S, D, F = 2, 1, 576, 4608
        return {
            "x": _w((lambda *s: torch.randn(*s, dtype=torch.bfloat16) * 0.05)(B, S, D)),
            "w_gate": _w((lambda *s: torch.randn(*s, dtype=torch.bfloat16) * 0.1)(D, F)),
            "w_up": _w((lambda *s: torch.randn(*s, dtype=torch.bfloat16) * 0.1)(D, F)),
            "w_down": _w((lambda *s: torch.randn(*s, dtype=torch.bfloat16) * 0.1)(F, D)),
        }
    _B_in = _B_setup()

    return {
        "A_x": _A_in["x"],
        "A_k_cache": _A_in["k_cache"],
        "A_v_cache": _A_in["v_cache"],
        "A_wq": _A_in["wq"],
        "A_wo": _A_in["wo"],
        "B_x": _B_in["x"],
        "B_w_gate": _B_in["w_gate"],
        "B_w_up": _B_in["w_up"],
        "B_w_down": _B_in["w_down"],
    }

def reference(A_x, A_k_cache, A_v_cache, A_wq, A_wo, B_x, B_w_gate, B_w_up, B_w_down):
    def _A_ref(x, k_cache, v_cache, wq, wo):
        B, Sq, D = x.shape
        H, Dh = 32, 128
        q = (lambda x, *d: x.permute(*d))((x @ wq).reshape(B, Sq, H, Dh), 0, 2, 1, 3)
        scores = torch.einsum("bhqd,bhkd->bhqk", q, k_cache) * (Dh ** -0.5)
        p = _softmax(scores, axis=-1)
        o = torch.einsum("bhqk,bhkd->bhqd", p, v_cache)
        return (lambda x, *d: x.permute(*d))(o, 0, 2, 1, 3).reshape(B, Sq, H * Dh) @ wo

    def _B_ref(x, w_gate, w_up, w_down):
        g = _silu(x @ w_gate)
        u = x @ w_up
        return (g * u) @ w_down

    x = A_x
    xn = _layernorm(x, axis=-1)
    s = _A_ref(xn, A_k_cache, A_v_cache, A_wq, A_wo)
    g = _silu(_B_ref(xn, B_w_gate, B_w_up, B_w_down))
    return x + s * g
```

```asm
; @launch grid=(256,1,1) block=(512,1,1) lds=37888
.amdgcn_target "amdgcn-amd-amdhsa--gfx950"
.text
.globl recurrent_scan__mha_block_cached__swiglu_ffn__decode_kernel
.p2align 8
.type recurrent_scan__mha_block_cached__swiglu_ffn__decode_kernel,@function
recurrent_scan__mha_block_cached__swiglu_ffn__decode_kernel:
    s_cmp_ge_u32 s2, 256
    s_cbranch_scc1 L_end
    s_load_dwordx16 s[4:19], s[0:1], 0
    s_load_dwordx8 s[20:27], s[0:1], 64
    v_lshrrev_b32 v1, 6, v0
    v_and_b32 v0, 63, v0
    v_readfirstlane_b32 s28, v1
    s_and_b32 s29, s2, 7
    s_lshr_b32 s32, s2, 6
    s_lshl_b32 s32, s32, 3
    s_add_u32 s32, s32, s29
    s_bfe_u32 s33, s2, 0x30003
    v_lshrrev_b32 v2, 4, v0
    v_and_b32 v3, 15, v0
    s_cmp_ge_u32 s28, 4
    s_cbranch_scc1 L_helper
    s_cmp_eq_u32 s33, 7
    s_cbranch_scc1 L_svc_lo
    s_lshr_b32 s31, s28, 1
    s_and_b32 s30, s28, 1
    s_getreg_b32 s97, hwreg(HW_REG_XCC_ID)
    s_lshl_b32 s71, s33, 1
    s_add_u32 s71, s71, s30
    s_lshl_b32 s34, s71, 10
    v_bfe_u32 v4, v0, 2, 2
    v_and_b32 v5, 3, v0
    v_lshlrev_b32 v4, 8, v4
    v_lshlrev_b32 v5, 4, v5
    v_lshl_add_u32 v10, v2, 6, v5
    v_add3_u32 v6, v4, v10, s34
    v_lshl_add_u32 v7, v0, 4, s34
    s_lshl_b32 s34, s31, 5
    s_add_u32 s34, s34, s32
    s_lshl_b32 s34, s34, 21
    s_mov_b32 s38, 2097152
    s_mov_b32 s39, 0x20000
    s_mov_b32 s68, 0
    s_waitcnt lgkmcnt(0)
    s_add_u32 s36, s6, s34
    s_addc_u32 s37, s7, 0
    buffer_load_dwordx4 v[56:59], v6, s[36:39], s68 offen nt
    s_addk_i32 s68, 14336
    buffer_load_dwordx4 v[60:63], v6, s[36:39], s68 offen nt
    s_addk_i32 s68, 14336
    buffer_load_dwordx4 v[64:67], v6, s[36:39], s68 offen nt
    s_addk_i32 s68, 14336
    buffer_load_dwordx4 v[68:71], v6, s[36:39], s68 offen nt
    s_addk_i32 s68, 14336
    s_barrier
    buffer_load_dwordx4 v[72:75], v6, s[36:39], s68 offen nt
    s_addk_i32 s68, 14336
    buffer_load_dwordx4 v[76:79], v6, s[36:39], s68 offen nt
    s_addk_i32 s68, 14336
    s_bitcmp0_b32 s97, 0
    s_cbranch_scc0 L_de6
    s_waitcnt vmcnt(5)
L_de6:
    buffer_load_dwordx4 v[80:83], v6, s[36:39], s68 offen nt
    s_addk_i32 s68, 14336
    s_add_u32 s40, s8, s34
    s_addc_u32 s41, s9, 0
    s_mov_b32 s42, s38
    s_mov_b32 s43, 0x20000
    s_mov_b32 s69, 0
    v_and_b32 v4, 1, v0
    v_lshlrev_b32 v4, 4, v4
    v_mov_b32 v5, 0xffff
    v_lshlrev_b32 v4, v4, v5
    v_bfe_u32 v5, v0, 1, 2
    v_cmp_eq_u32 vcc, 0, v5
    s_nop 1
    v_cndmask_b32 v16, 0, v4, vcc
    v_cmp_eq_u32 vcc, 1, v5
    s_nop 1
    v_cndmask_b32 v17, 0, v4, vcc
    v_cmp_eq_u32 vcc, 2, v5
    s_nop 1
    v_cndmask_b32 v18, 0, v4, vcc
    v_cmp_eq_u32 vcc, 3, v5
    s_nop 1
    v_cndmask_b32 v19, 0, v4, vcc
    v_mov_b32 v8, 0x3fb8aa3b
    s_lshl_b32 s3, s31, 8
    v_add_u32 v10, s3, v10
    v_and_b32 v4, 1, v2
    v_lshlrev_b32 v4, 4, v4
    v_lshl_add_u32 v11, v3, 5, v4
    s_lshl_b32 s3, s28, 9
    v_add_u32 v11, s3, v11
    s_lshl_b32 s3, s28, 3
    v_mov_b32 v12, s3
    v_bfe_u32 v13, v0, 2, 2
    s_waitcnt vmcnt(6)
    buffer_load_dwordx4 v[84:87], v6, s[36:39], s68 offen nt
    s_addk_i32 s68, 14336
    s_waitcnt vmcnt(6)
    s_bitcmp0_b32 s97, 0
    s_cbranch_scc0 L_de8
    s_waitcnt vmcnt(5)
L_de8:
    buffer_load_dwordx4 v[88:91], v6, s[36:39], s68 offen nt
    s_addk_i32 s68, 14336
    s_waitcnt vmcnt(6)
    buffer_load_dwordx4 v[92:95], v6, s[36:39], s68 offen nt
    s_addk_i32 s68, 14336
    s_waitcnt vmcnt(6)
    s_bitcmp0_b32 s97, 0
    s_cbranch_scc0 L_de10
    s_waitcnt vmcnt(5)
L_de10:
    buffer_load_dwordx4 v[96:99], v6, s[36:39], s68 offen nt
    s_addk_i32 s68, 14336
    s_waitcnt vmcnt(6)
    buffer_load_dwordx4 v[100:103], v6, s[36:39], s68 offen nt
    s_addk_i32 s68, 14336
    s_waitcnt vmcnt(6)
    s_bitcmp0_b32 s97, 0
    s_cbranch_scc0 L_de12
    s_waitcnt vmcnt(5)
L_de12:
    buffer_load_dwordx4 v[104:107], v6, s[36:39], s68 offen nt
    s_addk_i32 s68, 14336
    s_waitcnt vmcnt(6)
    buffer_load_dwordx4 v[108:111], v6, s[36:39], s68 offen nt
    s_addk_i32 s68, 14336
    s_waitcnt vmcnt(6)
    s_bitcmp0_b32 s97, 0
    s_cbranch_scc0 L_de14
    s_waitcnt vmcnt(5)
L_de14:
    buffer_load_dwordx4 v[112:115], v6, s[36:39], s68 offen nt
    s_addk_i32 s68, 14336
    s_waitcnt vmcnt(6)
    buffer_load_dwordx4 v[116:119], v6, s[36:39], s68 offen nt
    s_addk_i32 s68, 14336
    s_waitcnt vmcnt(6)
    s_bitcmp0_b32 s97, 0
    s_cbranch_scc0 L_de16
    s_waitcnt vmcnt(5)
L_de16:
    buffer_load_dwordx4 v[120:123], v6, s[36:39], s68 offen nt
    s_addk_i32 s68, 14336
    s_waitcnt vmcnt(6)
    buffer_load_dwordx4 v[124:127], v6, s[36:39], s68 offen nt
    s_addk_i32 s68, 14336
    s_waitcnt vmcnt(6)
    s_bitcmp0_b32 s97, 0
    s_cbranch_scc0 L_de18
    s_waitcnt vmcnt(5)
L_de18:
    buffer_load_dwordx4 v[128:131], v6, s[36:39], s68 offen nt
    s_addk_i32 s68, 14336
    s_waitcnt vmcnt(6)
    buffer_load_dwordx4 v[132:135], v6, s[36:39], s68 offen nt
    s_addk_i32 s68, 14336
    s_waitcnt vmcnt(6)
    s_bitcmp0_b32 s97, 0
    s_cbranch_scc0 L_de20
    s_waitcnt vmcnt(5)
L_de20:
    buffer_load_dwordx4 v[136:139], v6, s[36:39], s68 offen nt
    s_addk_i32 s68, 14336
    s_waitcnt vmcnt(6)
    buffer_load_dwordx4 v[140:143], v6, s[36:39], s68 offen nt
    s_addk_i32 s68, 14336
    s_waitcnt vmcnt(6)
    s_bitcmp0_b32 s97, 0
    s_cbranch_scc0 L_de22
    s_waitcnt vmcnt(5)
L_de22:
    buffer_load_dwordx4 v[144:147], v6, s[36:39], s68 offen nt
    s_addk_i32 s68, 14336
    s_waitcnt vmcnt(6)
    buffer_load_dwordx4 v[148:151], v6, s[36:39], s68 offen nt
    s_addk_i32 s68, 14336
    s_waitcnt vmcnt(6)
    s_bitcmp0_b32 s97, 0
    s_cbranch_scc0 L_de24
    s_waitcnt vmcnt(5)
L_de24:
    buffer_load_dwordx4 v[152:155], v6, s[36:39], s68 offen nt
    s_addk_i32 s68, 14336
    s_waitcnt vmcnt(6)
    buffer_load_dwordx4 v[156:159], v6, s[36:39], s68 offen nt
    s_addk_i32 s68, 14336
    s_waitcnt vmcnt(6)
    s_bitcmp0_b32 s97, 0
    s_cbranch_scc0 L_de26
    s_waitcnt vmcnt(5)
L_de26:
    buffer_load_dwordx4 v[160:163], v6, s[36:39], s68 offen nt
    s_addk_i32 s68, 14336
    s_waitcnt vmcnt(6)
    buffer_load_dwordx4 v[164:167], v6, s[36:39], s68 offen nt
    s_addk_i32 s68, 14336
    s_waitcnt vmcnt(6)
    s_mov_b32 exec_hi, 0
    s_mov_b32 exec_lo, 1
    ds_write_b32 v12, v12 offset:576
    s_mov_b64 exec, -1
    s_bitcmp0_b32 s97, 0
    s_cbranch_scc0 L_de28
    s_waitcnt vmcnt(5)
L_de28:
    buffer_load_dwordx4 v[168:171], v6, s[36:39], s68 offen nt
    s_addk_i32 s68, 14336
    s_waitcnt vmcnt(6)
    buffer_load_dwordx4 v[172:175], v6, s[36:39], s68 offen nt
    s_addk_i32 s68, 14336
    s_waitcnt vmcnt(6)
    s_bitcmp0_b32 s97, 0
    s_cbranch_scc0 L_de30
    s_waitcnt vmcnt(5)
L_de30:
    buffer_load_dwordx4 v[176:179], v6, s[36:39], s68 offen nt
    s_addk_i32 s68, 14336
    s_waitcnt vmcnt(6)
    buffer_load_dwordx4 v[180:183], v6, s[36:39], s68 offen nt
    s_addk_i32 s68, 14336
    s_waitcnt vmcnt(6)
    s_bitcmp0_b32 s97, 0
    s_cbranch_scc0 L_de32
    s_waitcnt vmcnt(5)
L_de32:
    buffer_load_dwordx4 v[184:187], v6, s[36:39], s68 offen nt
    s_addk_i32 s68, 14336
    s_waitcnt vmcnt(6)
    buffer_load_dwordx4 v[188:191], v6, s[36:39], s68 offen nt
    s_addk_i32 s68, 14336
    s_waitcnt vmcnt(6)
    s_bitcmp0_b32 s97, 0
    s_cbranch_scc0 L_de34
    s_waitcnt vmcnt(5)
L_de34:
    buffer_load_dwordx4 v[192:195], v6, s[36:39], s68 offen nt
    s_addk_i32 s68, 14336
    s_waitcnt vmcnt(6)
    buffer_load_dwordx4 v[196:199], v6, s[36:39], s68 offen nt
    s_addk_i32 s68, 14336
    s_waitcnt vmcnt(6)
    s_bitcmp0_b32 s97, 0
    s_cbranch_scc0 L_de36
    s_waitcnt vmcnt(5)
L_de36:
    buffer_load_dwordx4 v[200:203], v6, s[36:39], s68 offen nt
    s_addk_i32 s68, 14336
    s_waitcnt vmcnt(6)
    buffer_load_dwordx4 v[204:207], v6, s[36:39], s68 offen nt
    s_addk_i32 s68, 14336
    s_waitcnt vmcnt(6)
    s_bitcmp0_b32 s97, 0
    s_cbranch_scc0 L_de38
    s_waitcnt vmcnt(5)
L_de38:
    buffer_load_dwordx4 v[208:211], v6, s[36:39], s68 offen nt
    s_addk_i32 s68, 14336
    s_waitcnt vmcnt(6)
    buffer_load_dwordx4 v[212:215], v6, s[36:39], s68 offen nt
    s_addk_i32 s68, 14336
    s_barrier
    ds_read_b128 v[20:23], v10 offset:0
    s_waitcnt lgkmcnt(0)
    v_cmp_eq_u32 vcc, 0, v13
    s_nop 1
    v_cndmask_b32 v40, 0, v20, vcc
    v_cndmask_b32 v41, 0, v21, vcc
    v_cndmask_b32 v42, 0, v22, vcc
    v_cndmask_b32 v43, 0, v23, vcc
    v_cmp_eq_u32 vcc, 1, v13
    s_nop 1
    v_cndmask_b32 v44, 0, v20, vcc
    v_cndmask_b32 v45, 0, v21, vcc
    v_cndmask_b32 v46, 0, v22, vcc
    v_cndmask_b32 v47, 0, v23, vcc
    v_cmp_eq_u32 vcc, 2, v13
    s_nop 1
    v_cndmask_b32 v48, 0, v20, vcc
    v_cndmask_b32 v49, 0, v21, vcc
    v_cndmask_b32 v50, 0, v22, vcc
    v_cndmask_b32 v51, 0, v23, vcc
    v_cmp_eq_u32 vcc, 3, v13
    s_nop 1
    v_cndmask_b32 v52, 0, v20, vcc
    v_cndmask_b32 v53, 0, v21, vcc
    v_cndmask_b32 v54, 0, v22, vcc
    v_cndmask_b32 v55, 0, v23, vcc
    v_mfma_f32_16x16x32_bf16 v[24:27], v[56:59], v[40:43], 0
    v_mfma_f32_16x16x32_bf16 v[24:27], v[60:63], v[44:47], v[24:27]
    v_mfma_f32_16x16x32_bf16 v[24:27], v[64:67], v[48:51], v[24:27]
    v_mfma_f32_16x16x32_bf16 v[24:27], v[68:71], v[52:55], v[24:27]
    v_mfma_f32_16x16x32_bf16 v[28:31], v[72:75], v[40:43], 0
    v_mfma_f32_16x16x32_bf16 v[28:31], v[76:79], v[44:47], v[28:31]
    s_waitcnt vmcnt(6)
    s_bitcmp0_b32 s97, 0
    s_cbranch_scc0 L_de40
    s_waitcnt vmcnt(5)
L_de40:
    buffer_load_dwordx4 v[56:59], v6, s[36:39], s68 offen nt
    s_addk_i32 s68, 14336
    s_nop 0
    v_mov_b32_dpp v216, v24 quad_perm:[0,0,0,0] row_mask:0xf bank_mask:0xf
    v_mov_b32_dpp v9, v26 quad_perm:[2,2,2,2] row_mask:0xf bank_mask:0xf
    s_nop 0
    v_add_f32_dpp v216, v25, v216 quad_perm:[1,1,1,1] row_mask:0xf bank_mask:0xf
    v_add_f32_dpp v9, v27, v9 quad_perm:[3,3,3,3] row_mask:0xf bank_mask:0xf
    v_add_f32 v216, v216, v9
    v_cvt_pk_bf16_f32 v216, v216, v216
    v_and_b32 v216, 0xffff0000, v216
    v_mul_f32 v216, 0x3db504f3, v216
    v_cvt_pk_bf16_f32 v216, v216, v216
    v_and_b32 v216, 0xffff0000, v216
    v_mov_b32 v14, v216
    v_mfma_f32_16x16x32_bf16 v[28:31], v[80:83], v[48:51], v[28:31]
    v_mfma_f32_16x16x32_bf16 v[28:31], v[84:87], v[52:55], v[28:31]
    v_mfma_f32_16x16x32_bf16 v[24:27], v[88:91], v[40:43], 0
    v_mfma_f32_16x16x32_bf16 v[24:27], v[92:95], v[44:47], v[24:27]
    s_nop 5
    v_mov_b32_dpp v217, v28 quad_perm:[0,0,0,0] row_mask:0xf bank_mask:0xf
    v_mov_b32_dpp v9, v30 quad_perm:[2,2,2,2] row_mask:0xf bank_mask:0xf
    s_nop 0
    v_add_f32_dpp v217, v29, v217 quad_perm:[1,1,1,1] row_mask:0xf bank_mask:0xf
    v_add_f32_dpp v9, v31, v9 quad_perm:[3,3,3,3] row_mask:0xf bank_mask:0xf
    v_add_f32 v217, v217, v9
    v_cvt_pk_bf16_f32 v217, v217, v217
    v_and_b32 v217, 0xffff0000, v217
    v_mul_f32 v217, 0x3db504f3, v217
    v_cvt_pk_bf16_f32 v217, v217, v217
    v_and_b32 v217, 0xffff0000, v217
    v_max_f32 v14, v14, v217
    v_mfma_f32_16x16x32_bf16 v[24:27], v[96:99], v[48:51], v[24:27]
    v_mfma_f32_16x16x32_bf16 v[24:27], v[100:103], v[52:55], v[24:27]
    s_waitcnt vmcnt(6)
    buffer_load_dwordx4 v[60:63], v6, s[36:39], s68 offen nt
    s_addk_i32 s68, 14336
    v_mfma_f32_16x16x32_bf16 v[28:31], v[104:107], v[40:43], 0
    v_mfma_f32_16x16x32_bf16 v[28:31], v[108:111], v[44:47], v[28:31]
    s_nop 2
    v_mov_b32_dpp v218, v24 quad_perm:[0,0,0,0] row_mask:0xf bank_mask:0xf
    v_mov_b32_dpp v9, v26 quad_perm:[2,2,2,2] row_mask:0xf bank_mask:0xf
    s_nop 0
    v_add_f32_dpp v218, v25, v218 quad_perm:[1,1,1,1] row_mask:0xf bank_mask:0xf
    v_add_f32_dpp v9, v27, v9 quad_perm:[3,3,3,3] row_mask:0xf bank_mask:0xf
    v_add_f32 v218, v218, v9
    v_cvt_pk_bf16_f32 v218, v218, v218
    v_and_b32 v218, 0xffff0000, v218
    v_mul_f32 v218, 0x3db504f3, v218
    v_cvt_pk_bf16_f32 v218, v218, v218
    v_and_b32 v218, 0xffff0000, v218
    v_max_f32 v14, v14, v218
    v_mfma_f32_16x16x32_bf16 v[28:31], v[112:115], v[48:51], v[28:31]
    v_mfma_f32_16x16x32_bf16 v[28:31], v[116:119], v[52:55], v[28:31]
    v_mfma_f32_16x16x32_bf16 v[24:27], v[120:123], v[40:43], 0
    v_mfma_f32_16x16x32_bf16 v[24:27], v[124:127], v[44:47], v[24:27]
    s_waitcnt vmcnt(6)
    s_bitcmp0_b32 s97, 0
    s_cbranch_scc0 L_de42
    s_waitcnt vmcnt(5)
L_de42:
    buffer_load_dwordx4 v[64:67], v6, s[36:39], s68 offen nt
    s_addk_i32 s68, 14336
    s_nop 0
    v_mov_b32_dpp v219, v28 quad_perm:[0,0,0,0] row_mask:0xf bank_mask:0xf
    v_mov_b32_dpp v9, v30 quad_perm:[2,2,2,2] row_mask:0xf bank_mask:0xf
    s_nop 0
    v_add_f32_dpp v219, v29, v219 quad_perm:[1,1,1,1] row_mask:0xf bank_mask:0xf
    v_add_f32_dpp v9, v31, v9 quad_perm:[3,3,3,3] row_mask:0xf bank_mask:0xf
    v_add_f32 v219, v219, v9
    v_cvt_pk_bf16_f32 v219, v219, v219
    v_and_b32 v219, 0xffff0000, v219
    v_mul_f32 v219, 0x3db504f3, v219
    v_cvt_pk_bf16_f32 v219, v219, v219
    v_and_b32 v219, 0xffff0000, v219
    v_max_f32 v14, v14, v219
    v_mfma_f32_16x16x32_bf16 v[24:27], v[128:131], v[48:51], v[24:27]
    v_mfma_f32_16x16x32_bf16 v[24:27], v[132:135], v[52:55], v[24:27]
    v_mfma_f32_16x16x32_bf16 v[28:31], v[136:139], v[40:43], 0
    v_mfma_f32_16x16x32_bf16 v[28:31], v[140:143], v[44:47], v[28:31]
    s_nop 5
    v_mov_b32_dpp v220, v24 quad_perm:[0,0,0,0] row_mask:0xf bank_mask:0xf
    v_mov_b32_dpp v9, v26 quad_perm:[2,2,2,2] row_mask:0xf bank_mask:0xf
    s_nop 0
    v_add_f32_dpp v220, v25, v220 quad_perm:[1,1,1,1] row_mask:0xf bank_mask:0xf
    v_add_f32_dpp v9, v27, v9 quad_perm:[3,3,3,3] row_mask:0xf bank_mask:0xf
    v_add_f32 v220, v220, v9
    v_cvt_pk_bf16_f32 v220, v220, v220
    v_and_b32 v220, 0xffff0000, v220
    v_mul_f32 v220, 0x3db504f3, v220
    v_cvt_pk_bf16_f32 v220, v220, v220
    v_and_b32 v220, 0xffff0000, v220
    v_max_f32 v14, v14, v220
    v_mfma_f32_16x16x32_bf16 v[28:31], v[144:147], v[48:51], v[28:31]
    v_mfma_f32_16x16x32_bf16 v[28:31], v[148:151], v[52:55], v[28:31]
    s_waitcnt vmcnt(6)
    buffer_load_dwordx4 v[68:71], v6, s[36:39], s68 offen nt
    s_addk_i32 s68, 14336
    v_mfma_f32_16x16x32_bf16 v[24:27], v[152:155], v[40:43], 0
    v_mfma_f32_16x16x32_bf16 v[24:27], v[156:159], v[44:47], v[24:27]
    s_nop 2
    v_mov_b32_dpp v221, v28 quad_perm:[0,0,0,0] row_mask:0xf bank_mask:0xf
    v_mov_b32_dpp v9, v30 quad_perm:[2,2,2,2] row_mask:0xf bank_mask:0xf
    s_nop 0
    v_add_f32_dpp v221, v29, v221 quad_perm:[1,1,1,1] row_mask:0xf bank_mask:0xf
    v_add_f32_dpp v9, v31, v9 quad_perm:[3,3,3,3] row_mask:0xf bank_mask:0xf
    v_add_f32 v221, v221, v9
    v_cvt_pk_bf16_f32 v221, v221, v221
    v_and_b32 v221, 0xffff0000, v221
    v_mul_f32 v221, 0x3db504f3, v221
    v_cvt_pk_bf16_f32 v221, v221, v221
    v_and_b32 v221, 0xffff0000, v221
    v_max_f32 v14, v14, v221
    v_mfma_f32_16x16x32_bf16 v[24:27], v[160:163], v[48:51], v[24:27]
    v_mfma_f32_16x16x32_bf16 v[24:27], v[164:167], v[52:55], v[24:27]
    v_mfma_f32_16x16x32_bf16 v[28:31], v[168:171], v[40:43], 0
    v_mfma_f32_16x16x32_bf16 v[28:31], v[172:175], v[44:47], v[28:31]
    s_waitcnt vmcnt(6)
    s_bitcmp0_b32 s97, 0
    s_cbranch_scc0 L_de44
    s_waitcnt vmcnt(5)
L_de44:
    buffer_load_dwordx4 v[72:75], v6, s[36:39], s68 offen nt
    s_addk_i32 s68, 14336
    s_nop 0
    v_mov_b32_dpp v222, v24 quad_perm:[0,0,0,0] row_mask:0xf bank_mask:0xf
    v_mov_b32_dpp v9, v26 quad_perm:[2,2,2,2] row_mask:0xf bank_mask:0xf
    s_nop 0
    v_add_f32_dpp v222, v25, v222 quad_perm:[1,1,1,1] row_mask:0xf bank_mask:0xf
    v_add_f32_dpp v9, v27, v9 quad_perm:[3,3,3,3] row_mask:0xf bank_mask:0xf
    v_add_f32 v222, v222, v9
    v_cvt_pk_bf16_f32 v222, v222, v222
    v_and_b32 v222, 0xffff0000, v222
    v_mul_f32 v222, 0x3db504f3, v222
    v_cvt_pk_bf16_f32 v222, v222, v222
    v_and_b32 v222, 0xffff0000, v222
    v_max_f32 v14, v14, v222
    v_mfma_f32_16x16x32_bf16 v[28:31], v[176:179], v[48:51], v[28:31]
    v_mfma_f32_16x16x32_bf16 v[28:31], v[180:183], v[52:55], v[28:31]
    v_mfma_f32_16x16x32_bf16 v[24:27], v[184:187], v[40:43], 0
    v_mfma_f32_16x16x32_bf16 v[24:27], v[188:191], v[44:47], v[24:27]
    s_nop 5
    v_mov_b32_dpp v223, v28 quad_perm:[0,0,0,0] row_mask:0xf bank_mask:0xf
    v_mov_b32_dpp v9, v30 quad_perm:[2,2,2,2] row_mask:0xf bank_mask:0xf
    s_nop 0
    v_add_f32_dpp v223, v29, v223 quad_perm:[1,1,1,1] row_mask:0xf bank_mask:0xf
    v_add_f32_dpp v9, v31, v9 quad_perm:[3,3,3,3] row_mask:0xf bank_mask:0xf
    v_add_f32 v223, v223, v9
    v_cvt_pk_bf16_f32 v223, v223, v223
    v_and_b32 v223, 0xffff0000, v223
    v_mul_f32 v223, 0x3db504f3, v223
    v_cvt_pk_bf16_f32 v223, v223, v223
    v_and_b32 v223, 0xffff0000, v223
    v_max_f32 v14, v14, v223
    v_mfma_f32_16x16x32_bf16 v[24:27], v[192:195], v[48:51], v[24:27]
    v_mfma_f32_16x16x32_bf16 v[24:27], v[196:199], v[52:55], v[24:27]
    s_waitcnt vmcnt(6)
    buffer_load_dwordx4 v[76:79], v6, s[36:39], s68 offen nt
    s_addk_i32 s68, 14336
    v_mfma_f32_16x16x32_bf16 v[28:31], v[200:203], v[40:43], 0
    v_mfma_f32_16x16x32_bf16 v[28:31], v[204:207], v[44:47], v[28:31]
    s_nop 2
    v_mov_b32_dpp v224, v24 quad_perm:[0,0,0,0] row_mask:0xf bank_mask:0xf
    v_mov_b32_dpp v9, v26 quad_perm:[2,2,2,2] row_mask:0xf bank_mask:0xf
    s_nop 0
    v_add_f32_dpp v224, v25, v224 quad_perm:[1,1,1,1] row_mask:0xf bank_mask:0xf
    v_add_f32_dpp v9, v27, v9 quad_perm:[3,3,3,3] row_mask:0xf bank_mask:0xf
    v_add_f32 v224, v224, v9
    v_cvt_pk_bf16_f32 v224, v224, v224
    v_and_b32 v224, 0xffff0000, v224
    v_mul_f32 v224, 0x3db504f3, v224
    v_cvt_pk_bf16_f32 v224, v224, v224
    v_and_b32 v224, 0xffff0000, v224
    v_max_f32 v14, v14, v224
    v_mfma_f32_16x16x32_bf16 v[28:31], v[208:211], v[48:51], v[28:31]
    s_waitcnt vmcnt(6)
    v_mfma_f32_16x16x32_bf16 v[28:31], v[212:215], v[52:55], v[28:31]
    s_bitcmp0_b32 s97, 0
    s_cbranch_scc0 L_de46
    s_waitcnt vmcnt(5)
L_de46:
    buffer_load_dwordx4 v[80:83], v6, s[36:39], s68 offen nt
    s_addk_i32 s68, 14336
    s_waitcnt vmcnt(6)
    v_mfma_f32_16x16x32_bf16 v[24:27], v[56:59], v[40:43], 0
    buffer_load_dwordx4 v[84:87], v6, s[36:39], s68 offen nt
    s_addk_i32 s68, 14336
    s_waitcnt vmcnt(6)
    v_mfma_f32_16x16x32_bf16 v[24:27], v[60:63], v[44:47], v[24:27]
    s_bitcmp0_b32 s97, 0
    s_cbranch_scc0 L_de48
    s_waitcnt vmcnt(5)
L_de48:
    buffer_load_dwordx4 v[88:91], v6, s[36:39], s68 offen nt
    s_addk_i32 s68, 14336
    v_mov_b32_dpp v225, v28 quad_perm:[0,0,0,0] row_mask:0xf bank_mask:0xf
    v_mov_b32_dpp v9, v30 quad_perm:[2,2,2,2] row_mask:0xf bank_mask:0xf
    s_nop 0
    v_add_f32_dpp v225, v29, v225 quad_perm:[1,1,1,1] row_mask:0xf bank_mask:0xf
    v_add_f32_dpp v9, v31, v9 quad_perm:[3,3,3,3] row_mask:0xf bank_mask:0xf
    v_add_f32 v225, v225, v9
    v_cvt_pk_bf16_f32 v225, v225, v225
    v_and_b32 v225, 0xffff0000, v225
    v_mul_f32 v225, 0x3db504f3, v225
    v_cvt_pk_bf16_f32 v225, v225, v225
    v_and_b32 v225, 0xffff0000, v225
    v_max_f32 v14, v14, v225
    s_waitcnt vmcnt(6)
    v_mfma_f32_16x16x32_bf16 v[24:27], v[64:67], v[48:51], v[24:27]
    buffer_load_dwordx4 v[92:95], v6, s[36:39], s68 offen nt
    s_addk_i32 s68, 14336
    s_waitcnt vmcnt(6)
    v_mfma_f32_16x16x32_bf16 v[24:27], v[68:71], v[52:55], v[24:27]
    s_bitcmp0_b32 s97, 0
    s_cbranch_scc0 L_de50
    s_waitcnt vmcnt(5)
L_de50:
    buffer_load_dwordx4 v[96:99], v6, s[36:39], s68 offen nt
    s_addk_i32 s68, 14336
    s_waitcnt vmcnt(6)
    v_mfma_f32_16x16x32_bf16 v[28:31], v[72:75], v[40:43], 0
    buffer_load_dwordx4 v[100:103], v6, s[36:39], s68 offen nt
    s_addk_i32 s68, 14336
    s_waitcnt vmcnt(6)
    v_mfma_f32_16x16x32_bf16 v[28:31], v[76:79], v[44:47], v[28:31]
    s_bitcmp0_b32 s97, 0
    s_cbranch_scc0 L_de52
    s_waitcnt vmcnt(5)
L_de52:
    buffer_load_dwordx4 v[104:107], v6, s[36:39], s68 offen nt
    s_addk_i32 s68, 14336
    v_mov_b32_dpp v226, v24 quad_perm:[0,0,0,0] row_mask:0xf bank_mask:0xf
    v_mov_b32_dpp v9, v26 quad_perm:[2,2,2,2] row_mask:0xf bank_mask:0xf
    s_nop 0
    v_add_f32_dpp v226, v25, v226 quad_perm:[1,1,1,1] row_mask:0xf bank_mask:0xf
    v_add_f32_dpp v9, v27, v9 quad_perm:[3,3,3,3] row_mask:0xf bank_mask:0xf
    v_add_f32 v226, v226, v9
    v_cvt_pk_bf16_f32 v226, v226, v226
    v_and_b32 v226, 0xffff0000, v226
    v_mul_f32 v226, 0x3db504f3, v226
    v_cvt_pk_bf16_f32 v226, v226, v226
    v_and_b32 v226, 0xffff0000, v226
    v_max_f32 v14, v14, v226
    s_waitcnt vmcnt(6)
    v_mfma_f32_16x16x32_bf16 v[28:31], v[80:83], v[48:51], v[28:31]
    buffer_load_dwordx4 v[108:111], v6, s[36:39], s68 offen nt
    s_addk_i32 s68, 14336
    s_waitcnt vmcnt(6)
    v_mfma_f32_16x16x32_bf16 v[28:31], v[84:87], v[52:55], v[28:31]
    s_bitcmp0_b32 s97, 0
    s_cbranch_scc0 L_de54
    s_waitcnt vmcnt(5)
L_de54:
    buffer_load_dwordx4 v[112:115], v6, s[36:39], s68 offen nt
    s_addk_i32 s68, 14336
    s_waitcnt vmcnt(6)
    v_mfma_f32_16x16x32_bf16 v[24:27], v[88:91], v[40:43], 0
    buffer_load_dwordx4 v[116:119], v6, s[36:39], s68 offen nt
    s_addk_i32 s68, 14336
    s_waitcnt vmcnt(6)
    v_mfma_f32_16x16x32_bf16 v[24:27], v[92:95], v[44:47], v[24:27]
    s_bitcmp0_b32 s97, 0
    s_cbranch_scc0 L_de56
    s_waitcnt vmcnt(5)
L_de56:
    buffer_load_dwordx4 v[120:123], v6, s[36:39], s68 offen nt
    s_addk_i32 s68, 14336
    v_mov_b32_dpp v227, v28 quad_perm:[0,0,0,0] row_mask:0xf bank_mask:0xf
    v_mov_b32_dpp v9, v30 quad_perm:[2,2,2,2] row_mask:0xf bank_mask:0xf
    s_nop 0
    v_add_f32_dpp v227, v29, v227 quad_perm:[1,1,1,1] row_mask:0xf bank_mask:0xf
    v_add_f32_dpp v9, v31, v9 quad_perm:[3,3,3,3] row_mask:0xf bank_mask:0xf
    v_add_f32 v227, v227, v9
    v_cvt_pk_bf16_f32 v227, v227, v227
    v_and_b32 v227, 0xffff0000, v227
    v_mul_f32 v227, 0x3db504f3, v227
    v_cvt_pk_bf16_f32 v227, v227, v227
    v_and_b32 v227, 0xffff0000, v227
    v_max_f32 v14, v14, v227
    s_waitcnt vmcnt(6)
    v_mfma_f32_16x16x32_bf16 v[24:27], v[96:99], v[48:51], v[24:27]
    buffer_load_dwordx4 v[124:127], v6, s[36:39], s68 offen nt
    s_addk_i32 s68, 14336
    s_waitcnt vmcnt(6)
    v_mfma_f32_16x16x32_bf16 v[24:27], v[100:103], v[52:55], v[24:27]
    s_bitcmp0_b32 s97, 0
    s_cbranch_scc0 L_de58
    s_waitcnt vmcnt(5)
L_de58:
    buffer_load_dwordx4 v[128:131], v6, s[36:39], s68 offen nt
    s_addk_i32 s68, 14336
    s_waitcnt vmcnt(6)
    v_mfma_f32_16x16x32_bf16 v[28:31], v[104:107], v[40:43], 0
    buffer_load_dwordx4 v[132:135], v6, s[36:39], s68 offen nt
    s_addk_i32 s68, 14336
    s_waitcnt vmcnt(6)
    v_mfma_f32_16x16x32_bf16 v[28:31], v[108:111], v[44:47], v[28:31]
    s_bitcmp0_b32 s97, 0
    s_cbranch_scc0 L_de60
    s_waitcnt vmcnt(5)
L_de60:
    buffer_load_dwordx4 v[136:139], v6, s[36:39], s68 offen nt
    s_addk_i32 s68, 14336
    v_mov_b32_dpp v228, v24 quad_perm:[0,0,0,0] row_mask:0xf bank_mask:0xf
    v_mov_b32_dpp v9, v26 quad_perm:[2,2,2,2] row_mask:0xf bank_mask:0xf
    s_nop 0
    v_add_f32_dpp v228, v25, v228 quad_perm:[1,1,1,1] row_mask:0xf bank_mask:0xf
    v_add_f32_dpp v9, v27, v9 quad_perm:[3,3,3,3] row_mask:0xf bank_mask:0xf
    v_add_f32 v228, v228, v9
    v_cvt_pk_bf16_f32 v228, v228, v228
    v_and_b32 v228, 0xffff0000, v228
    v_mul_f32 v228, 0x3db504f3, v228
    v_cvt_pk_bf16_f32 v228, v228, v228
    v_and_b32 v228, 0xffff0000, v228
    v_max_f32 v14, v14, v228
    s_waitcnt vmcnt(6)
    v_mfma_f32_16x16x32_bf16 v[28:31], v[112:115], v[48:51], v[28:31]
    buffer_load_dwordx4 v[140:143], v6, s[36:39], s68 offen nt
    s_addk_i32 s68, 14336
    s_waitcnt vmcnt(6)
    v_mfma_f32_16x16x32_bf16 v[28:31], v[116:119], v[52:55], v[28:31]
    s_bitcmp0_b32 s97, 0
    s_cbranch_scc0 L_de62
    s_waitcnt vmcnt(5)
L_de62:
    buffer_load_dwordx4 v[144:147], v6, s[36:39], s68 offen nt
    s_addk_i32 s68, 14336
    s_waitcnt vmcnt(6)
    v_mfma_f32_16x16x32_bf16 v[24:27], v[120:123], v[40:43], 0
    buffer_load_dwordx4 v[148:151], v6, s[36:39], s68 offen nt
    s_addk_i32 s68, 14336
    s_waitcnt vmcnt(6)
    v_mfma_f32_16x16x32_bf16 v[24:27], v[124:127], v[44:47], v[24:27]
    s_bitcmp0_b32 s97, 0
    s_cbranch_scc0 L_de64
    s_waitcnt vmcnt(5)
L_de64:
    buffer_load_dwordx4 v[152:155], v6, s[36:39], s68 offen nt
    s_addk_i32 s68, 14336
    v_mov_b32_dpp v229, v28 quad_perm:[0,0,0,0] row_mask:0xf bank_mask:0xf
    v_mov_b32_dpp v9, v30 quad_perm:[2,2,2,2] row_mask:0xf bank_mask:0xf
    s_nop 0
    v_add_f32_dpp v229, v29, v229 quad_perm:[1,1,1,1] row_mask:0xf bank_mask:0xf
    v_add_f32_dpp v9, v31, v9 quad_perm:[3,3,3,3] row_mask:0xf bank_mask:0xf
    v_add_f32 v229, v229, v9
    v_cvt_pk_bf16_f32 v229, v229, v229
    v_and_b32 v229, 0xffff0000, v229
    v_mul_f32 v229, 0x3db504f3, v229
    v_cvt_pk_bf16_f32 v229, v229, v229
    v_and_b32 v229, 0xffff0000, v229
    v_max_f32 v14, v14, v229
    s_waitcnt vmcnt(6)
    v_mfma_f32_16x16x32_bf16 v[24:27], v[128:131], v[48:51], v[24:27]
    buffer_load_dwordx4 v[156:159], v6, s[36:39], s68 offen nt
    s_addk_i32 s68, 14336
    s_waitcnt vmcnt(6)
    v_mfma_f32_16x16x32_bf16 v[24:27], v[132:135], v[52:55], v[24:27]
    s_bitcmp0_b32 s97, 0
    s_cbranch_scc0 L_de66
    s_waitcnt vmcnt(5)
L_de66:
    buffer_load_dwordx4 v[160:163], v6, s[36:39], s68 offen nt
    s_addk_i32 s68, 14336
    s_waitcnt vmcnt(6)
    v_mfma_f32_16x16x32_bf16 v[28:31], v[136:139], v[40:43], 0
    buffer_load_dwordx4 v[164:167], v6, s[36:39], s68 offen nt
    s_addk_i32 s68, 14336
    s_waitcnt vmcnt(6)
    v_mfma_f32_16x16x32_bf16 v[28:31], v[140:143], v[44:47], v[28:31]
    s_bitcmp0_b32 s97, 0
    s_cbranch_scc0 L_de68
    s_waitcnt vmcnt(5)
L_de68:
    buffer_load_dwordx4 v[168:171], v6, s[36:39], s68 offen nt
    s_addk_i32 s68, 14336
    v_mov_b32_dpp v230, v24 quad_perm:[0,0,0,0] row_mask:0xf bank_mask:0xf
    v_mov_b32_dpp v9, v26 quad_perm:[2,2,2,2] row_mask:0xf bank_mask:0xf
    s_nop 0
    v_add_f32_dpp v230, v25, v230 quad_perm:[1,1,1,1] row_mask:0xf bank_mask:0xf
    v_add_f32_dpp v9, v27, v9 quad_perm:[3,3,3,3] row_mask:0xf bank_mask:0xf
    v_add_f32 v230, v230, v9
    v_cvt_pk_bf16_f32 v230, v230, v230
    v_and_b32 v230, 0xffff0000, v230
    v_mul_f32 v230, 0x3db504f3, v230
    v_cvt_pk_bf16_f32 v230, v230, v230
    v_and_b32 v230, 0xffff0000, v230
    v_max_f32 v14, v14, v230
    s_waitcnt vmcnt(6)
    v_mfma_f32_16x16x32_bf16 v[28:31], v[144:147], v[48:51], v[28:31]
    buffer_load_dwordx4 v[172:175], v6, s[36:39], s68 offen nt
    s_addk_i32 s68, 14336
    s_waitcnt vmcnt(6)
    v_mfma_f32_16x16x32_bf16 v[28:31], v[148:151], v[52:55], v[28:31]
    s_bitcmp0_b32 s97, 0
    s_cbranch_scc0 L_de70
    s_waitcnt vmcnt(5)
L_de70:
    buffer_load_dwordx4 v[176:179], v6, s[36:39], s68 offen nt
    s_addk_i32 s68, 14336
    s_waitcnt vmcnt(6)
    v_mfma_f32_16x16x32_bf16 v[24:27], v[152:155], v[40:43], 0
    buffer_load_dwordx4 v[180:183], v6, s[36:39], s68 offen nt
    s_addk_i32 s68, 14336
    s_waitcnt vmcnt(6)
    v_mfma_f32_16x16x32_bf16 v[24:27], v[156:159], v[44:47], v[24:27]
    s_bitcmp0_b32 s97, 0
    s_cbranch_scc0 L_de72
    s_waitcnt vmcnt(5)
L_de72:
    buffer_load_dwordx4 v[184:187], v6, s[36:39], s68 offen nt
    s_addk_i32 s68, 14336
    v_mov_b32_dpp v231, v28 quad_perm:[0,0,0,0] row_mask:0xf bank_mask:0xf
    v_mov_b32_dpp v9, v30 quad_perm:[2,2,2,2] row_mask:0xf bank_mask:0xf
    s_nop 0
    v_add_f32_dpp v231, v29, v231 quad_perm:[1,1,1,1] row_mask:0xf bank_mask:0xf
    v_add_f32_dpp v9, v31, v9 quad_perm:[3,3,3,3] row_mask:0xf bank_mask:0xf
    v_add_f32 v231, v231, v9
    v_cvt_pk_bf16_f32 v231, v231, v231
    v_and_b32 v231, 0xffff0000, v231
    v_mul_f32 v231, 0x3db504f3, v231
    v_cvt_pk_bf16_f32 v231, v231, v231
    v_and_b32 v231, 0xffff0000, v231
    v_max_f32 v14, v14, v231
    s_waitcnt vmcnt(6)
    v_mfma_f32_16x16x32_bf16 v[24:27], v[160:163], v[48:51], v[24:27]
    buffer_load_dwordx4 v[188:191], v6, s[36:39], s68 offen nt
    s_addk_i32 s68, 14336
    s_waitcnt vmcnt(6)
    v_mfma_f32_16x16x32_bf16 v[24:27], v[164:167], v[52:55], v[24:27]
    s_bitcmp0_b32 s97, 0
    s_cbranch_scc0 L_de74
    s_waitcnt vmcnt(5)
L_de74:
    buffer_load_dwordx4 v[192:195], v6, s[36:39], s68 offen nt
    s_addk_i32 s68, 14336
    s_waitcnt vmcnt(6)
    v_mfma_f32_16x16x32_bf16 v[28:31], v[168:171], v[40:43], 0
    buffer_load_dwordx4 v[196:199], v6, s[36:39], s68 offen nt
    s_addk_i32 s68, 14336
    s_waitcnt vmcnt(6)
    v_mfma_f32_16x16x32_bf16 v[28:31], v[172:175], v[44:47], v[28:31]
    s_bitcmp0_b32 s97, 0
    s_cbranch_scc0 L_de76
    s_waitcnt vmcnt(5)
L_de76:
    buffer_load_dwordx4 v[200:203], v6, s[36:39], s68 offen nt
    s_addk_i32 s68, 14336
    v_mov_b32_dpp v232, v24 quad_perm:[0,0,0,0] row_mask:0xf bank_mask:0xf
    v_mov_b32_dpp v9, v26 quad_perm:[2,2,2,2] row_mask:0xf bank_mask:0xf
    s_nop 0
    v_add_f32_dpp v232, v25, v232 quad_perm:[1,1,1,1] row_mask:0xf bank_mask:0xf
    v_add_f32_dpp v9, v27, v9 quad_perm:[3,3,3,3] row_mask:0xf bank_mask:0xf
    v_add_f32 v232, v232, v9
    v_cvt_pk_bf16_f32 v232, v232, v232
    v_and_b32 v232, 0xffff0000, v232
    v_mul_f32 v232, 0x3db504f3, v232
    v_cvt_pk_bf16_f32 v232, v232, v232
    v_and_b32 v232, 0xffff0000, v232
    v_max_f32 v14, v14, v232
    s_waitcnt vmcnt(6)
    v_mfma_f32_16x16x32_bf16 v[28:31], v[176:179], v[48:51], v[28:31]
    buffer_load_dwordx4 v[204:207], v6, s[36:39], s68 offen nt
    s_addk_i32 s68, 14336
    s_waitcnt vmcnt(6)
    v_mfma_f32_16x16x32_bf16 v[28:31], v[180:183], v[52:55], v[28:31]
    s_bitcmp0_b32 s97, 0
    s_cbranch_scc0 L_de78
    s_waitcnt vmcnt(5)
L_de78:
    buffer_load_dwordx4 v[208:211], v6, s[36:39], s68 offen nt
    s_addk_i32 s68, 14336
    s_waitcnt vmcnt(6)
    v_mfma_f32_16x16x32_bf16 v[24:27], v[184:187], v[40:43], 0
    buffer_load_dwordx4 v[212:215], v6, s[36:39], s68 offen nt
    s_addk_i32 s68, 14336
    s_waitcnt vmcnt(6)
    v_mfma_f32_16x16x32_bf16 v[24:27], v[188:191], v[44:47], v[24:27]
    s_bitcmp0_b32 s97, 0
    s_cbranch_scc0 L_de80
    s_waitcnt vmcnt(5)
L_de80:
    buffer_load_dwordx4 v[56:59], v6, s[36:39], s68 offen nt
    s_addk_i32 s68, 14336
    v_mov_b32_dpp v233, v28 quad_perm:[0,0,0,0] row_mask:0xf bank_mask:0xf
    v_mov_b32_dpp v9, v30 quad_perm:[2,2,2,2] row_mask:0xf bank_mask:0xf
    s_nop 0
    v_add_f32_dpp v233, v29, v233 quad_perm:[1,1,1,1] row_mask:0xf bank_mask:0xf
    v_add_f32_dpp v9, v31, v9 quad_perm:[3,3,3,3] row_mask:0xf bank_mask:0xf
    v_add_f32 v233, v233, v9
    v_cvt_pk_bf16_f32 v233, v233, v233
    v_and_b32 v233, 0xffff0000, v233
    v_mul_f32 v233, 0x3db504f3, v233
    v_cvt_pk_bf16_f32 v233, v233, v233
    v_and_b32 v233, 0xffff0000, v233
    v_max_f32 v14, v14, v233
    s_waitcnt vmcnt(6)
    v_mfma_f32_16x16x32_bf16 v[24:27], v[192:195], v[48:51], v[24:27]
    buffer_load_dwordx4 v[60:63], v6, s[36:39], s68 offen nt
    s_addk_i32 s68, 14336
    s_waitcnt vmcnt(6)
    v_mfma_f32_16x16x32_bf16 v[24:27], v[196:199], v[52:55], v[24:27]
    s_bitcmp0_b32 s97, 0
    s_cbranch_scc0 L_de82
    s_waitcnt vmcnt(5)
L_de82:
    buffer_load_dwordx4 v[64:67], v6, s[36:39], s68 offen nt
    s_addk_i32 s68, 14336
    s_waitcnt vmcnt(6)
    v_mfma_f32_16x16x32_bf16 v[28:31], v[200:203], v[40:43], 0
    buffer_load_dwordx4 v[68:71], v6, s[36:39], s68 offen nt
    s_addk_i32 s68, 14336
    s_waitcnt vmcnt(6)
    v_mfma_f32_16x16x32_bf16 v[28:31], v[204:207], v[44:47], v[28:31]
    s_bitcmp0_b32 s97, 0
    s_cbranch_scc0 L_de84
    s_waitcnt vmcnt(5)
L_de84:
    buffer_load_dwordx4 v[72:75], v6, s[36:39], s68 offen nt
    s_addk_i32 s68, 14336
    v_mov_b32_dpp v234, v24 quad_perm:[0,0,0,0] row_mask:0xf bank_mask:0xf
    v_mov_b32_dpp v9, v26 quad_perm:[2,2,2,2] row_mask:0xf bank_mask:0xf
    s_nop 0
    v_add_f32_dpp v234, v25, v234 quad_perm:[1,1,1,1] row_mask:0xf bank_mask:0xf
    v_add_f32_dpp v9, v27, v9 quad_perm:[3,3,3,3] row_mask:0xf bank_mask:0xf
    v_add_f32 v234, v234, v9
    v_cvt_pk_bf16_f32 v234, v234, v234
    v_and_b32 v234, 0xffff0000, v234
    v_mul_f32 v234, 0x3db504f3, v234
    v_cvt_pk_bf16_f32 v234, v234, v234
    v_and_b32 v234, 0xffff0000, v234
    v_max_f32 v14, v14, v234
    s_waitcnt vmcnt(6)
    v_mfma_f32_16x16x32_bf16 v[28:31], v[208:211], v[48:51], v[28:31]
    buffer_load_dwordx4 v[76:79], v6, s[36:39], s68 offen nt
    s_addk_i32 s68, 14336
    s_waitcnt vmcnt(6)
    v_mfma_f32_16x16x32_bf16 v[28:31], v[212:215], v[52:55], v[28:31]
    s_bitcmp0_b32 s97, 0
    s_cbranch_scc0 L_de86
    s_waitcnt vmcnt(5)
L_de86:
    buffer_load_dwordx4 v[80:83], v6, s[36:39], s68 offen nt
    s_addk_i32 s68, 14336
    s_waitcnt vmcnt(6)
    v_mfma_f32_16x16x32_bf16 v[24:27], v[56:59], v[40:43], 0
    buffer_load_dwordx4 v[84:87], v6, s[36:39], s68 offen nt
    s_addk_i32 s68, 14336
    s_waitcnt vmcnt(6)
    v_mfma_f32_16x16x32_bf16 v[24:27], v[60:63], v[44:47], v[24:27]
    s_bitcmp0_b32 s97, 0
    s_cbranch_scc0 L_de88
    s_waitcnt vmcnt(5)
L_de88:
    buffer_load_dwordx4 v[88:91], v6, s[36:39], s68 offen nt
    s_addk_i32 s68, 14336
    v_mov_b32_dpp v235, v28 quad_perm:[0,0,0,0] row_mask:0xf bank_mask:0xf
    v_mov_b32_dpp v9, v30 quad_perm:[2,2,2,2] row_mask:0xf bank_mask:0xf
    s_nop 0
    v_add_f32_dpp v235, v29, v235 quad_perm:[1,1,1,1] row_mask:0xf bank_mask:0xf
    v_add_f32_dpp v9, v31, v9 quad_perm:[3,3,3,3] row_mask:0xf bank_mask:0xf
    v_add_f32 v235, v235, v9
    v_cvt_pk_bf16_f32 v235, v235, v235
    v_and_b32 v235, 0xffff0000, v235
    v_mul_f32 v235, 0x3db504f3, v235
    v_cvt_pk_bf16_f32 v235, v235, v235
    v_and_b32 v235, 0xffff0000, v235
    v_max_f32 v14, v14, v235
    s_waitcnt vmcnt(6)
    v_mfma_f32_16x16x32_bf16 v[24:27], v[64:67], v[48:51], v[24:27]
    buffer_load_dwordx4 v[92:95], v6, s[36:39], s68 offen nt
    s_addk_i32 s68, 14336
    s_waitcnt vmcnt(6)
    v_mfma_f32_16x16x32_bf16 v[24:27], v[68:71], v[52:55], v[24:27]
    s_bitcmp0_b32 s97, 0
    s_cbranch_scc0 L_de90
    s_waitcnt vmcnt(5)
L_de90:
    buffer_load_dwordx4 v[96:99], v6, s[36:39], s68 offen nt
    s_addk_i32 s68, 14336
    s_waitcnt vmcnt(6)
    v_mfma_f32_16x16x32_bf16 v[28:31], v[72:75], v[40:43], 0
    buffer_load_dwordx4 v[100:103], v6, s[36:39], s68 offen nt
    s_addk_i32 s68, 14336
    s_waitcnt vmcnt(6)
    v_mfma_f32_16x16x32_bf16 v[28:31], v[76:79], v[44:47], v[28:31]
    s_bitcmp0_b32 s97, 0
    s_cbranch_scc0 L_de92
    s_waitcnt vmcnt(5)
L_de92:
    buffer_load_dwordx4 v[104:107], v6, s[36:39], s68 offen nt
    s_addk_i32 s68, 14336
    v_mov_b32_dpp v236, v24 quad_perm:[0,0,0,0] row_mask:0xf bank_mask:0xf
    v_mov_b32_dpp v9, v26 quad_perm:[2,2,2,2] row_mask:0xf bank_mask:0xf
    s_nop 0
    v_add_f32_dpp v236, v25, v236 quad_perm:[1,1,1,1] row_mask:0xf bank_mask:0xf
    v_add_f32_dpp v9, v27, v9 quad_perm:[3,3,3,3] row_mask:0xf bank_mask:0xf
    v_add_f32 v236, v236, v9
    v_cvt_pk_bf16_f32 v236, v236, v236
    v_and_b32 v236, 0xffff0000, v236
    v_mul_f32 v236, 0x3db504f3, v236
    v_cvt_pk_bf16_f32 v236, v236, v236
    v_and_b32 v236, 0xffff0000, v236
    v_max_f32 v14, v14, v236
    s_waitcnt vmcnt(6)
    v_mfma_f32_16x16x32_bf16 v[28:31], v[80:83], v[48:51], v[28:31]
    buffer_load_dwordx4 v[108:111], v6, s[36:39], s68 offen nt
    s_addk_i32 s68, 14336
    s_waitcnt vmcnt(6)
    v_mfma_f32_16x16x32_bf16 v[28:31], v[84:87], v[52:55], v[28:31]
    s_bitcmp0_b32 s97, 0
    s_cbranch_scc0 L_de94
    s_waitcnt vmcnt(5)
L_de94:
    buffer_load_dwordx4 v[112:115], v6, s[36:39], s68 offen nt
    s_addk_i32 s68, 14336
    s_waitcnt vmcnt(6)
    v_mfma_f32_16x16x32_bf16 v[24:27], v[88:91], v[40:43], 0
    buffer_load_dwordx4 v[116:119], v6, s[36:39], s68 offen nt
    s_addk_i32 s68, 14336
    s_waitcnt vmcnt(6)
    v_mfma_f32_16x16x32_bf16 v[24:27], v[92:95], v[44:47], v[24:27]
    s_bitcmp0_b32 s97, 0
    s_cbranch_scc0 L_de96
    s_waitcnt vmcnt(5)
L_de96:
    buffer_load_dwordx4 v[120:123], v6, s[36:39], s68 offen nt
    s_addk_i32 s68, 14336
    v_mov_b32_dpp v237, v28 quad_perm:[0,0,0,0] row_mask:0xf bank_mask:0xf
    v_mov_b32_dpp v9, v30 quad_perm:[2,2,2,2] row_mask:0xf bank_mask:0xf
    s_nop 0
    v_add_f32_dpp v237, v29, v237 quad_perm:[1,1,1,1] row_mask:0xf bank_mask:0xf
    v_add_f32_dpp v9, v31, v9 quad_perm:[3,3,3,3] row_mask:0xf bank_mask:0xf
    v_add_f32 v237, v237, v9
    v_cvt_pk_bf16_f32 v237, v237, v237
    v_and_b32 v237, 0xffff0000, v237
    v_mul_f32 v237, 0x3db504f3, v237
    v_cvt_pk_bf16_f32 v237, v237, v237
    v_and_b32 v237, 0xffff0000, v237
    v_max_f32 v14, v14, v237
    s_waitcnt vmcnt(6)
    v_mfma_f32_16x16x32_bf16 v[24:27], v[96:99], v[48:51], v[24:27]
    buffer_load_dwordx4 v[124:127], v6, s[36:39], s68 offen nt
    s_addk_i32 s68, 14336
    s_waitcnt vmcnt(6)
    v_mfma_f32_16x16x32_bf16 v[24:27], v[100:103], v[52:55], v[24:27]
    s_bitcmp0_b32 s97, 0
    s_cbranch_scc0 L_de98
    s_waitcnt vmcnt(5)
L_de98:
    buffer_load_dwordx4 v[128:131], v6, s[36:39], s68 offen nt
    s_addk_i32 s68, 14336
    s_waitcnt vmcnt(6)
    v_mfma_f32_16x16x32_bf16 v[28:31], v[104:107], v[40:43], 0
    buffer_load_dwordx4 v[132:135], v6, s[36:39], s68 offen nt
    s_addk_i32 s68, 14336
    s_waitcnt vmcnt(6)
    v_mfma_f32_16x16x32_bf16 v[28:31], v[108:111], v[44:47], v[28:31]
    s_bitcmp0_b32 s97, 0
    s_cbranch_scc0 L_de100
    s_waitcnt vmcnt(5)
L_de100:
    buffer_load_dwordx4 v[136:139], v6, s[36:39], s68 offen nt
    s_addk_i32 s68, 14336
    v_mov_b32_dpp v238, v24 quad_perm:[0,0,0,0] row_mask:0xf bank_mask:0xf
    v_mov_b32_dpp v9, v26 quad_perm:[2,2,2,2] row_mask:0xf bank_mask:0xf
    s_nop 0
    v_add_f32_dpp v238, v25, v238 quad_perm:[1,1,1,1] row_mask:0xf bank_mask:0xf
    v_add_f32_dpp v9, v27, v9 quad_perm:[3,3,3,3] row_mask:0xf bank_mask:0xf
    v_add_f32 v238, v238, v9
    v_cvt_pk_bf16_f32 v238, v238, v238
    v_and_b32 v238, 0xffff0000, v238
    v_mul_f32 v238, 0x3db504f3, v238
    v_cvt_pk_bf16_f32 v238, v238, v238
    v_and_b32 v238, 0xffff0000, v238
    v_max_f32 v14, v14, v238
    s_waitcnt vmcnt(6)
    v_mfma_f32_16x16x32_bf16 v[28:31], v[112:115], v[48:51], v[28:31]
    buffer_load_dwordx4 v[140:143], v6, s[36:39], s68 offen nt
    s_addk_i32 s68, 14336
    s_waitcnt vmcnt(6)
    v_mfma_f32_16x16x32_bf16 v[28:31], v[116:119], v[52:55], v[28:31]
    s_bitcmp0_b32 s97, 0
    s_cbranch_scc0 L_de102
    s_waitcnt vmcnt(5)
L_de102:
    buffer_load_dwordx4 v[144:147], v6, s[36:39], s68 offen nt
    s_addk_i32 s68, 14336
    s_waitcnt vmcnt(6)
    v_mfma_f32_16x16x32_bf16 v[24:27], v[120:123], v[40:43], 0
    buffer_load_dwordx4 v[148:151], v6, s[36:39], s68 offen nt
    s_addk_i32 s68, 14336
    s_waitcnt vmcnt(6)
    v_mfma_f32_16x16x32_bf16 v[24:27], v[124:127], v[44:47], v[24:27]
    s_bitcmp0_b32 s97, 0
    s_cbranch_scc0 L_de104
    s_waitcnt vmcnt(5)
L_de104:
    buffer_load_dwordx4 v[152:155], v6, s[36:39], s68 offen nt
    s_addk_i32 s68, 14336
    v_mov_b32_dpp v239, v28 quad_perm:[0,0,0,0] row_mask:0xf bank_mask:0xf
    v_mov_b32_dpp v9, v30 quad_perm:[2,2,2,2] row_mask:0xf bank_mask:0xf
    s_nop 0
    v_add_f32_dpp v239, v29, v239 quad_perm:[1,1,1,1] row_mask:0xf bank_mask:0xf
    v_add_f32_dpp v9, v31, v9 quad_perm:[3,3,3,3] row_mask:0xf bank_mask:0xf
    v_add_f32 v239, v239, v9
    v_cvt_pk_bf16_f32 v239, v239, v239
    v_and_b32 v239, 0xffff0000, v239
    v_mul_f32 v239, 0x3db504f3, v239
    v_cvt_pk_bf16_f32 v239, v239, v239
    v_and_b32 v239, 0xffff0000, v239
    v_max_f32 v14, v14, v239
    s_waitcnt vmcnt(6)
    v_mfma_f32_16x16x32_bf16 v[24:27], v[128:131], v[48:51], v[24:27]
    buffer_load_dwordx4 v[156:159], v6, s[36:39], s68 offen nt
    s_addk_i32 s68, 14336
    s_waitcnt vmcnt(6)
    v_mfma_f32_16x16x32_bf16 v[24:27], v[132:135], v[52:55], v[24:27]
    s_bitcmp0_b32 s97, 0
    s_cbranch_scc0 L_de106
    s_waitcnt vmcnt(5)
L_de106:
    buffer_load_dwordx4 v[160:163], v6, s[36:39], s68 offen nt
    s_addk_i32 s68, 14336
    s_waitcnt vmcnt(6)
    v_mfma_f32_16x16x32_bf16 v[28:31], v[136:139], v[40:43], 0
    buffer_load_dwordx4 v[164:167], v6, s[36:39], s68 offen nt
    s_addk_i32 s68, 14336
    s_waitcnt vmcnt(6)
    v_mfma_f32_16x16x32_bf16 v[28:31], v[140:143], v[44:47], v[28:31]
    s_bitcmp0_b32 s97, 0
    s_cbranch_scc0 L_de108
    s_waitcnt vmcnt(5)
L_de108:
    buffer_load_dwordx4 v[168:171], v6, s[36:39], s68 offen nt
    s_addk_i32 s68, 14336
    v_mov_b32_dpp v240, v24 quad_perm:[0,0,0,0] row_mask:0xf bank_mask:0xf
    v_mov_b32_dpp v9, v26 quad_perm:[2,2,2,2] row_mask:0xf bank_mask:0xf
    s_nop 0
    v_add_f32_dpp v240, v25, v240 quad_perm:[1,1,1,1] row_mask:0xf bank_mask:0xf
    v_add_f32_dpp v9, v27, v9 quad_perm:[3,3,3,3] row_mask:0xf bank_mask:0xf
    v_add_f32 v240, v240, v9
    v_cvt_pk_bf16_f32 v240, v240, v240
    v_and_b32 v240, 0xffff0000, v240
    v_mul_f32 v240, 0x3db504f3, v240
    v_cvt_pk_bf16_f32 v240, v240, v240
    v_and_b32 v240, 0xffff0000, v240
    v_max_f32 v14, v14, v240
    s_waitcnt vmcnt(6)
    v_mfma_f32_16x16x32_bf16 v[28:31], v[144:147], v[48:51], v[28:31]
    buffer_load_dwordx4 v[172:175], v6, s[36:39], s68 offen nt
    s_addk_i32 s68, 14336
    s_waitcnt vmcnt(6)
    v_mfma_f32_16x16x32_bf16 v[28:31], v[148:151], v[52:55], v[28:31]
    s_bitcmp0_b32 s97, 0
    s_cbranch_scc0 L_de110
    s_waitcnt vmcnt(5)
L_de110:
    buffer_load_dwordx4 v[176:179], v6, s[36:39], s68 offen nt
    s_addk_i32 s68, 14336
    s_waitcnt vmcnt(6)
    v_mfma_f32_16x16x32_bf16 v[24:27], v[152:155], v[40:43], 0
    buffer_load_dwordx4 v[180:183], v6, s[36:39], s68 offen nt
    s_addk_i32 s68, 14336
    s_waitcnt vmcnt(6)
    v_mfma_f32_16x16x32_bf16 v[24:27], v[156:159], v[44:47], v[24:27]
    s_bitcmp0_b32 s97, 0
    s_cbranch_scc0 L_de112
    s_waitcnt vmcnt(5)
L_de112:
    buffer_load_dwordx4 v[184:187], v6, s[36:39], s68 offen nt
    s_addk_i32 s68, 14336
    v_mov_b32_dpp v241, v28 quad_perm:[0,0,0,0] row_mask:0xf bank_mask:0xf
    v_mov_b32_dpp v9, v30 quad_perm:[2,2,2,2] row_mask:0xf bank_mask:0xf
    s_nop 0
    v_add_f32_dpp v241, v29, v241 quad_perm:[1,1,1,1] row_mask:0xf bank_mask:0xf
    v_add_f32_dpp v9, v31, v9 quad_perm:[3,3,3,3] row_mask:0xf bank_mask:0xf
    v_add_f32 v241, v241, v9
    v_cvt_pk_bf16_f32 v241, v241, v241
    v_and_b32 v241, 0xffff0000, v241
    v_mul_f32 v241, 0x3db504f3, v241
    v_cvt_pk_bf16_f32 v241, v241, v241
    v_and_b32 v241, 0xffff0000, v241
    v_max_f32 v14, v14, v241
    s_waitcnt vmcnt(6)
    v_mfma_f32_16x16x32_bf16 v[24:27], v[160:163], v[48:51], v[24:27]
    buffer_load_dwordx4 v[188:191], v6, s[36:39], s68 offen nt
    s_addk_i32 s68, 14336
    s_waitcnt vmcnt(6)
    v_mfma_f32_16x16x32_bf16 v[24:27], v[164:167], v[52:55], v[24:27]
    s_bitcmp0_b32 s97, 0
    s_cbranch_scc0 L_de114
    s_waitcnt vmcnt(5)
L_de114:
    buffer_load_dwordx4 v[192:195], v6, s[36:39], s68 offen nt
    s_addk_i32 s68, 14336
    s_waitcnt vmcnt(6)
    v_mfma_f32_16x16x32_bf16 v[28:31], v[168:171], v[40:43], 0
    buffer_load_dwordx4 v[196:199], v6, s[36:39], s68 offen nt
    s_addk_i32 s68, 14336
    s_waitcnt vmcnt(6)
    v_mfma_f32_16x16x32_bf16 v[28:31], v[172:175], v[44:47], v[28:31]
    s_bitcmp0_b32 s97, 0
    s_cbranch_scc0 L_de116
    s_waitcnt vmcnt(5)
L_de116:
    buffer_load_dwordx4 v[200:203], v6, s[36:39], s68 offen nt
    s_addk_i32 s68, 14336
    v_mov_b32_dpp v242, v24 quad_perm:[0,0,0,0] row_mask:0xf bank_mask:0xf
    v_mov_b32_dpp v9, v26 quad_perm:[2,2,2,2] row_mask:0xf bank_mask:0xf
    s_nop 0
    v_add_f32_dpp v242, v25, v242 quad_perm:[1,1,1,1] row_mask:0xf bank_mask:0xf
    v_add_f32_dpp v9, v27, v9 quad_perm:[3,3,3,3] row_mask:0xf bank_mask:0xf
    v_add_f32 v242, v242, v9
    v_cvt_pk_bf16_f32 v242, v242, v242
    v_and_b32 v242, 0xffff0000, v242
    v_mul_f32 v242, 0x3db504f3, v242
    v_cvt_pk_bf16_f32 v242, v242, v242
    v_and_b32 v242, 0xffff0000, v242
    v_max_f32 v14, v14, v242
    s_waitcnt vmcnt(6)
    v_mfma_f32_16x16x32_bf16 v[28:31], v[176:179], v[48:51], v[28:31]
    buffer_load_dwordx4 v[204:207], v6, s[36:39], s68 offen nt
    s_addk_i32 s68, 14336
    s_waitcnt vmcnt(6)
    v_mfma_f32_16x16x32_bf16 v[28:31], v[180:183], v[52:55], v[28:31]
    s_bitcmp0_b32 s97, 0
    s_cbranch_scc0 L_de118
    s_waitcnt vmcnt(5)
L_de118:
    buffer_load_dwordx4 v[208:211], v6, s[36:39], s68 offen nt
    s_addk_i32 s68, 14336
    s_waitcnt vmcnt(6)
    v_mfma_f32_16x16x32_bf16 v[24:27], v[184:187], v[40:43], 0
    buffer_load_dwordx4 v[212:215], v6, s[36:39], s68 offen nt
    s_addk_i32 s68, 14336
    s_waitcnt vmcnt(6)
    v_mfma_f32_16x16x32_bf16 v[24:27], v[188:191], v[44:47], v[24:27]
    s_bitcmp0_b32 s97, 0
    s_cbranch_scc0 L_de120
    s_waitcnt vmcnt(5)
L_de120:
    buffer_load_dwordx4 v[56:59], v6, s[36:39], s68 offen nt
    s_addk_i32 s68, 14336
    v_mov_b32_dpp v243, v28 quad_perm:[0,0,0,0] row_mask:0xf bank_mask:0xf
    v_mov_b32_dpp v9, v30 quad_perm:[2,2,2,2] row_mask:0xf bank_mask:0xf
    s_nop 0
    v_add_f32_dpp v243, v29, v243 quad_perm:[1,1,1,1] row_mask:0xf bank_mask:0xf
    v_add_f32_dpp v9, v31, v9 quad_perm:[3,3,3,3] row_mask:0xf bank_mask:0xf
    v_add_f32 v243, v243, v9
    v_cvt_pk_bf16_f32 v243, v243, v243
    v_and_b32 v243, 0xffff0000, v243
    v_mul_f32 v243, 0x3db504f3, v243
    v_cvt_pk_bf16_f32 v243, v243, v243
    v_and_b32 v243, 0xffff0000, v243
    v_max_f32 v14, v14, v243
    s_waitcnt vmcnt(6)
    v_mfma_f32_16x16x32_bf16 v[24:27], v[192:195], v[48:51], v[24:27]
    buffer_load_dwordx4 v[60:63], v6, s[36:39], s68 offen nt
    s_addk_i32 s68, 14336
    s_waitcnt vmcnt(6)
    v_mfma_f32_16x16x32_bf16 v[24:27], v[196:199], v[52:55], v[24:27]
    s_bitcmp0_b32 s97, 0
    s_cbranch_scc0 L_de122
    s_waitcnt vmcnt(5)
L_de122:
    buffer_load_dwordx4 v[64:67], v6, s[36:39], s68 offen nt
    s_addk_i32 s68, 14336
    s_waitcnt vmcnt(6)
    v_mfma_f32_16x16x32_bf16 v[28:31], v[200:203], v[40:43], 0
    buffer_load_dwordx4 v[68:71], v6, s[36:39], s68 offen nt
    s_addk_i32 s68, 14336
    s_waitcnt vmcnt(6)
    v_mfma_f32_16x16x32_bf16 v[28:31], v[204:207], v[44:47], v[28:31]
    s_bitcmp0_b32 s97, 0
    s_cbranch_scc0 L_de124
    s_waitcnt vmcnt(5)
L_de124:
    buffer_load_dwordx4 v[72:75], v6, s[36:39], s68 offen nt
    s_addk_i32 s68, 14336
    v_mov_b32_dpp v244, v24 quad_perm:[0,0,0,0] row_mask:0xf bank_mask:0xf
    v_mov_b32_dpp v9, v26 quad_perm:[2,2,2,2] row_mask:0xf bank_mask:0xf
    s_nop 0
    v_add_f32_dpp v244, v25, v244 quad_perm:[1,1,1,1] row_mask:0xf bank_mask:0xf
    v_add_f32_dpp v9, v27, v9 quad_perm:[3,3,3,3] row_mask:0xf bank_mask:0xf
    v_add_f32 v244, v244, v9
    v_cvt_pk_bf16_f32 v244, v244, v244
    v_and_b32 v244, 0xffff0000, v244
    v_mul_f32 v244, 0x3db504f3, v244
    v_cvt_pk_bf16_f32 v244, v244, v244
    v_and_b32 v244, 0xffff0000, v244
    v_max_f32 v14, v14, v244
    s_waitcnt vmcnt(6)
    v_mfma_f32_16x16x32_bf16 v[28:31], v[208:211], v[48:51], v[28:31]
    buffer_load_dwordx4 v[76:79], v6, s[36:39], s68 offen nt
    s_addk_i32 s68, 14336
    s_waitcnt vmcnt(6)
    v_mfma_f32_16x16x32_bf16 v[28:31], v[212:215], v[52:55], v[28:31]
    s_bitcmp0_b32 s97, 0
    s_cbranch_scc0 L_de126
    s_waitcnt vmcnt(5)
L_de126:
    buffer_load_dwordx4 v[80:83], v6, s[36:39], s68 offen nt
    s_addk_i32 s68, 14336
    s_waitcnt vmcnt(6)
    v_mfma_f32_16x16x32_bf16 v[24:27], v[56:59], v[40:43], 0
    buffer_load_dwordx4 v[84:87], v6, s[36:39], s68 offen nt
    s_addk_i32 s68, 14336
    s_waitcnt vmcnt(6)
    v_mfma_f32_16x16x32_bf16 v[24:27], v[60:63], v[44:47], v[24:27]
    s_bitcmp0_b32 s97, 0
    s_cbranch_scc0 L_de128
    s_waitcnt vmcnt(5)
L_de128:
    buffer_load_dwordx4 v[88:91], v6, s[36:39], s68 offen nt
    s_addk_i32 s68, 14336
    v_mov_b32_dpp v245, v28 quad_perm:[0,0,0,0] row_mask:0xf bank_mask:0xf
    v_mov_b32_dpp v9, v30 quad_perm:[2,2,2,2] row_mask:0xf bank_mask:0xf
    s_nop 0
    v_add_f32_dpp v245, v29, v245 quad_perm:[1,1,1,1] row_mask:0xf bank_mask:0xf
    v_add_f32_dpp v9, v31, v9 quad_perm:[3,3,3,3] row_mask:0xf bank_mask:0xf
    v_add_f32 v245, v245, v9
    v_cvt_pk_bf16_f32 v245, v245, v245
    v_and_b32 v245, 0xffff0000, v245
    v_mul_f32 v245, 0x3db504f3, v245
    v_cvt_pk_bf16_f32 v245, v245, v245
    v_and_b32 v245, 0xffff0000, v245
    v_max_f32 v14, v14, v245
    s_waitcnt vmcnt(6)
    v_mfma_f32_16x16x32_bf16 v[24:27], v[64:67], v[48:51], v[24:27]
    buffer_load_dwordx4 v[92:95], v6, s[36:39], s68 offen nt
    s_addk_i32 s68, 14336
    s_waitcnt vmcnt(6)
    v_mfma_f32_16x16x32_bf16 v[24:27], v[68:71], v[52:55], v[24:27]
    s_bitcmp0_b32 s97, 0
    s_cbranch_scc0 L_de130
    s_waitcnt vmcnt(5)
L_de130:
    buffer_load_dwordx4 v[96:99], v6, s[36:39], s68 offen nt
    s_addk_i32 s68, 14336
    s_waitcnt vmcnt(6)
    v_mfma_f32_16x16x32_bf16 v[28:31], v[72:75], v[40:43], 0
    buffer_load_dwordx4 v[100:103], v6, s[36:39], s68 offen nt
    s_addk_i32 s68, 14336
    s_waitcnt vmcnt(6)
    v_mfma_f32_16x16x32_bf16 v[28:31], v[76:79], v[44:47], v[28:31]
    s_bitcmp0_b32 s97, 0
    s_cbranch_scc0 L_de132
    s_waitcnt vmcnt(5)
L_de132:
    buffer_load_dwordx4 v[104:107], v6, s[36:39], s68 offen nt
    s_addk_i32 s68, 14336
    v_mov_b32_dpp v246, v24 quad_perm:[0,0,0,0] row_mask:0xf bank_mask:0xf
    v_mov_b32_dpp v9, v26 quad_perm:[2,2,2,2] row_mask:0xf bank_mask:0xf
    s_nop 0
    v_add_f32_dpp v246, v25, v246 quad_perm:[1,1,1,1] row_mask:0xf bank_mask:0xf
    v_add_f32_dpp v9, v27, v9 quad_perm:[3,3,3,3] row_mask:0xf bank_mask:0xf
    v_add_f32 v246, v246, v9
    v_cvt_pk_bf16_f32 v246, v246, v246
    v_and_b32 v246, 0xffff0000, v246
    v_mul_f32 v246, 0x3db504f3, v246
    v_cvt_pk_bf16_f32 v246, v246, v246
    v_and_b32 v246, 0xffff0000, v246
    v_max_f32 v14, v14, v246
    s_waitcnt vmcnt(6)
    v_mfma_f32_16x16x32_bf16 v[28:31], v[80:83], v[48:51], v[28:31]
    buffer_load_dwordx4 v[108:111], v6, s[36:39], s68 offen nt
    s_addk_i32 s68, 14336
    s_waitcnt vmcnt(6)
    v_mfma_f32_16x16x32_bf16 v[28:31], v[84:87], v[52:55], v[28:31]
    s_bitcmp0_b32 s97, 0
    s_cbranch_scc0 L_de134
    s_waitcnt vmcnt(5)
L_de134:
    buffer_load_dwordx4 v[112:115], v6, s[36:39], s68 offen nt
    s_addk_i32 s68, 14336
    s_waitcnt vmcnt(6)
    v_mfma_f32_16x16x32_bf16 v[24:27], v[88:91], v[40:43], 0
    buffer_load_dwordx4 v[116:119], v6, s[36:39], s68 offen nt
    s_addk_i32 s68, 14336
    s_waitcnt vmcnt(6)
    v_mfma_f32_16x16x32_bf16 v[24:27], v[92:95], v[44:47], v[24:27]
    s_bitcmp0_b32 s97, 0
    s_cbranch_scc0 L_de136
    s_waitcnt vmcnt(5)
L_de136:
    buffer_load_dwordx4 v[120:123], v6, s[36:39], s68 offen nt
    s_addk_i32 s68, 14336
    v_mov_b32_dpp v247, v28 quad_perm:[0,0,0,0] row_mask:0xf bank_mask:0xf
    v_mov_b32_dpp v9, v30 quad_perm:[2,2,2,2] row_mask:0xf bank_mask:0xf
    s_nop 0
    v_add_f32_dpp v247, v29, v247 quad_perm:[1,1,1,1] row_mask:0xf bank_mask:0xf
    v_add_f32_dpp v9, v31, v9 quad_perm:[3,3,3,3] row_mask:0xf bank_mask:0xf
    v_add_f32 v247, v247, v9
    v_cvt_pk_bf16_f32 v247, v247, v247
    v_and_b32 v247, 0xffff0000, v247
    v_mul_f32 v247, 0x3db504f3, v247
    v_cvt_pk_bf16_f32 v247, v247, v247
    v_and_b32 v247, 0xffff0000, v247
    v_max_f32 v14, v14, v247
    s_waitcnt vmcnt(6)
    v_mfma_f32_16x16x32_bf16 v[24:27], v[96:99], v[48:51], v[24:27]
    buffer_load_dwordx4 v[124:127], v6, s[36:39], s68 offen nt
    s_addk_i32 s68, 14336
    s_waitcnt vmcnt(6)
    v_mfma_f32_16x16x32_bf16 v[24:27], v[100:103], v[52:55], v[24:27]
    s_bitcmp0_b32 s97, 0
    s_cbranch_scc0 L_de138
    s_waitcnt vmcnt(5)
L_de138:
    buffer_load_dwordx4 v[128:131], v6, s[36:39], s68 offen nt
    s_addk_i32 s68, 14336
    s_waitcnt vmcnt(6)
    v_mfma_f32_16x16x32_bf16 v[28:31], v[104:107], v[40:43], 0
    buffer_load_dwordx4 v[132:135], v6, s[36:39], s68 offen nt
    s_addk_i32 s68, 14336
    s_waitcnt vmcnt(6)
    v_mfma_f32_16x16x32_bf16 v[28:31], v[108:111], v[44:47], v[28:31]
    s_bitcmp0_b32 s97, 0
    s_cbranch_scc0 L_de140
    s_waitcnt vmcnt(5)
L_de140:
    buffer_load_dwordx4 v[136:139], v6, s[36:39], s68 offen nt
    s_addk_i32 s68, 14336
    v_mov_b32_dpp v248, v24 quad_perm:[0,0,0,0] row_mask:0xf bank_mask:0xf
    v_mov_b32_dpp v9, v26 quad_perm:[2,2,2,2] row_mask:0xf bank_mask:0xf
    s_nop 0
    v_add_f32_dpp v248, v25, v248 quad_perm:[1,1,1,1] row_mask:0xf bank_mask:0xf
    v_add_f32_dpp v9, v27, v9 quad_perm:[3,3,3,3] row_mask:0xf bank_mask:0xf
    v_add_f32 v248, v248, v9
    v_cvt_pk_bf16_f32 v248, v248, v248
    v_and_b32 v248, 0xffff0000, v248
    v_mul_f32 v248, 0x3db504f3, v248
    v_cvt_pk_bf16_f32 v248, v248, v248
    v_and_b32 v248, 0xffff0000, v248
    v_max_f32 v14, v14, v248
    s_waitcnt vmcnt(6)
    v_mfma_f32_16x16x32_bf16 v[28:31], v[112:115], v[48:51], v[28:31]
    buffer_load_dwordx4 v[140:143], v6, s[36:39], s68 offen nt
    s_addk_i32 s68, 14336
    s_waitcnt vmcnt(6)
    v_mfma_f32_16x16x32_bf16 v[28:31], v[116:119], v[52:55], v[28:31]
    s_bitcmp0_b32 s97, 0
    s_cbranch_scc0 L_de142
    s_waitcnt vmcnt(5)
L_de142:
    buffer_load_dwordx4 v[144:147], v6, s[36:39], s68 offen nt
    s_addk_i32 s68, 14336
    s_waitcnt vmcnt(6)
    v_mfma_f32_16x16x32_bf16 v[24:27], v[120:123], v[40:43], 0
    buffer_load_dwordx4 v[148:151], v6, s[36:39], s68 offen nt
    s_addk_i32 s68, 14336
    s_waitcnt vmcnt(6)
    v_mfma_f32_16x16x32_bf16 v[24:27], v[124:127], v[44:47], v[24:27]
    s_bitcmp0_b32 s97, 0
    s_cbranch_scc0 L_de144
    s_waitcnt vmcnt(5)
L_de144:
    buffer_load_dwordx4 v[152:155], v6, s[36:39], s68 offen nt
    s_addk_i32 s68, 14336
    v_mov_b32_dpp v249, v28 quad_perm:[0,0,0,0] row_mask:0xf bank_mask:0xf
    v_mov_b32_dpp v9, v30 quad_perm:[2,2,2,2] row_mask:0xf bank_mask:0xf
    s_nop 0
    v_add_f32_dpp v249, v29, v249 quad_perm:[1,1,1,1] row_mask:0xf bank_mask:0xf
    v_add_f32_dpp v9, v31, v9 quad_perm:[3,3,3,3] row_mask:0xf bank_mask:0xf
    v_add_f32 v249, v249, v9
    v_cvt_pk_bf16_f32 v249, v249, v249
    v_and_b32 v249, 0xffff0000, v249
    v_mul_f32 v249, 0x3db504f3, v249
    v_cvt_pk_bf16_f32 v249, v249, v249
    v_and_b32 v249, 0xffff0000, v249
    v_max_f32 v14, v14, v249
    s_waitcnt vmcnt(6)
    v_mfma_f32_16x16x32_bf16 v[24:27], v[128:131], v[48:51], v[24:27]
    buffer_load_dwordx4 v[156:159], v6, s[36:39], s68 offen nt
    s_addk_i32 s68, 14336
    s_waitcnt vmcnt(6)
    v_mfma_f32_16x16x32_bf16 v[24:27], v[132:135], v[52:55], v[24:27]
    s_bitcmp0_b32 s97, 0
    s_cbranch_scc0 L_de146
    s_waitcnt vmcnt(5)
L_de146:
    buffer_load_dwordx4 v[160:163], v6, s[36:39], s68 offen nt
    s_addk_i32 s68, 14336
    s_waitcnt vmcnt(6)
    v_mfma_f32_16x16x32_bf16 v[28:31], v[136:139], v[40:43], 0
    buffer_load_dwordx4 v[164:167], v7, s[40:43], s69 offen nt
    s_addk_i32 s69, 14336
    s_waitcnt vmcnt(6)
    v_mfma_f32_16x16x32_bf16 v[28:31], v[140:143], v[44:47], v[28:31]
    s_bitcmp0_b32 s97, 0
    s_cbranch_scc0 L_de148
    s_waitcnt vmcnt(5)
L_de148:
    buffer_load_dwordx4 v[168:171], v7, s[40:43], s69 offen nt
    s_addk_i32 s69, 14336
    v_mov_b32_dpp v250, v24 quad_perm:[0,0,0,0] row_mask:0xf bank_mask:0xf
    v_mov_b32_dpp v9, v26 quad_perm:[2,2,2,2] row_mask:0xf bank_mask:0xf
    s_nop 0
    v_add_f32_dpp v250, v25, v250 quad_perm:[1,1,1,1] row_mask:0xf bank_mask:0xf
    v_add_f32_dpp v9, v27, v9 quad_perm:[3,3,3,3] row_mask:0xf bank_mask:0xf
    v_add_f32 v250, v250, v9
    v_cvt_pk_bf16_f32 v250, v250, v250
    v_and_b32 v250, 0xffff0000, v250
    v_mul_f32 v250, 0x3db504f3, v250
    v_cvt_pk_bf16_f32 v250, v250, v250
    v_and_b32 v250, 0xffff0000, v250
    v_max_f32 v14, v14, v250
    s_waitcnt vmcnt(6)
    v_mfma_f32_16x16x32_bf16 v[28:31], v[144:147], v[48:51], v[28:31]
    buffer_load_dwordx4 v[172:175], v7, s[40:43], s69 offen nt
    s_addk_i32 s69, 14336
    s_waitcnt vmcnt(6)
    v_mfma_f32_16x16x32_bf16 v[28:31], v[148:151], v[52:55], v[28:31]
    s_bitcmp0_b32 s97, 0
    s_cbranch_scc0 L_de150
    s_waitcnt vmcnt(5)
L_de150:
    buffer_load_dwordx4 v[176:179], v7, s[40:43], s69 offen nt
    s_addk_i32 s69, 14336
    s_waitcnt vmcnt(6)
    v_mfma_f32_16x16x32_bf16 v[24:27], v[152:155], v[40:43], 0
    buffer_load_dwordx4 v[180:183], v7, s[40:43], s69 offen nt
    s_addk_i32 s69, 14336
    s_waitcnt vmcnt(6)
    v_mfma_f32_16x16x32_bf16 v[24:27], v[156:159], v[44:47], v[24:27]
    s_bitcmp0_b32 s97, 0
    s_cbranch_scc0 L_de152
    s_waitcnt vmcnt(5)
L_de152:
    buffer_load_dwordx4 v[184:187], v7, s[40:43], s69 offen nt
    s_addk_i32 s69, 14336
    v_mov_b32_dpp v251, v28 quad_perm:[0,0,0,0] row_mask:0xf bank_mask:0xf
    v_mov_b32_dpp v9, v30 quad_perm:[2,2,2,2] row_mask:0xf bank_mask:0xf
    s_nop 0
    v_add_f32_dpp v251, v29, v251 quad_perm:[1,1,1,1] row_mask:0xf bank_mask:0xf
    v_add_f32_dpp v9, v31, v9 quad_perm:[3,3,3,3] row_mask:0xf bank_mask:0xf
    v_add_f32 v251, v251, v9
    v_cvt_pk_bf16_f32 v251, v251, v251
    v_and_b32 v251, 0xffff0000, v251
    v_mul_f32 v251, 0x3db504f3, v251
    v_cvt_pk_bf16_f32 v251, v251, v251
    v_and_b32 v251, 0xffff0000, v251
    v_max_f32 v14, v14, v251
    s_waitcnt vmcnt(6)
    v_mfma_f32_16x16x32_bf16 v[24:27], v[160:163], v[48:51], v[24:27]
    buffer_load_dwordx4 v[188:191], v7, s[40:43], s69 offen nt
    s_addk_i32 s69, 14336
    s_bitcmp0_b32 s97, 0
    s_cbranch_scc0 L_de154
    s_waitcnt vmcnt(5)
L_de154:
    buffer_load_dwordx4 v[192:195], v7, s[40:43], s69 offen nt
    s_addk_i32 s69, 14336
    buffer_load_dwordx4 v[196:199], v7, s[40:43], s69 offen nt
    s_addk_i32 s69, 14336
    s_bitcmp0_b32 s97, 0
    s_cbranch_scc0 L_de156
    s_waitcnt vmcnt(5)
L_de156:
    buffer_load_dwordx4 v[200:203], v7, s[40:43], s69 offen nt
    s_addk_i32 s69, 14336
    v_mov_b32_dpp v252, v24 quad_perm:[0,0,0,0] row_mask:0xf bank_mask:0xf
    v_mov_b32_dpp v9, v26 quad_perm:[2,2,2,2] row_mask:0xf bank_mask:0xf
    s_nop 0
    v_add_f32_dpp v252, v25, v252 quad_perm:[1,1,1,1] row_mask:0xf bank_mask:0xf
    v_add_f32_dpp v9, v27, v9 quad_perm:[3,3,3,3] row_mask:0xf bank_mask:0xf
    v_add_f32 v252, v252, v9
    v_cvt_pk_bf16_f32 v252, v252, v252
    v_and_b32 v252, 0xffff0000, v252
    v_mul_f32 v252, 0x3db504f3, v252
    v_cvt_pk_bf16_f32 v252, v252, v252
    v_and_b32 v252, 0xffff0000, v252
    s_add_u32 s34, s71, 2016
    v_mul_u32_u24 v4, 14, v13
    v_add_u32 v4, s34, v4
    s_movk_i32 s71, 2048
    v_cmp_gt_u32 vcc, s71, v4
    v_mov_b32 v5, 0xff800000
    s_nop 0
    v_cndmask_b32 v252, v5, v252, vcc
    v_max_f32 v14, v14, v252
    s_nop 1
    v_max_f32_dpp v14, v14, v14 row_ror:8 row_mask:0xf bank_mask:0xf
    s_nop 1
    v_max_f32_dpp v14, v14, v14 row_ror:4 row_mask:0xf bank_mask:0xf
    s_nop 1
    v_max_f32_dpp v14, v14, v14 row_bcast:15 row_mask:0xa bank_mask:0xf
    s_nop 1
    v_max_f32_dpp v14, v14, v14 row_bcast:31 row_mask:0xc bank_mask:0xf
    v_mul_f32 v14, v14, v8
    s_nop 0
    v_readlane_b32 s75, v14, 63
    s_nop 1
    v_fma_f32 v216, v216, v8, -s75
    v_exp_f32 v216, v216
    s_nop 0
    v_mov_b32 v15, v216
    v_cvt_pk_bf16_f32 v216, v216, v216
    s_nop 1
    v_and_b32_dpp v36, v216, v16 row_newbcast:0 row_mask:0xf bank_mask:0xf
    v_and_b32_dpp v37, v216, v17 row_newbcast:0 row_mask:0xf bank_mask:0xf
    v_and_b32_dpp v38, v216, v18 row_newbcast:0 row_mask:0xf bank_mask:0xf
    v_and_b32_dpp v39, v216, v19 row_newbcast:0 row_mask:0xf bank_mask:0xf
    s_waitcnt vmcnt(9)
    s_nop 0
    v_mfma_f32_16x16x32_bf16 v[20:23], v[36:39], v[164:167], 0
    v_fma_f32 v217, v217, v8, -s75
    v_exp_f32 v217, v217
    s_nop 0
    v_add_f32 v15, v15, v217
    v_cvt_pk_bf16_f32 v217, v217, v217
    v_and_b32_dpp v32, v216, v16 row_newbcast:4 row_mask:0xf bank_mask:0xf
    v_and_b32_dpp v33, v216, v17 row_newbcast:4 row_mask:0xf bank_mask:0xf
    v_and_b32_dpp v34, v216, v18 row_newbcast:4 row_mask:0xf bank_mask:0xf
    v_and_b32_dpp v35, v216, v19 row_newbcast:4 row_mask:0xf bank_mask:0xf
    s_waitcnt vmcnt(8)
    s_nop 0
    v_mfma_f32_16x16x32_bf16 v[20:23], v[32:35], v[168:171], v[20:23]
    v_fma_f32 v218, v218, v8, -s75
    v_exp_f32 v218, v218
    s_nop 0
    v_add_f32 v15, v15, v218
    v_cvt_pk_bf16_f32 v218, v218, v218
    v_and_b32_dpp v36, v216, v16 row_newbcast:8 row_mask:0xf bank_mask:0xf
    v_and_b32_dpp v37, v216, v17 row_newbcast:8 row_mask:0xf bank_mask:0xf
    v_and_b32_dpp v38, v216, v18 row_newbcast:8 row_mask:0xf bank_mask:0xf
    v_and_b32_dpp v39, v216, v19 row_newbcast:8 row_mask:0xf bank_mask:0xf
    s_waitcnt vmcnt(7)
    s_nop 0
    v_mfma_f32_16x16x32_bf16 v[20:23], v[36:39], v[172:175], v[20:23]
    v_fma_f32 v219, v219, v8, -s75
    v_exp_f32 v219, v219
    s_nop 0
    v_add_f32 v15, v15, v219
    v_cvt_pk_bf16_f32 v219, v219, v219
    v_and_b32_dpp v32, v216, v16 row_newbcast:12 row_mask:0xf bank_mask:0xf
    v_and_b32_dpp v33, v216, v17 row_newbcast:12 row_mask:0xf bank_mask:0xf
    v_and_b32_dpp v34, v216, v18 row_newbcast:12 row_mask:0xf bank_mask:0xf
    v_and_b32_dpp v35, v216, v19 row_newbcast:12 row_mask:0xf bank_mask:0xf
    s_waitcnt vmcnt(6)
    s_nop 0
    v_mfma_f32_16x16x32_bf16 v[20:23], v[32:35], v[176:179], v[20:23]
    buffer_load_dwordx4 v[204:207], v7, s[40:43], s69 offen nt
    s_addk_i32 s69, 14336
    v_fma_f32 v220, v220, v8, -s75
    v_exp_f32 v220, v220
    s_nop 0
    v_add_f32 v15, v15, v220
    v_cvt_pk_bf16_f32 v220, v220, v220
    v_and_b32_dpp v36, v217, v16 row_newbcast:0 row_mask:0xf bank_mask:0xf
    v_and_b32_dpp v37, v217, v17 row_newbcast:0 row_mask:0xf bank_mask:0xf
    v_and_b32_dpp v38, v217, v18 row_newbcast:0 row_mask:0xf bank_mask:0xf
    v_and_b32_dpp v39, v217, v19 row_newbcast:0 row_mask:0xf bank_mask:0xf
    s_waitcnt vmcnt(6)
    s_nop 0
    v_mfma_f32_16x16x32_bf16 v[20:23], v[36:39], v[180:183], v[20:23]
    s_bitcmp0_b32 s97, 0
    s_cbranch_scc0 L_de158
    s_waitcnt vmcnt(5)
L_de158:
    buffer_load_dwordx4 v[208:211], v7, s[40:43], s69 offen nt
    s_addk_i32 s69, 14336
    v_fma_f32 v221, v221, v8, -s75
    v_exp_f32 v221, v221
    s_nop 0
    v_add_f32 v15, v15, v221
    v_cvt_pk_bf16_f32 v221, v221, v221
    v_and_b32_dpp v32, v217, v16 row_newbcast:4 row_mask:0xf bank_mask:0xf
    v_and_b32_dpp v33, v217, v17 row_newbcast:4 row_mask:0xf bank_mask:0xf
    v_and_b32_dpp v34, v217, v18 row_newbcast:4 row_mask:0xf bank_mask:0xf
    v_and_b32_dpp v35, v217, v19 row_newbcast:4 row_mask:0xf bank_mask:0xf
    s_waitcnt vmcnt(6)
    s_nop 0
    v_mfma_f32_16x16x32_bf16 v[20:23], v[32:35], v[184:187], v[20:23]
    buffer_load_dwordx4 v[212:215], v7, s[40:43], s69 offen nt
    s_addk_i32 s69, 14336
    v_fma_f32 v222, v222, v8, -s75
    v_exp_f32 v222, v222
    s_nop 0
    v_add_f32 v15, v15, v222
    v_cvt_pk_bf16_f32 v222, v222, v222
    v_and_b32_dpp v36, v217, v16 row_newbcast:8 row_mask:0xf bank_mask:0xf
    v_and_b32_dpp v37, v217, v17 row_newbcast:8 row_mask:0xf bank_mask:0xf
    v_and_b32_dpp v38, v217, v18 row_newbcast:8 row_mask:0xf bank_mask:0xf
    v_and_b32_dpp v39, v217, v19 row_newbcast:8 row_mask:0xf bank_mask:0xf
    s_waitcnt vmcnt(6)
    s_nop 0
    v_mfma_f32_16x16x32_bf16 v[20:23], v[36:39], v[188:191], v[20:23]
    s_bitcmp0_b32 s97, 0
    s_cbranch_scc0 L_de160
    s_waitcnt vmcnt(5)
L_de160:
    buffer_load_dwordx4 v[56:59], v7, s[40:43], s69 offen nt
    s_addk_i32 s69, 14336
    v_fma_f32 v223, v223, v8, -s75
    v_exp_f32 v223, v223
    s_nop 0
    v_add_f32 v15, v15, v223
    v_cvt_pk_bf16_f32 v223, v223, v223
    v_and_b32_dpp v32, v217, v16 row_newbcast:12 row_mask:0xf bank_mask:0xf
    v_and_b32_dpp v33, v217, v17 row_newbcast:12 row_mask:0xf bank_mask:0xf
    v_and_b32_dpp v34, v217, v18 row_newbcast:12 row_mask:0xf bank_mask:0xf
    v_and_b32_dpp v35, v217, v19 row_newbcast:12 row_mask:0xf bank_mask:0xf
    s_waitcnt vmcnt(6)
    s_nop 0
    v_mfma_f32_16x16x32_bf16 v[20:23], v[32:35], v[192:195], v[20:23]
    buffer_load_dwordx4 v[60:63], v7, s[40:43], s69 offen nt
    s_addk_i32 s69, 14336
    v_fma_f32 v224, v224, v8, -s75
    v_exp_f32 v224, v224
    s_nop 0
    v_add_f32 v15, v15, v224
    v_cvt_pk_bf16_f32 v224, v224, v224
    v_and_b32_dpp v36, v218, v16 row_newbcast:0 row_mask:0xf bank_mask:0xf
    v_and_b32_dpp v37, v218, v17 row_newbcast:0 row_mask:0xf bank_mask:0xf
    v_and_b32_dpp v38, v218, v18 row_newbcast:0 row_mask:0xf bank_mask:0xf
    v_and_b32_dpp v39, v218, v19 row_newbcast:0 row_mask:0xf bank_mask:0xf
    s_waitcnt vmcnt(6)
    s_nop 0
    v_mfma_f32_16x16x32_bf16 v[20:23], v[36:39], v[196:199], v[20:23]
    s_bitcmp0_b32 s97, 0
    s_cbranch_scc0 L_de162
    s_waitcnt vmcnt(5)
L_de162:
    buffer_load_dwordx4 v[64:67], v7, s[40:43], s69 offen nt
    s_addk_i32 s69, 14336
    v_fma_f32 v225, v225, v8, -s75
    v_exp_f32 v225, v225
    s_nop 0
    v_add_f32 v15, v15, v225
    v_cvt_pk_bf16_f32 v225, v225, v225
    v_and_b32_dpp v32, v218, v16 row_newbcast:4 row_mask:0xf bank_mask:0xf
    v_and_b32_dpp v33, v218, v17 row_newbcast:4 row_mask:0xf bank_mask:0xf
    v_and_b32_dpp v34, v218, v18 row_newbcast:4 row_mask:0xf bank_mask:0xf
    v_and_b32_dpp v35, v218, v19 row_newbcast:4 row_mask:0xf bank_mask:0xf
    s_waitcnt vmcnt(6)
    s_nop 0
    v_mfma_f32_16x16x32_bf16 v[20:23], v[32:35], v[200:203], v[20:23]
    buffer_load_dwordx4 v[68:71], v7, s[40:43], s69 offen nt
    s_addk_i32 s69, 14336
    v_fma_f32 v226, v226, v8, -s75
    v_exp_f32 v226, v226
    s_nop 0
    v_add_f32 v15, v15, v226
    v_cvt_pk_bf16_f32 v226, v226, v226
    v_and_b32_dpp v36, v218, v16 row_newbcast:8 row_mask:0xf bank_mask:0xf
    v_and_b32_dpp v37, v218, v17 row_newbcast:8 row_mask:0xf bank_mask:0xf
    v_and_b32_dpp v38, v218, v18 row_newbcast:8 row_mask:0xf bank_mask:0xf
    v_and_b32_dpp v39, v218, v19 row_newbcast:8 row_mask:0xf bank_mask:0xf
    s_waitcnt vmcnt(6)
    s_nop 0
    v_mfma_f32_16x16x32_bf16 v[20:23], v[36:39], v[204:207], v[20:23]
    s_bitcmp0_b32 s97, 0
    s_cbranch_scc0 L_de164
    s_waitcnt vmcnt(5)
L_de164:
    buffer_load_dwordx4 v[72:75], v7, s[40:43], s69 offen nt
    s_addk_i32 s69, 14336
    v_fma_f32 v227, v227, v8, -s75
    v_exp_f32 v227, v227
    s_nop 0
    v_add_f32 v15, v15, v227
    v_cvt_pk_bf16_f32 v227, v227, v227
    v_and_b32_dpp v32, v218, v16 row_newbcast:12 row_mask:0xf bank_mask:0xf
    v_and_b32_dpp v33, v218, v17 row_newbcast:12 row_mask:0xf bank_mask:0xf
    v_and_b32_dpp v34, v218, v18 row_newbcast:12 row_mask:0xf bank_mask:0xf
    v_and_b32_dpp v35, v218, v19 row_newbcast:12 row_mask:0xf bank_mask:0xf
    s_waitcnt vmcnt(6)
    s_nop 0
    v_mfma_f32_16x16x32_bf16 v[20:23], v[32:35], v[208:211], v[20:23]
    buffer_load_dwordx4 v[76:79], v7, s[40:43], s69 offen nt
    s_addk_i32 s69, 14336
    v_fma_f32 v228, v228, v8, -s75
    v_exp_f32 v228, v228
    s_nop 0
    v_add_f32 v15, v15, v228
    v_cvt_pk_bf16_f32 v228, v228, v228
    v_and_b32_dpp v36, v219, v16 row_newbcast:0 row_mask:0xf bank_mask:0xf
    v_and_b32_dpp v37, v219, v17 row_newbcast:0 row_mask:0xf bank_mask:0xf
    v_and_b32_dpp v38, v219, v18 row_newbcast:0 row_mask:0xf bank_mask:0xf
    v_and_b32_dpp v39, v219, v19 row_newbcast:0 row_mask:0xf bank_mask:0xf
    s_waitcnt vmcnt(6)
    s_nop 0
    v_mfma_f32_16x16x32_bf16 v[20:23], v[36:39], v[212:215], v[20:23]
    s_bitcmp0_b32 s97, 0
    s_cbranch_scc0 L_de166
    s_waitcnt vmcnt(5)
L_de166:
    buffer_load_dwordx4 v[80:83], v7, s[40:43], s69 offen nt
    s_addk_i32 s69, 14336
    v_fma_f32 v229, v229, v8, -s75
    v_exp_f32 v229, v229
    s_nop 0
    v_add_f32 v15, v15, v229
    v_cvt_pk_bf16_f32 v229, v229, v229
    v_and_b32_dpp v32, v219, v16 row_newbcast:4 row_mask:0xf bank_mask:0xf
    v_and_b32_dpp v33, v219, v17 row_newbcast:4 row_mask:0xf bank_mask:0xf
    v_and_b32_dpp v34, v219, v18 row_newbcast:4 row_mask:0xf bank_mask:0xf
    v_and_b32_dpp v35, v219, v19 row_newbcast:4 row_mask:0xf bank_mask:0xf
    s_waitcnt vmcnt(6)
    s_nop 0
    v_mfma_f32_16x16x32_bf16 v[20:23], v[32:35], v[56:59], v[20:23]
    buffer_load_dwordx4 v[84:87], v7, s[40:43], s69 offen nt
    s_addk_i32 s69, 14336
    v_fma_f32 v230, v230, v8, -s75
    v_exp_f32 v230, v230
    s_nop 0
    v_add_f32 v15, v15, v230
    v_cvt_pk_bf16_f32 v230, v230, v230
    v_and_b32_dpp v36, v219, v16 row_newbcast:8 row_mask:0xf bank_mask:0xf
    v_and_b32_dpp v37, v219, v17 row_newbcast:8 row_mask:0xf bank_mask:0xf
    v_and_b32_dpp v38, v219, v18 row_newbcast:8 row_mask:0xf bank_mask:0xf
    v_and_b32_dpp v39, v219, v19 row_newbcast:8 row_mask:0xf bank_mask:0xf
    s_waitcnt vmcnt(6)
    s_nop 0
    v_mfma_f32_16x16x32_bf16 v[20:23], v[36:39], v[60:63], v[20:23]
    s_bitcmp0_b32 s97, 0
    s_cbranch_scc0 L_de168
    s_waitcnt vmcnt(5)
L_de168:
    buffer_load_dwordx4 v[88:91], v7, s[40:43], s69 offen nt
    s_addk_i32 s69, 14336
    v_fma_f32 v231, v231, v8, -s75
    v_exp_f32 v231, v231
    s_nop 0
    v_add_f32 v15, v15, v231
    v_cvt_pk_bf16_f32 v231, v231, v231
    v_and_b32_dpp v32, v219, v16 row_newbcast:12 row_mask:0xf bank_mask:0xf
    v_and_b32_dpp v33, v219, v17 row_newbcast:12 row_mask:0xf bank_mask:0xf
    v_and_b32_dpp v34, v219, v18 row_newbcast:12 row_mask:0xf bank_mask:0xf
    v_and_b32_dpp v35, v219, v19 row_newbcast:12 row_mask:0xf bank_mask:0xf
    s_waitcnt vmcnt(6)
    s_nop 0
    v_mfma_f32_16x16x32_bf16 v[20:23], v[32:35], v[64:67], v[20:23]
    buffer_load_dwordx4 v[92:95], v7, s[40:43], s69 offen nt
    s_addk_i32 s69, 14336
    v_fma_f32 v232, v232, v8, -s75
    v_exp_f32 v232, v232
    s_nop 0
    v_add_f32 v15, v15, v232
    v_cvt_pk_bf16_f32 v232, v232, v232
    v_and_b32_dpp v36, v220, v16 row_newbcast:0 row_mask:0xf bank_mask:0xf
    v_and_b32_dpp v37, v220, v17 row_newbcast:0 row_mask:0xf bank_mask:0xf
    v_and_b32_dpp v38, v220, v18 row_newbcast:0 row_mask:0xf bank_mask:0xf
    v_and_b32_dpp v39, v220, v19 row_newbcast:0 row_mask:0xf bank_mask:0xf
    s_waitcnt vmcnt(6)
    s_nop 0
    v_mfma_f32_16x16x32_bf16 v[20:23], v[36:39], v[68:71], v[20:23]
    s_bitcmp0_b32 s97, 0
    s_cbranch_scc0 L_de170
    s_waitcnt vmcnt(5)
L_de170:
    buffer_load_dwordx4 v[96:99], v7, s[40:43], s69 offen nt
    s_addk_i32 s69, 14336
    v_fma_f32 v233, v233, v8, -s75
    v_exp_f32 v233, v233
    s_nop 0
    v_add_f32 v15, v15, v233
    v_cvt_pk_bf16_f32 v233, v233, v233
    v_and_b32_dpp v32, v220, v16 row_newbcast:4 row_mask:0xf bank_mask:0xf
    v_and_b32_dpp v33, v220, v17 row_newbcast:4 row_mask:0xf bank_mask:0xf
    v_and_b32_dpp v34, v220, v18 row_newbcast:4 row_mask:0xf bank_mask:0xf
    v_and_b32_dpp v35, v220, v19 row_newbcast:4 row_mask:0xf bank_mask:0xf
    s_waitcnt vmcnt(6)
    s_nop 0
    v_mfma_f32_16x16x32_bf16 v[20:23], v[32:35], v[72:75], v[20:23]
    buffer_load_dwordx4 v[100:103], v7, s[40:43], s69 offen nt
    s_addk_i32 s69, 14336
    v_fma_f32 v234, v234, v8, -s75
    v_exp_f32 v234, v234
    s_nop 0
    v_add_f32 v15, v15, v234
    v_cvt_pk_bf16_f32 v234, v234, v234
    v_and_b32_dpp v36, v220, v16 row_newbcast:8 row_mask:0xf bank_mask:0xf
    v_and_b32_dpp v37, v220, v17 row_newbcast:8 row_mask:0xf bank_mask:0xf
    v_and_b32_dpp v38, v220, v18 row_newbcast:8 row_mask:0xf bank_mask:0xf
    v_and_b32_dpp v39, v220, v19 row_newbcast:8 row_mask:0xf bank_mask:0xf
    s_waitcnt vmcnt(6)
    s_nop 0
    v_mfma_f32_16x16x32_bf16 v[20:23], v[36:39], v[76:79], v[20:23]
    s_bitcmp0_b32 s97, 0
    s_cbranch_scc0 L_de172
    s_waitcnt vmcnt(5)
L_de172:
    buffer_load_dwordx4 v[104:107], v7, s[40:43], s69 offen nt
    s_addk_i32 s69, 14336
    v_fma_f32 v235, v235, v8, -s75
    v_exp_f32 v235, v235
    s_nop 0
    v_add_f32 v15, v15, v235
    v_cvt_pk_bf16_f32 v235, v235, v235
    v_and_b32_dpp v32, v220, v16 row_newbcast:12 row_mask:0xf bank_mask:0xf
    v_and_b32_dpp v33, v220, v17 row_newbcast:12 row_mask:0xf bank_mask:0xf
    v_and_b32_dpp v34, v220, v18 row_newbcast:12 row_mask:0xf bank_mask:0xf
    v_and_b32_dpp v35, v220, v19 row_newbcast:12 row_mask:0xf bank_mask:0xf
    s_waitcnt vmcnt(6)
    s_nop 0
    v_mfma_f32_16x16x32_bf16 v[20:23], v[32:35], v[80:83], v[20:23]
    buffer_load_dwordx4 v[108:111], v7, s[40:43], s69 offen nt
    s_addk_i32 s69, 14336
    v_fma_f32 v236, v236, v8, -s75
    v_exp_f32 v236, v236
    s_nop 0
    v_add_f32 v15, v15, v236
    v_cvt_pk_bf16_f32 v236, v236, v236
    v_and_b32_dpp v36, v221, v16 row_newbcast:0 row_mask:0xf bank_mask:0xf
    v_and_b32_dpp v37, v221, v17 row_newbcast:0 row_mask:0xf bank_mask:0xf
    v_and_b32_dpp v38, v221, v18 row_newbcast:0 row_mask:0xf bank_mask:0xf
    v_and_b32_dpp v39, v221, v19 row_newbcast:0 row_mask:0xf bank_mask:0xf
    s_waitcnt vmcnt(6)
    s_nop 0
    v_mfma_f32_16x16x32_bf16 v[20:23], v[36:39], v[84:87], v[20:23]
    s_bitcmp0_b32 s97, 0
    s_cbranch_scc0 L_de174
    s_waitcnt vmcnt(5)
L_de174:
    buffer_load_dwordx4 v[112:115], v7, s[40:43], s69 offen nt
    s_addk_i32 s69, 14336
    v_fma_f32 v237, v237, v8, -s75
    v_exp_f32 v237, v237
    s_nop 0
    v_add_f32 v15, v15, v237
    v_cvt_pk_bf16_f32 v237, v237, v237
    v_and_b32_dpp v32, v221, v16 row_newbcast:4 row_mask:0xf bank_mask:0xf
    v_and_b32_dpp v33, v221, v17 row_newbcast:4 row_mask:0xf bank_mask:0xf
    v_and_b32_dpp v34, v221, v18 row_newbcast:4 row_mask:0xf bank_mask:0xf
    v_and_b32_dpp v35, v221, v19 row_newbcast:4 row_mask:0xf bank_mask:0xf
    s_waitcnt vmcnt(6)
    s_nop 0
    v_mfma_f32_16x16x32_bf16 v[20:23], v[32:35], v[88:91], v[20:23]
    buffer_load_dwordx4 v[116:119], v7, s[40:43], s69 offen nt
    s_addk_i32 s69, 14336
    v_fma_f32 v238, v238, v8, -s75
    v_exp_f32 v238, v238
    s_nop 0
    v_add_f32 v15, v15, v238
    v_cvt_pk_bf16_f32 v238, v238, v238
    v_and_b32_dpp v36, v221, v16 row_newbcast:8 row_mask:0xf bank_mask:0xf
    v_and_b32_dpp v37, v221, v17 row_newbcast:8 row_mask:0xf bank_mask:0xf
    v_and_b32_dpp v38, v221, v18 row_newbcast:8 row_mask:0xf bank_mask:0xf
    v_and_b32_dpp v39, v221, v19 row_newbcast:8 row_mask:0xf bank_mask:0xf
    s_waitcnt vmcnt(6)
    s_nop 0
    v_mfma_f32_16x16x32_bf16 v[20:23], v[36:39], v[92:95], v[20:23]
    s_bitcmp0_b32 s97, 0
    s_cbranch_scc0 L_de176
    s_waitcnt vmcnt(5)
L_de176:
    buffer_load_dwordx4 v[120:123], v7, s[40:43], s69 offen nt
    s_addk_i32 s69, 14336
    v_fma_f32 v239, v239, v8, -s75
    v_exp_f32 v239, v239
    s_nop 0
    v_add_f32 v15, v15, v239
    v_cvt_pk_bf16_f32 v239, v239, v239
    v_and_b32_dpp v32, v221, v16 row_newbcast:12 row_mask:0xf bank_mask:0xf
    v_and_b32_dpp v33, v221, v17 row_newbcast:12 row_mask:0xf bank_mask:0xf
    v_and_b32_dpp v34, v221, v18 row_newbcast:12 row_mask:0xf bank_mask:0xf
    v_and_b32_dpp v35, v221, v19 row_newbcast:12 row_mask:0xf bank_mask:0xf
    s_waitcnt vmcnt(6)
    s_nop 0
    v_mfma_f32_16x16x32_bf16 v[20:23], v[32:35], v[96:99], v[20:23]
    buffer_load_dwordx4 v[124:127], v7, s[40:43], s69 offen nt
    s_addk_i32 s69, 14336
    v_fma_f32 v240, v240, v8, -s75
    v_exp_f32 v240, v240
    s_nop 0
    v_add_f32 v15, v15, v240
    v_cvt_pk_bf16_f32 v240, v240, v240
    v_and_b32_dpp v36, v222, v16 row_newbcast:0 row_mask:0xf bank_mask:0xf
    v_and_b32_dpp v37, v222, v17 row_newbcast:0 row_mask:0xf bank_mask:0xf
    v_and_b32_dpp v38, v222, v18 row_newbcast:0 row_mask:0xf bank_mask:0xf
    v_and_b32_dpp v39, v222, v19 row_newbcast:0 row_mask:0xf bank_mask:0xf
    s_waitcnt vmcnt(6)
    s_nop 0
    v_mfma_f32_16x16x32_bf16 v[20:23], v[36:39], v[100:103], v[20:23]
    s_bitcmp0_b32 s97, 0
    s_cbranch_scc0 L_de178
    s_waitcnt vmcnt(5)
L_de178:
    buffer_load_dwordx4 v[128:131], v7, s[40:43], s69 offen nt
    s_addk_i32 s69, 14336
    v_fma_f32 v241, v241, v8, -s75
    v_exp_f32 v241, v241
    s_nop 0
    v_add_f32 v15, v15, v241
    v_cvt_pk_bf16_f32 v241, v241, v241
    v_and_b32_dpp v32, v222, v16 row_newbcast:4 row_mask:0xf bank_mask:0xf
    v_and_b32_dpp v33, v222, v17 row_newbcast:4 row_mask:0xf bank_mask:0xf
    v_and_b32_dpp v34, v222, v18 row_newbcast:4 row_mask:0xf bank_mask:0xf
    v_and_b32_dpp v35, v222, v19 row_newbcast:4 row_mask:0xf bank_mask:0xf
    s_waitcnt vmcnt(6)
    s_nop 0
    v_mfma_f32_16x16x32_bf16 v[20:23], v[32:35], v[104:107], v[20:23]
    buffer_load_dwordx4 v[132:135], v7, s[40:43], s69 offen nt
    s_addk_i32 s69, 14336
    v_fma_f32 v242, v242, v8, -s75
    v_exp_f32 v242, v242
    s_nop 0
    v_add_f32 v15, v15, v242
    v_cvt_pk_bf16_f32 v242, v242, v242
    v_and_b32_dpp v36, v222, v16 row_newbcast:8 row_mask:0xf bank_mask:0xf
    v_and_b32_dpp v37, v222, v17 row_newbcast:8 row_mask:0xf bank_mask:0xf
    v_and_b32_dpp v38, v222, v18 row_newbcast:8 row_mask:0xf bank_mask:0xf
    v_and_b32_dpp v39, v222, v19 row_newbcast:8 row_mask:0xf bank_mask:0xf
    s_waitcnt vmcnt(6)
    s_nop 0
    v_mfma_f32_16x16x32_bf16 v[20:23], v[36:39], v[108:111], v[20:23]
    s_bitcmp0_b32 s97, 0
    s_cbranch_scc0 L_de180
    s_waitcnt vmcnt(5)
L_de180:
    buffer_load_dwordx4 v[136:139], v7, s[40:43], s69 offen nt
    s_addk_i32 s69, 14336
    v_fma_f32 v243, v243, v8, -s75
    v_exp_f32 v243, v243
    s_nop 0
    v_add_f32 v15, v15, v243
    v_cvt_pk_bf16_f32 v243, v243, v243
    v_and_b32_dpp v32, v222, v16 row_newbcast:12 row_mask:0xf bank_mask:0xf
    v_and_b32_dpp v33, v222, v17 row_newbcast:12 row_mask:0xf bank_mask:0xf
    v_and_b32_dpp v34, v222, v18 row_newbcast:12 row_mask:0xf bank_mask:0xf
    v_and_b32_dpp v35, v222, v19 row_newbcast:12 row_mask:0xf bank_mask:0xf
    s_waitcnt vmcnt(6)
    s_nop 0
    v_mfma_f32_16x16x32_bf16 v[20:23], v[32:35], v[112:115], v[20:23]
    buffer_load_dwordx4 v[140:143], v7, s[40:43], s69 offen nt
    s_addk_i32 s69, 14336
    v_fma_f32 v244, v244, v8, -s75
    v_exp_f32 v244, v244
    s_nop 0
    v_add_f32 v15, v15, v244
    v_cvt_pk_bf16_f32 v244, v244, v244
    v_and_b32_dpp v36, v223, v16 row_newbcast:0 row_mask:0xf bank_mask:0xf
    v_and_b32_dpp v37, v223, v17 row_newbcast:0 row_mask:0xf bank_mask:0xf
    v_and_b32_dpp v38, v223, v18 row_newbcast:0 row_mask:0xf bank_mask:0xf
    v_and_b32_dpp v39, v223, v19 row_newbcast:0 row_mask:0xf bank_mask:0xf
    s_waitcnt vmcnt(6)
    s_nop 0
    v_mfma_f32_16x16x32_bf16 v[20:23], v[36:39], v[116:119], v[20:23]
    s_bitcmp0_b32 s97, 0
    s_cbranch_scc0 L_de182
    s_waitcnt vmcnt(5)
L_de182:
    buffer_load_dwordx4 v[144:147], v7, s[40:43], s69 offen nt
    s_addk_i32 s69, 14336
    v_fma_f32 v245, v245, v8, -s75
    v_exp_f32 v245, v245
    s_nop 0
    v_add_f32 v15, v15, v245
    v_cvt_pk_bf16_f32 v245, v245, v245
    v_and_b32_dpp v32, v223, v16 row_newbcast:4 row_mask:0xf bank_mask:0xf
    v_and_b32_dpp v33, v223, v17 row_newbcast:4 row_mask:0xf bank_mask:0xf
    v_and_b32_dpp v34, v223, v18 row_newbcast:4 row_mask:0xf bank_mask:0xf
    v_and_b32_dpp v35, v223, v19 row_newbcast:4 row_mask:0xf bank_mask:0xf
    s_waitcnt vmcnt(6)
    s_nop 0
    v_mfma_f32_16x16x32_bf16 v[20:23], v[32:35], v[120:123], v[20:23]
    buffer_load_dwordx4 v[148:151], v7, s[40:43], s69 offen nt
    s_addk_i32 s69, 14336
    v_fma_f32 v246, v246, v8, -s75
    v_exp_f32 v246, v246
    s_nop 0
    v_add_f32 v15, v15, v246
    v_cvt_pk_bf16_f32 v246, v246, v246
    v_and_b32_dpp v36, v223, v16 row_newbcast:8 row_mask:0xf bank_mask:0xf
    v_and_b32_dpp v37, v223, v17 row_newbcast:8 row_mask:0xf bank_mask:0xf
    v_and_b32_dpp v38, v223, v18 row_newbcast:8 row_mask:0xf bank_mask:0xf
    v_and_b32_dpp v39, v223, v19 row_newbcast:8 row_mask:0xf bank_mask:0xf
    s_waitcnt vmcnt(6)
    s_nop 0
    v_mfma_f32_16x16x32_bf16 v[20:23], v[36:39], v[124:127], v[20:23]
    s_bitcmp0_b32 s97, 0
    s_cbranch_scc0 L_de184
    s_waitcnt vmcnt(5)
L_de184:
    buffer_load_dwordx4 v[152:155], v7, s[40:43], s69 offen nt
    s_addk_i32 s69, 14336
    v_fma_f32 v247, v247, v8, -s75
    v_exp_f32 v247, v247
    s_nop 0
    v_add_f32 v15, v15, v247
    v_cvt_pk_bf16_f32 v247, v247, v247
    v_and_b32_dpp v32, v223, v16 row_newbcast:12 row_mask:0xf bank_mask:0xf
    v_and_b32_dpp v33, v223, v17 row_newbcast:12 row_mask:0xf bank_mask:0xf
    v_and_b32_dpp v34, v223, v18 row_newbcast:12 row_mask:0xf bank_mask:0xf
    v_and_b32_dpp v35, v223, v19 row_newbcast:12 row_mask:0xf bank_mask:0xf
    s_waitcnt vmcnt(6)
    s_nop 0
    v_mfma_f32_16x16x32_bf16 v[20:23], v[32:35], v[128:131], v[20:23]
    buffer_load_dwordx4 v[156:159], v7, s[40:43], s69 offen nt
    s_addk_i32 s69, 14336
    v_fma_f32 v248, v248, v8, -s75
    v_exp_f32 v248, v248
    s_nop 0
    v_add_f32 v15, v15, v248
    v_cvt_pk_bf16_f32 v248, v248, v248
    v_and_b32_dpp v36, v224, v16 row_newbcast:0 row_mask:0xf bank_mask:0xf
    v_and_b32_dpp v37, v224, v17 row_newbcast:0 row_mask:0xf bank_mask:0xf
    v_and_b32_dpp v38, v224, v18 row_newbcast:0 row_mask:0xf bank_mask:0xf
    v_and_b32_dpp v39, v224, v19 row_newbcast:0 row_mask:0xf bank_mask:0xf
    s_waitcnt vmcnt(6)
    s_nop 0
    v_mfma_f32_16x16x32_bf16 v[20:23], v[36:39], v[132:135], v[20:23]
    s_bitcmp0_b32 s97, 0
    s_cbranch_scc0 L_de186
    s_waitcnt vmcnt(5)
L_de186:
    buffer_load_dwordx4 v[160:163], v7, s[40:43], s69 offen nt
    s_addk_i32 s69, 14336
    v_fma_f32 v249, v249, v8, -s75
    v_exp_f32 v249, v249
    s_nop 0
    v_add_f32 v15, v15, v249
    v_cvt_pk_bf16_f32 v249, v249, v249
    v_and_b32_dpp v32, v224, v16 row_newbcast:4 row_mask:0xf bank_mask:0xf
    v_and_b32_dpp v33, v224, v17 row_newbcast:4 row_mask:0xf bank_mask:0xf
    v_and_b32_dpp v34, v224, v18 row_newbcast:4 row_mask:0xf bank_mask:0xf
    v_and_b32_dpp v35, v224, v19 row_newbcast:4 row_mask:0xf bank_mask:0xf
    s_waitcnt vmcnt(6)
    s_nop 0
    v_mfma_f32_16x16x32_bf16 v[20:23], v[32:35], v[136:139], v[20:23]
    buffer_load_dwordx4 v[164:167], v7, s[40:43], s69 offen nt
    s_addk_i32 s69, 14336
    v_fma_f32 v250, v250, v8, -s75
    v_exp_f32 v250, v250
    s_nop 0
    v_add_f32 v15, v15, v250
    v_cvt_pk_bf16_f32 v250, v250, v250
    v_and_b32_dpp v36, v224, v16 row_newbcast:8 row_mask:0xf bank_mask:0xf
    v_and_b32_dpp v37, v224, v17 row_newbcast:8 row_mask:0xf bank_mask:0xf
    v_and_b32_dpp v38, v224, v18 row_newbcast:8 row_mask:0xf bank_mask:0xf
    v_and_b32_dpp v39, v224, v19 row_newbcast:8 row_mask:0xf bank_mask:0xf
    s_waitcnt vmcnt(6)
    s_nop 0
    v_mfma_f32_16x16x32_bf16 v[20:23], v[36:39], v[140:143], v[20:23]
    s_bitcmp0_b32 s97, 0
    s_cbranch_scc0 L_de188
    s_waitcnt vmcnt(5)
L_de188:
    buffer_load_dwordx4 v[168:171], v7, s[40:43], s69 offen nt
    s_addk_i32 s69, 14336
    v_fma_f32 v251, v251, v8, -s75
    v_exp_f32 v251, v251
    s_nop 0
    v_add_f32 v15, v15, v251
    v_cvt_pk_bf16_f32 v251, v251, v251
    v_and_b32_dpp v32, v224, v16 row_newbcast:12 row_mask:0xf bank_mask:0xf
    v_and_b32_dpp v33, v224, v17 row_newbcast:12 row_mask:0xf bank_mask:0xf
    v_and_b32_dpp v34, v224, v18 row_newbcast:12 row_mask:0xf bank_mask:0xf
    v_and_b32_dpp v35, v224, v19 row_newbcast:12 row_mask:0xf bank_mask:0xf
    s_waitcnt vmcnt(6)
    s_nop 0
    v_mfma_f32_16x16x32_bf16 v[20:23], v[32:35], v[144:147], v[20:23]
    buffer_load_dwordx4 v[172:175], v7, s[40:43], s69 offen nt
    s_addk_i32 s69, 14336
    v_fma_f32 v252, v252, v8, -s75
    v_exp_f32 v252, v252
    s_nop 0
    v_add_f32 v15, v15, v252
    v_cvt_pk_bf16_f32 v252, v252, v252
    s_nop 0
    v_add_f32_dpp v15, v15, v15 row_ror:8 row_mask:0xf bank_mask:0xf
    s_nop 1
    v_add_f32_dpp v15, v15, v15 row_ror:4 row_mask:0xf bank_mask:0xf
    s_nop 1
    v_add_f32_dpp v15, v15, v15 row_bcast:15 row_mask:0xa bank_mask:0xf
    s_nop 1
    v_add_f32_dpp v15, v15, v15 row_bcast:31 row_mask:0xc bank_mask:0xf
    v_min_u32 v14, -2, v14
    v_min_u32 v15, -2, v15
    s_mov_b32 exec_lo, 0
    s_mov_b32 exec_hi, 0x80000000
    ds_write_b64 v12, v[14:15] offset:512
    s_mov_b64 exec, -1
    v_and_b32_dpp v36, v225, v16 row_newbcast:0 row_mask:0xf bank_mask:0xf
    v_and_b32_dpp v37, v225, v17 row_newbcast:0 row_mask:0xf bank_mask:0xf
    v_and_b32_dpp v38, v225, v18 row_newbcast:0 row_mask:0xf bank_mask:0xf
    v_and_b32_dpp v39, v225, v19 row_newbcast:0 row_mask:0xf bank_mask:0xf
    s_waitcnt vmcnt(6)
    s_nop 0
    v_mfma_f32_16x16x32_bf16 v[20:23], v[36:39], v[148:151], v[20:23]
    s_bitcmp0_b32 s97, 0
    s_cbranch_scc0 L_de190
    s_waitcnt vmcnt(5)
L_de190:
    buffer_load_dwordx4 v[176:179], v7, s[40:43], s69 offen nt
    s_addk_i32 s69, 14336
    v_and_b32_dpp v32, v225, v16 row_newbcast:4 row_mask:0xf bank_mask:0xf
    v_and_b32_dpp v33, v225, v17 row_newbcast:4 row_mask:0xf bank_mask:0xf
    v_and_b32_dpp v34, v225, v18 row_newbcast:4 row_mask:0xf bank_mask:0xf
    v_and_b32_dpp v35, v225, v19 row_newbcast:4 row_mask:0xf bank_mask:0xf
    s_waitcnt vmcnt(6)
    s_nop 0
    v_mfma_f32_16x16x32_bf16 v[20:23], v[32:35], v[152:155], v[20:23]
    buffer_load_dwordx4 v[180:183], v7, s[40:43], s69 offen nt
    s_addk_i32 s69, 14336
    v_and_b32_dpp v36, v225, v16 row_newbcast:8 row_mask:0xf bank_mask:0xf
    v_and_b32_dpp v37, v225, v17 row_newbcast:8 row_mask:0xf bank_mask:0xf
    v_and_b32_dpp v38, v225, v18 row_newbcast:8 row_mask:0xf bank_mask:0xf
    v_and_b32_dpp v39, v225, v19 row_newbcast:8 row_mask:0xf bank_mask:0xf
    s_waitcnt vmcnt(6)
    s_nop 0
    v_mfma_f32_16x16x32_bf16 v[20:23], v[36:39], v[156:159], v[20:23]
    s_bitcmp0_b32 s97, 0
    s_cbranch_scc0 L_de192
    s_waitcnt vmcnt(5)
L_de192:
    buffer_load_dwordx4 v[184:187], v7, s[40:43], s69 offen nt
    s_addk_i32 s69, 14336
    v_and_b32_dpp v32, v225, v16 row_newbcast:12 row_mask:0xf bank_mask:0xf
    v_and_b32_dpp v33, v225, v17 row_newbcast:12 row_mask:0xf bank_mask:0xf
    v_and_b32_dpp v34, v225, v18 row_newbcast:12 row_mask:0xf bank_mask:0xf
    v_and_b32_dpp v35, v225, v19 row_newbcast:12 row_mask:0xf bank_mask:0xf
    s_waitcnt vmcnt(6)
    s_nop 0
    v_mfma_f32_16x16x32_bf16 v[20:23], v[32:35], v[160:163], v[20:23]
    buffer_load_dwordx4 v[188:191], v7, s[40:43], s69 offen nt
    s_addk_i32 s69, 14336
    v_and_b32_dpp v36, v226, v16 row_newbcast:0 row_mask:0xf bank_mask:0xf
    v_and_b32_dpp v37, v226, v17 row_newbcast:0 row_mask:0xf bank_mask:0xf
    v_and_b32_dpp v38, v226, v18 row_newbcast:0 row_mask:0xf bank_mask:0xf
    v_and_b32_dpp v39, v226, v19 row_newbcast:0 row_mask:0xf bank_mask:0xf
    s_waitcnt vmcnt(6)
    s_nop 0
    v_mfma_f32_16x16x32_bf16 v[20:23], v[36:39], v[164:167], v[20:23]
    s_bitcmp0_b32 s97, 0
    s_cbranch_scc0 L_de194
    s_waitcnt vmcnt(5)
L_de194:
    buffer_load_dwordx4 v[192:195], v7, s[40:43], s69 offen nt
    s_addk_i32 s69, 14336
    v_and_b32_dpp v32, v226, v16 row_newbcast:4 row_mask:0xf bank_mask:0xf
    v_and_b32_dpp v33, v226, v17 row_newbcast:4 row_mask:0xf bank_mask:0xf
    v_and_b32_dpp v34, v226, v18 row_newbcast:4 row_mask:0xf bank_mask:0xf
    v_and_b32_dpp v35, v226, v19 row_newbcast:4 row_mask:0xf bank_mask:0xf
    s_waitcnt vmcnt(6)
    s_nop 0
    v_mfma_f32_16x16x32_bf16 v[20:23], v[32:35], v[168:171], v[20:23]
    buffer_load_dwordx4 v[196:199], v7, s[40:43], s69 offen nt
    s_addk_i32 s69, 14336
    v_and_b32_dpp v36, v226, v16 row_newbcast:8 row_mask:0xf bank_mask:0xf
    v_and_b32_dpp v37, v226, v17 row_newbcast:8 row_mask:0xf bank_mask:0xf
    v_and_b32_dpp v38, v226, v18 row_newbcast:8 row_mask:0xf bank_mask:0xf
    v_and_b32_dpp v39, v226, v19 row_newbcast:8 row_mask:0xf bank_mask:0xf
    s_waitcnt vmcnt(6)
    s_nop 0
    v_mfma_f32_16x16x32_bf16 v[20:23], v[36:39], v[172:175], v[20:23]
    s_bitcmp0_b32 s97, 0
    s_cbranch_scc0 L_de196
    s_waitcnt vmcnt(5)
L_de196:
    buffer_load_dwordx4 v[200:203], v7, s[40:43], s69 offen nt
    s_addk_i32 s69, 14336
    v_and_b32_dpp v32, v226, v16 row_newbcast:12 row_mask:0xf bank_mask:0xf
    v_and_b32_dpp v33, v226, v17 row_newbcast:12 row_mask:0xf bank_mask:0xf
    v_and_b32_dpp v34, v226, v18 row_newbcast:12 row_mask:0xf bank_mask:0xf
    v_and_b32_dpp v35, v226, v19 row_newbcast:12 row_mask:0xf bank_mask:0xf
    s_waitcnt vmcnt(6)
    s_nop 0
    v_mfma_f32_16x16x32_bf16 v[20:23], v[32:35], v[176:179], v[20:23]
    buffer_load_dwordx4 v[204:207], v7, s[40:43], s69 offen nt
    s_addk_i32 s69, 14336
    v_and_b32_dpp v36, v227, v16 row_newbcast:0 row_mask:0xf bank_mask:0xf
    v_and_b32_dpp v37, v227, v17 row_newbcast:0 row_mask:0xf bank_mask:0xf
    v_and_b32_dpp v38, v227, v18 row_newbcast:0 row_mask:0xf bank_mask:0xf
    v_and_b32_dpp v39, v227, v19 row_newbcast:0 row_mask:0xf bank_mask:0xf
    s_waitcnt vmcnt(6)
    s_nop 0
    v_mfma_f32_16x16x32_bf16 v[20:23], v[36:39], v[180:183], v[20:23]
    s_bitcmp0_b32 s97, 0
    s_cbranch_scc0 L_de198
    s_waitcnt vmcnt(5)
L_de198:
    buffer_load_dwordx4 v[208:211], v7, s[40:43], s69 offen nt
    s_addk_i32 s69, 14336
    v_and_b32_dpp v32, v227, v16 row_newbcast:4 row_mask:0xf bank_mask:0xf
    v_and_b32_dpp v33, v227, v17 row_newbcast:4 row_mask:0xf bank_mask:0xf
    v_and_b32_dpp v34, v227, v18 row_newbcast:4 row_mask:0xf bank_mask:0xf
    v_and_b32_dpp v35, v227, v19 row_newbcast:4 row_mask:0xf bank_mask:0xf
    s_waitcnt vmcnt(6)
    s_nop 0
    v_mfma_f32_16x16x32_bf16 v[20:23], v[32:35], v[184:187], v[20:23]
    buffer_load_dwordx4 v[212:215], v7, s[40:43], s69 offen nt
    s_addk_i32 s69, 14336
    v_and_b32_dpp v36, v227, v16 row_newbcast:8 row_mask:0xf bank_mask:0xf
    v_and_b32_dpp v37, v227, v17 row_newbcast:8 row_mask:0xf bank_mask:0xf
    v_and_b32_dpp v38, v227, v18 row_newbcast:8 row_mask:0xf bank_mask:0xf
    v_and_b32_dpp v39, v227, v19 row_newbcast:8 row_mask:0xf bank_mask:0xf
    s_waitcnt vmcnt(6)
    s_nop 0
    v_mfma_f32_16x16x32_bf16 v[20:23], v[36:39], v[188:191], v[20:23]
    s_bitcmp0_b32 s97, 0
    s_cbranch_scc0 L_de200
    s_waitcnt vmcnt(5)
L_de200:
    buffer_load_dwordx4 v[56:59], v7, s[40:43], s69 offen nt
    s_addk_i32 s69, 14336
    v_and_b32_dpp v32, v227, v16 row_newbcast:12 row_mask:0xf bank_mask:0xf
    v_and_b32_dpp v33, v227, v17 row_newbcast:12 row_mask:0xf bank_mask:0xf
    v_and_b32_dpp v34, v227, v18 row_newbcast:12 row_mask:0xf bank_mask:0xf
    v_and_b32_dpp v35, v227, v19 row_newbcast:12 row_mask:0xf bank_mask:0xf
    s_waitcnt vmcnt(6)
    s_nop 0
    v_mfma_f32_16x16x32_bf16 v[20:23], v[32:35], v[192:195], v[20:23]
    buffer_load_dwordx4 v[60:63], v7, s[40:43], s69 offen nt
    s_addk_i32 s69, 14336
    v_and_b32_dpp v36, v228, v16 row_newbcast:0 row_mask:0xf bank_mask:0xf
    v_and_b32_dpp v37, v228, v17 row_newbcast:0 row_mask:0xf bank_mask:0xf
    v_and_b32_dpp v38, v228, v18 row_newbcast:0 row_mask:0xf bank_mask:0xf
    v_and_b32_dpp v39, v228, v19 row_newbcast:0 row_mask:0xf bank_mask:0xf
    s_waitcnt vmcnt(6)
    s_nop 0
    v_mfma_f32_16x16x32_bf16 v[20:23], v[36:39], v[196:199], v[20:23]
    s_bitcmp0_b32 s97, 0
    s_cbranch_scc0 L_de202
    s_waitcnt vmcnt(5)
L_de202:
    buffer_load_dwordx4 v[64:67], v7, s[40:43], s69 offen nt
    s_addk_i32 s69, 14336
    v_and_b32_dpp v32, v228, v16 row_newbcast:4 row_mask:0xf bank_mask:0xf
    v_and_b32_dpp v33, v228, v17 row_newbcast:4 row_mask:0xf bank_mask:0xf
    v_and_b32_dpp v34, v228, v18 row_newbcast:4 row_mask:0xf bank_mask:0xf
    v_and_b32_dpp v35, v228, v19 row_newbcast:4 row_mask:0xf bank_mask:0xf
    s_waitcnt vmcnt(6)
    s_nop 0
    v_mfma_f32_16x16x32_bf16 v[20:23], v[32:35], v[200:203], v[20:23]
    buffer_load_dwordx4 v[68:71], v7, s[40:43], s69 offen nt
    s_addk_i32 s69, 14336
    v_and_b32_dpp v36, v228, v16 row_newbcast:8 row_mask:0xf bank_mask:0xf
    v_and_b32_dpp v37, v228, v17 row_newbcast:8 row_mask:0xf bank_mask:0xf
    v_and_b32_dpp v38, v228, v18 row_newbcast:8 row_mask:0xf bank_mask:0xf
    v_and_b32_dpp v39, v228, v19 row_newbcast:8 row_mask:0xf bank_mask:0xf
    s_waitcnt vmcnt(6)
    s_nop 0
    v_mfma_f32_16x16x32_bf16 v[20:23], v[36:39], v[204:207], v[20:23]
    s_bitcmp0_b32 s97, 0
    s_cbranch_scc0 L_de204
    s_waitcnt vmcnt(5)
L_de204:
    buffer_load_dwordx4 v[72:75], v7, s[40:43], s69 offen nt
    s_addk_i32 s69, 14336
    v_and_b32_dpp v32, v228, v16 row_newbcast:12 row_mask:0xf bank_mask:0xf
    v_and_b32_dpp v33, v228, v17 row_newbcast:12 row_mask:0xf bank_mask:0xf
    v_and_b32_dpp v34, v228, v18 row_newbcast:12 row_mask:0xf bank_mask:0xf
    v_and_b32_dpp v35, v228, v19 row_newbcast:12 row_mask:0xf bank_mask:0xf
    s_waitcnt vmcnt(6)
    s_nop 0
    v_mfma_f32_16x16x32_bf16 v[20:23], v[32:35], v[208:211], v[20:23]
    buffer_load_dwordx4 v[76:79], v7, s[40:43], s69 offen nt
    s_addk_i32 s69, 14336
    v_and_b32_dpp v36, v229, v16 row_newbcast:0 row_mask:0xf bank_mask:0xf
    v_and_b32_dpp v37, v229, v17 row_newbcast:0 row_mask:0xf bank_mask:0xf
    v_and_b32_dpp v38, v229, v18 row_newbcast:0 row_mask:0xf bank_mask:0xf
    v_and_b32_dpp v39, v229, v19 row_newbcast:0 row_mask:0xf bank_mask:0xf
    s_waitcnt vmcnt(6)
    s_nop 0
    v_mfma_f32_16x16x32_bf16 v[20:23], v[36:39], v[212:215], v[20:23]
    s_bitcmp0_b32 s97, 0
    s_cbranch_scc0 L_de206
    s_waitcnt vmcnt(5)
L_de206:
    buffer_load_dwordx4 v[80:83], v7, s[40:43], s69 offen nt
    s_addk_i32 s69, 14336
    v_and_b32_dpp v32, v229, v16 row_newbcast:4 row_mask:0xf bank_mask:0xf
    v_and_b32_dpp v33, v229, v17 row_newbcast:4 row_mask:0xf bank_mask:0xf
    v_and_b32_dpp v34, v229, v18 row_newbcast:4 row_mask:0xf bank_mask:0xf
    v_and_b32_dpp v35, v229, v19 row_newbcast:4 row_mask:0xf bank_mask:0xf
    s_waitcnt vmcnt(6)
    s_nop 0
    v_mfma_f32_16x16x32_bf16 v[20:23], v[32:35], v[56:59], v[20:23]
    buffer_load_dwordx4 v[84:87], v7, s[40:43], s69 offen nt
    s_addk_i32 s69, 14336
    v_and_b32_dpp v36, v229, v16 row_newbcast:8 row_mask:0xf bank_mask:0xf
    v_and_b32_dpp v37, v229, v17 row_newbcast:8 row_mask:0xf bank_mask:0xf
    v_and_b32_dpp v38, v229, v18 row_newbcast:8 row_mask:0xf bank_mask:0xf
    v_and_b32_dpp v39, v229, v19 row_newbcast:8 row_mask:0xf bank_mask:0xf
    s_waitcnt vmcnt(6)
    s_nop 0
    v_mfma_f32_16x16x32_bf16 v[20:23], v[36:39], v[60:63], v[20:23]
    s_bitcmp0_b32 s97, 0
    s_cbranch_scc0 L_de208
    s_waitcnt vmcnt(5)
L_de208:
    buffer_load_dwordx4 v[88:91], v7, s[40:43], s69 offen nt
    s_addk_i32 s69, 14336
    v_and_b32_dpp v32, v229, v16 row_newbcast:12 row_mask:0xf bank_mask:0xf
    v_and_b32_dpp v33, v229, v17 row_newbcast:12 row_mask:0xf bank_mask:0xf
    v_and_b32_dpp v34, v229, v18 row_newbcast:12 row_mask:0xf bank_mask:0xf
    v_and_b32_dpp v35, v229, v19 row_newbcast:12 row_mask:0xf bank_mask:0xf
    s_waitcnt vmcnt(6)
    s_nop 0
    v_mfma_f32_16x16x32_bf16 v[20:23], v[32:35], v[64:67], v[20:23]
    buffer_load_dwordx4 v[92:95], v7, s[40:43], s69 offen nt
    s_addk_i32 s69, 14336
    v_and_b32_dpp v36, v230, v16 row_newbcast:0 row_mask:0xf bank_mask:0xf
    v_and_b32_dpp v37, v230, v17 row_newbcast:0 row_mask:0xf bank_mask:0xf
    v_and_b32_dpp v38, v230, v18 row_newbcast:0 row_mask:0xf bank_mask:0xf
    v_and_b32_dpp v39, v230, v19 row_newbcast:0 row_mask:0xf bank_mask:0xf
    s_waitcnt vmcnt(6)
    s_nop 0
    v_mfma_f32_16x16x32_bf16 v[20:23], v[36:39], v[68:71], v[20:23]
    s_bitcmp0_b32 s97, 0
    s_cbranch_scc0 L_de210
    s_waitcnt vmcnt(5)
L_de210:
    buffer_load_dwordx4 v[96:99], v7, s[40:43], s69 offen nt
    s_addk_i32 s69, 14336
    v_and_b32_dpp v32, v230, v16 row_newbcast:4 row_mask:0xf bank_mask:0xf
    v_and_b32_dpp v33, v230, v17 row_newbcast:4 row_mask:0xf bank_mask:0xf
    v_and_b32_dpp v34, v230, v18 row_newbcast:4 row_mask:0xf bank_mask:0xf
    v_and_b32_dpp v35, v230, v19 row_newbcast:4 row_mask:0xf bank_mask:0xf
    s_waitcnt vmcnt(6)
    s_nop 0
    v_mfma_f32_16x16x32_bf16 v[20:23], v[32:35], v[72:75], v[20:23]
    buffer_load_dwordx4 v[100:103], v7, s[40:43], s69 offen nt
    s_addk_i32 s69, 14336
    v_and_b32_dpp v36, v230, v16 row_newbcast:8 row_mask:0xf bank_mask:0xf
    v_and_b32_dpp v37, v230, v17 row_newbcast:8 row_mask:0xf bank_mask:0xf
    v_and_b32_dpp v38, v230, v18 row_newbcast:8 row_mask:0xf bank_mask:0xf
    v_and_b32_dpp v39, v230, v19 row_newbcast:8 row_mask:0xf bank_mask:0xf
    s_waitcnt vmcnt(6)
    s_nop 0
    v_mfma_f32_16x16x32_bf16 v[20:23], v[36:39], v[76:79], v[20:23]
    s_bitcmp0_b32 s97, 0
    s_cbranch_scc0 L_de212
    s_waitcnt vmcnt(5)
L_de212:
    buffer_load_dwordx4 v[104:107], v7, s[40:43], s69 offen nt
    s_addk_i32 s69, 14336
    v_and_b32_dpp v32, v230, v16 row_newbcast:12 row_mask:0xf bank_mask:0xf
    v_and_b32_dpp v33, v230, v17 row_newbcast:12 row_mask:0xf bank_mask:0xf
    v_and_b32_dpp v34, v230, v18 row_newbcast:12 row_mask:0xf bank_mask:0xf
    v_and_b32_dpp v35, v230, v19 row_newbcast:12 row_mask:0xf bank_mask:0xf
    s_waitcnt vmcnt(6)
    s_nop 0
    v_mfma_f32_16x16x32_bf16 v[20:23], v[32:35], v[80:83], v[20:23]
    buffer_load_dwordx4 v[108:111], v7, s[40:43], s69 offen nt
    s_addk_i32 s69, 14336
    v_and_b32_dpp v36, v231, v16 row_newbcast:0 row_mask:0xf bank_mask:0xf
    v_and_b32_dpp v37, v231, v17 row_newbcast:0 row_mask:0xf bank_mask:0xf
    v_and_b32_dpp v38, v231, v18 row_newbcast:0 row_mask:0xf bank_mask:0xf
    v_and_b32_dpp v39, v231, v19 row_newbcast:0 row_mask:0xf bank_mask:0xf
    s_waitcnt vmcnt(6)
    s_nop 0
    v_mfma_f32_16x16x32_bf16 v[20:23], v[36:39], v[84:87], v[20:23]
    s_bitcmp0_b32 s97, 0
    s_cbranch_scc0 L_de214
    s_waitcnt vmcnt(5)
L_de214:
    buffer_load_dwordx4 v[112:115], v7, s[40:43], s69 offen nt
    s_addk_i32 s69, 14336
    v_and_b32_dpp v32, v231, v16 row_newbcast:4 row_mask:0xf bank_mask:0xf
    v_and_b32_dpp v33, v231, v17 row_newbcast:4 row_mask:0xf bank_mask:0xf
    v_and_b32_dpp v34, v231, v18 row_newbcast:4 row_mask:0xf bank_mask:0xf
    v_and_b32_dpp v35, v231, v19 row_newbcast:4 row_mask:0xf bank_mask:0xf
    s_waitcnt vmcnt(6)
    s_nop 0
    v_mfma_f32_16x16x32_bf16 v[20:23], v[32:35], v[88:91], v[20:23]
    buffer_load_dwordx4 v[116:119], v7, s[40:43], s69 offen nt
    s_addk_i32 s69, 14336
    v_and_b32_dpp v36, v231, v16 row_newbcast:8 row_mask:0xf bank_mask:0xf
    v_and_b32_dpp v37, v231, v17 row_newbcast:8 row_mask:0xf bank_mask:0xf
    v_and_b32_dpp v38, v231, v18 row_newbcast:8 row_mask:0xf bank_mask:0xf
    v_and_b32_dpp v39, v231, v19 row_newbcast:8 row_mask:0xf bank_mask:0xf
    s_waitcnt vmcnt(6)
    s_nop 0
    v_mfma_f32_16x16x32_bf16 v[20:23], v[36:39], v[92:95], v[20:23]
    s_bitcmp0_b32 s97, 0
    s_cbranch_scc0 L_de216
    s_waitcnt vmcnt(5)
L_de216:
    buffer_load_dwordx4 v[120:123], v7, s[40:43], s69 offen nt
    s_addk_i32 s69, 14336
    v_and_b32_dpp v32, v231, v16 row_newbcast:12 row_mask:0xf bank_mask:0xf
    v_and_b32_dpp v33, v231, v17 row_newbcast:12 row_mask:0xf bank_mask:0xf
    v_and_b32_dpp v34, v231, v18 row_newbcast:12 row_mask:0xf bank_mask:0xf
    v_and_b32_dpp v35, v231, v19 row_newbcast:12 row_mask:0xf bank_mask:0xf
    s_waitcnt vmcnt(6)
    s_nop 0
    v_mfma_f32_16x16x32_bf16 v[20:23], v[32:35], v[96:99], v[20:23]
    buffer_load_dwordx4 v[124:127], v7, s[40:43], s69 offen nt
    s_addk_i32 s69, 14336
    v_and_b32_dpp v36, v232, v16 row_newbcast:0 row_mask:0xf bank_mask:0xf
    v_and_b32_dpp v37, v232, v17 row_newbcast:0 row_mask:0xf bank_mask:0xf
    v_and_b32_dpp v38, v232, v18 row_newbcast:0 row_mask:0xf bank_mask:0xf
    v_and_b32_dpp v39, v232, v19 row_newbcast:0 row_mask:0xf bank_mask:0xf
    s_waitcnt vmcnt(6)
    s_nop 0
    v_mfma_f32_16x16x32_bf16 v[20:23], v[36:39], v[100:103], v[20:23]
    s_bitcmp0_b32 s97, 0
    s_cbranch_scc0 L_de218
    s_waitcnt vmcnt(5)
L_de218:
    buffer_load_dwordx4 v[128:131], v7, s[40:43], s69 offen nt
    s_addk_i32 s69, 14336
    v_and_b32_dpp v32, v232, v16 row_newbcast:4 row_mask:0xf bank_mask:0xf
    v_and_b32_dpp v33, v232, v17 row_newbcast:4 row_mask:0xf bank_mask:0xf
    v_and_b32_dpp v34, v232, v18 row_newbcast:4 row_mask:0xf bank_mask:0xf
    v_and_b32_dpp v35, v232, v19 row_newbcast:4 row_mask:0xf bank_mask:0xf
    s_waitcnt vmcnt(6)
    s_nop 0
    v_mfma_f32_16x16x32_bf16 v[20:23], v[32:35], v[104:107], v[20:23]
    buffer_load_dwordx4 v[132:135], v7, s[40:43], s69 offen nt
    s_addk_i32 s69, 14336
    v_and_b32_dpp v36, v232, v16 row_newbcast:8 row_mask:0xf bank_mask:0xf
    v_and_b32_dpp v37, v232, v17 row_newbcast:8 row_mask:0xf bank_mask:0xf
    v_and_b32_dpp v38, v232, v18 row_newbcast:8 row_mask:0xf bank_mask:0xf
    v_and_b32_dpp v39, v232, v19 row_newbcast:8 row_mask:0xf bank_mask:0xf
    s_waitcnt vmcnt(6)
    s_nop 0
    v_mfma_f32_16x16x32_bf16 v[20:23], v[36:39], v[108:111], v[20:23]
    s_bitcmp0_b32 s97, 0
    s_cbranch_scc0 L_de220
    s_waitcnt vmcnt(5)
L_de220:
    buffer_load_dwordx4 v[136:139], v7, s[40:43], s69 offen nt
    s_addk_i32 s69, 14336
    v_and_b32_dpp v32, v232, v16 row_newbcast:12 row_mask:0xf bank_mask:0xf
    v_and_b32_dpp v33, v232, v17 row_newbcast:12 row_mask:0xf bank_mask:0xf
    v_and_b32_dpp v34, v232, v18 row_newbcast:12 row_mask:0xf bank_mask:0xf
    v_and_b32_dpp v35, v232, v19 row_newbcast:12 row_mask:0xf bank_mask:0xf
    s_waitcnt vmcnt(6)
    s_nop 0
    v_mfma_f32_16x16x32_bf16 v[20:23], v[32:35], v[112:115], v[20:23]
    buffer_load_dwordx4 v[140:143], v7, s[40:43], s69 offen nt
    s_addk_i32 s69, 14336
    v_and_b32_dpp v36, v233, v16 row_newbcast:0 row_mask:0xf bank_mask:0xf
    v_and_b32_dpp v37, v233, v17 row_newbcast:0 row_mask:0xf bank_mask:0xf
    v_and_b32_dpp v38, v233, v18 row_newbcast:0 row_mask:0xf bank_mask:0xf
    v_and_b32_dpp v39, v233, v19 row_newbcast:0 row_mask:0xf bank_mask:0xf
    s_waitcnt vmcnt(6)
    s_nop 0
    v_mfma_f32_16x16x32_bf16 v[20:23], v[36:39], v[116:119], v[20:23]
    s_bitcmp0_b32 s97, 0
    s_cbranch_scc0 L_de222
    s_waitcnt vmcnt(5)
L_de222:
    buffer_load_dwordx4 v[144:147], v7, s[40:43], s69 offen nt
    s_addk_i32 s69, 14336
    v_and_b32_dpp v32, v233, v16 row_newbcast:4 row_mask:0xf bank_mask:0xf
    v_and_b32_dpp v33, v233, v17 row_newbcast:4 row_mask:0xf bank_mask:0xf
    v_and_b32_dpp v34, v233, v18 row_newbcast:4 row_mask:0xf bank_mask:0xf
    v_and_b32_dpp v35, v233, v19 row_newbcast:4 row_mask:0xf bank_mask:0xf
    s_waitcnt vmcnt(6)
    s_nop 0
    v_mfma_f32_16x16x32_bf16 v[20:23], v[32:35], v[120:123], v[20:23]
    buffer_load_dwordx4 v[148:151], v7, s[40:43], s69 offen nt
    s_addk_i32 s69, 14336
    v_and_b32_dpp v36, v233, v16 row_newbcast:8 row_mask:0xf bank_mask:0xf
    v_and_b32_dpp v37, v233, v17 row_newbcast:8 row_mask:0xf bank_mask:0xf
    v_and_b32_dpp v38, v233, v18 row_newbcast:8 row_mask:0xf bank_mask:0xf
    v_and_b32_dpp v39, v233, v19 row_newbcast:8 row_mask:0xf bank_mask:0xf
    s_waitcnt vmcnt(6)
    s_nop 0
    v_mfma_f32_16x16x32_bf16 v[20:23], v[36:39], v[124:127], v[20:23]
    s_bitcmp0_b32 s97, 0
    s_cbranch_scc0 L_de224
    s_waitcnt vmcnt(5)
L_de224:
    buffer_load_dwordx4 v[152:155], v7, s[40:43], s69 offen nt
    s_addk_i32 s69, 14336
    v_and_b32_dpp v32, v233, v16 row_newbcast:12 row_mask:0xf bank_mask:0xf
    v_and_b32_dpp v33, v233, v17 row_newbcast:12 row_mask:0xf bank_mask:0xf
    v_and_b32_dpp v34, v233, v18 row_newbcast:12 row_mask:0xf bank_mask:0xf
    v_and_b32_dpp v35, v233, v19 row_newbcast:12 row_mask:0xf bank_mask:0xf
    s_waitcnt vmcnt(6)
    s_nop 0
    v_mfma_f32_16x16x32_bf16 v[20:23], v[32:35], v[128:131], v[20:23]
    buffer_load_dwordx4 v[156:159], v7, s[40:43], s69 offen nt
    s_addk_i32 s69, 14336
    v_and_b32_dpp v36, v234, v16 row_newbcast:0 row_mask:0xf bank_mask:0xf
    v_and_b32_dpp v37, v234, v17 row_newbcast:0 row_mask:0xf bank_mask:0xf
    v_and_b32_dpp v38, v234, v18 row_newbcast:0 row_mask:0xf bank_mask:0xf
    v_and_b32_dpp v39, v234, v19 row_newbcast:0 row_mask:0xf bank_mask:0xf
    s_waitcnt vmcnt(6)
    s_nop 0
    v_mfma_f32_16x16x32_bf16 v[20:23], v[36:39], v[132:135], v[20:23]
    s_bitcmp0_b32 s97, 0
    s_cbranch_scc0 L_de226
    s_waitcnt vmcnt(5)
L_de226:
    buffer_load_dwordx4 v[160:163], v7, s[40:43], s69 offen nt
    s_addk_i32 s69, 14336
    v_and_b32_dpp v32, v234, v16 row_newbcast:4 row_mask:0xf bank_mask:0xf
    v_and_b32_dpp v33, v234, v17 row_newbcast:4 row_mask:0xf bank_mask:0xf
    v_and_b32_dpp v34, v234, v18 row_newbcast:4 row_mask:0xf bank_mask:0xf
    v_and_b32_dpp v35, v234, v19 row_newbcast:4 row_mask:0xf bank_mask:0xf
    s_waitcnt vmcnt(6)
    s_nop 0
    v_mfma_f32_16x16x32_bf16 v[20:23], v[32:35], v[136:139], v[20:23]
    buffer_load_dwordx4 v[164:167], v7, s[40:43], s69 offen nt
    s_addk_i32 s69, 14336
    v_and_b32_dpp v36, v234, v16 row_newbcast:8 row_mask:0xf bank_mask:0xf
    v_and_b32_dpp v37, v234, v17 row_newbcast:8 row_mask:0xf bank_mask:0xf
    v_and_b32_dpp v38, v234, v18 row_newbcast:8 row_mask:0xf bank_mask:0xf
    v_and_b32_dpp v39, v234, v19 row_newbcast:8 row_mask:0xf bank_mask:0xf
    s_waitcnt vmcnt(6)
    s_nop 0
    v_mfma_f32_16x16x32_bf16 v[20:23], v[36:39], v[140:143], v[20:23]
    s_bitcmp0_b32 s97, 0
    s_cbranch_scc0 L_de228
    s_waitcnt vmcnt(5)
L_de228:
    buffer_load_dwordx4 v[168:171], v7, s[40:43], s69 offen nt
    s_addk_i32 s69, 14336
    v_and_b32_dpp v32, v234, v16 row_newbcast:12 row_mask:0xf bank_mask:0xf
    v_and_b32_dpp v33, v234, v17 row_newbcast:12 row_mask:0xf bank_mask:0xf
    v_and_b32_dpp v34, v234, v18 row_newbcast:12 row_mask:0xf bank_mask:0xf
    v_and_b32_dpp v35, v234, v19 row_newbcast:12 row_mask:0xf bank_mask:0xf
    s_waitcnt vmcnt(6)
    s_nop 0
    v_mfma_f32_16x16x32_bf16 v[20:23], v[32:35], v[144:147], v[20:23]
    buffer_load_dwordx4 v[172:175], v7, s[40:43], s69 offen nt
    s_addk_i32 s69, 14336
    v_and_b32_dpp v36, v235, v16 row_newbcast:0 row_mask:0xf bank_mask:0xf
    v_and_b32_dpp v37, v235, v17 row_newbcast:0 row_mask:0xf bank_mask:0xf
    v_and_b32_dpp v38, v235, v18 row_newbcast:0 row_mask:0xf bank_mask:0xf
    v_and_b32_dpp v39, v235, v19 row_newbcast:0 row_mask:0xf bank_mask:0xf
    s_waitcnt vmcnt(6)
    s_nop 0
    v_mfma_f32_16x16x32_bf16 v[20:23], v[36:39], v[148:151], v[20:23]
    s_bitcmp0_b32 s97, 0
    s_cbranch_scc0 L_de230
    s_waitcnt vmcnt(5)
L_de230:
    buffer_load_dwordx4 v[176:179], v7, s[40:43], s69 offen nt
    s_addk_i32 s69, 14336
    v_and_b32_dpp v32, v235, v16 row_newbcast:4 row_mask:0xf bank_mask:0xf
    v_and_b32_dpp v33, v235, v17 row_newbcast:4 row_mask:0xf bank_mask:0xf
    v_and_b32_dpp v34, v235, v18 row_newbcast:4 row_mask:0xf bank_mask:0xf
    v_and_b32_dpp v35, v235, v19 row_newbcast:4 row_mask:0xf bank_mask:0xf
    s_waitcnt vmcnt(6)
    s_nop 0
    v_mfma_f32_16x16x32_bf16 v[20:23], v[32:35], v[152:155], v[20:23]
    buffer_load_dwordx4 v[180:183], v7, s[40:43], s69 offen nt
    s_addk_i32 s69, 14336
    v_and_b32_dpp v36, v235, v16 row_newbcast:8 row_mask:0xf bank_mask:0xf
    v_and_b32_dpp v37, v235, v17 row_newbcast:8 row_mask:0xf bank_mask:0xf
    v_and_b32_dpp v38, v235, v18 row_newbcast:8 row_mask:0xf bank_mask:0xf
    v_and_b32_dpp v39, v235, v19 row_newbcast:8 row_mask:0xf bank_mask:0xf
    s_waitcnt vmcnt(6)
    s_nop 0
    v_mfma_f32_16x16x32_bf16 v[20:23], v[36:39], v[156:159], v[20:23]
    s_bitcmp0_b32 s97, 0
    s_cbranch_scc0 L_de232
    s_waitcnt vmcnt(5)
L_de232:
    buffer_load_dwordx4 v[184:187], v7, s[40:43], s69 offen nt
    s_addk_i32 s69, 14336
    v_and_b32_dpp v32, v235, v16 row_newbcast:12 row_mask:0xf bank_mask:0xf
    v_and_b32_dpp v33, v235, v17 row_newbcast:12 row_mask:0xf bank_mask:0xf
    v_and_b32_dpp v34, v235, v18 row_newbcast:12 row_mask:0xf bank_mask:0xf
    v_and_b32_dpp v35, v235, v19 row_newbcast:12 row_mask:0xf bank_mask:0xf
    s_waitcnt vmcnt(6)
    s_nop 0
    v_mfma_f32_16x16x32_bf16 v[20:23], v[32:35], v[160:163], v[20:23]
    buffer_load_dwordx4 v[188:191], v7, s[40:43], s69 offen nt
    s_addk_i32 s69, 14336
    v_and_b32_dpp v36, v236, v16 row_newbcast:0 row_mask:0xf bank_mask:0xf
    v_and_b32_dpp v37, v236, v17 row_newbcast:0 row_mask:0xf bank_mask:0xf
    v_and_b32_dpp v38, v236, v18 row_newbcast:0 row_mask:0xf bank_mask:0xf
    v_and_b32_dpp v39, v236, v19 row_newbcast:0 row_mask:0xf bank_mask:0xf
    s_waitcnt vmcnt(6)
    s_nop 0
    v_mfma_f32_16x16x32_bf16 v[20:23], v[36:39], v[164:167], v[20:23]
    s_bitcmp0_b32 s97, 0
    s_cbranch_scc0 L_de234
    s_waitcnt vmcnt(5)
L_de234:
    buffer_load_dwordx4 v[192:195], v7, s[40:43], s69 offen nt
    s_addk_i32 s69, 14336
    v_and_b32_dpp v32, v236, v16 row_newbcast:4 row_mask:0xf bank_mask:0xf
    v_and_b32_dpp v33, v236, v17 row_newbcast:4 row_mask:0xf bank_mask:0xf
    v_and_b32_dpp v34, v236, v18 row_newbcast:4 row_mask:0xf bank_mask:0xf
    v_and_b32_dpp v35, v236, v19 row_newbcast:4 row_mask:0xf bank_mask:0xf
    s_waitcnt vmcnt(6)
    s_nop 0
    v_mfma_f32_16x16x32_bf16 v[20:23], v[32:35], v[168:171], v[20:23]
    buffer_load_dwordx4 v[196:199], v7, s[40:43], s69 offen nt
    s_addk_i32 s69, 14336
    v_and_b32_dpp v36, v236, v16 row_newbcast:8 row_mask:0xf bank_mask:0xf
    v_and_b32_dpp v37, v236, v17 row_newbcast:8 row_mask:0xf bank_mask:0xf
    v_and_b32_dpp v38, v236, v18 row_newbcast:8 row_mask:0xf bank_mask:0xf
    v_and_b32_dpp v39, v236, v19 row_newbcast:8 row_mask:0xf bank_mask:0xf
    s_waitcnt vmcnt(6)
    s_nop 0
    v_mfma_f32_16x16x32_bf16 v[20:23], v[36:39], v[172:175], v[20:23]
    s_bitcmp0_b32 s97, 0
    s_cbranch_scc0 L_de236
    s_waitcnt vmcnt(5)
L_de236:
    buffer_load_dwordx4 v[200:203], v7, s[40:43], s69 offen nt
    s_addk_i32 s69, 14336
    v_and_b32_dpp v32, v236, v16 row_newbcast:12 row_mask:0xf bank_mask:0xf
    v_and_b32_dpp v33, v236, v17 row_newbcast:12 row_mask:0xf bank_mask:0xf
    v_and_b32_dpp v34, v236, v18 row_newbcast:12 row_mask:0xf bank_mask:0xf
    v_and_b32_dpp v35, v236, v19 row_newbcast:12 row_mask:0xf bank_mask:0xf
    s_waitcnt vmcnt(6)
    s_nop 0
    v_mfma_f32_16x16x32_bf16 v[20:23], v[32:35], v[176:179], v[20:23]
    buffer_load_dwordx4 v[204:207], v7, s[40:43], s69 offen nt
    s_addk_i32 s69, 14336
    v_and_b32_dpp v36, v237, v16 row_newbcast:0 row_mask:0xf bank_mask:0xf
    v_and_b32_dpp v37, v237, v17 row_newbcast:0 row_mask:0xf bank_mask:0xf
    v_and_b32_dpp v38, v237, v18 row_newbcast:0 row_mask:0xf bank_mask:0xf
    v_and_b32_dpp v39, v237, v19 row_newbcast:0 row_mask:0xf bank_mask:0xf
    s_waitcnt vmcnt(6)
    s_nop 0
    v_mfma_f32_16x16x32_bf16 v[20:23], v[36:39], v[180:183], v[20:23]
    s_bitcmp0_b32 s97, 0
    s_cbranch_scc0 L_de238
    s_waitcnt vmcnt(5)
L_de238:
    buffer_load_dwordx4 v[208:211], v7, s[40:43], s69 offen nt
    s_addk_i32 s69, 14336
    v_and_b32_dpp v32, v237, v16 row_newbcast:4 row_mask:0xf bank_mask:0xf
    v_and_b32_dpp v33, v237, v17 row_newbcast:4 row_mask:0xf bank_mask:0xf
    v_and_b32_dpp v34, v237, v18 row_newbcast:4 row_mask:0xf bank_mask:0xf
    v_and_b32_dpp v35, v237, v19 row_newbcast:4 row_mask:0xf bank_mask:0xf
    s_waitcnt vmcnt(6)
    s_nop 0
    v_mfma_f32_16x16x32_bf16 v[20:23], v[32:35], v[184:187], v[20:23]
    buffer_load_dwordx4 v[212:215], v7, s[40:43], s69 offen nt
    s_addk_i32 s69, 14336
    v_and_b32_dpp v36, v237, v16 row_newbcast:8 row_mask:0xf bank_mask:0xf
    v_and_b32_dpp v37, v237, v17 row_newbcast:8 row_mask:0xf bank_mask:0xf
    v_and_b32_dpp v38, v237, v18 row_newbcast:8 row_mask:0xf bank_mask:0xf
    v_and_b32_dpp v39, v237, v19 row_newbcast:8 row_mask:0xf bank_mask:0xf
    s_waitcnt vmcnt(6)
    s_nop 0
    v_mfma_f32_16x16x32_bf16 v[20:23], v[36:39], v[188:191], v[20:23]
    s_bitcmp0_b32 s97, 0
    s_cbranch_scc0 L_de240
    s_waitcnt vmcnt(5)
L_de240:
    buffer_load_dwordx4 v[56:59], v7, s[40:43], s69 offen nt
    s_addk_i32 s69, 14336
    v_and_b32_dpp v32, v237, v16 row_newbcast:12 row_mask:0xf bank_mask:0xf
    v_and_b32_dpp v33, v237, v17 row_newbcast:12 row_mask:0xf bank_mask:0xf
    v_and_b32_dpp v34, v237, v18 row_newbcast:12 row_mask:0xf bank_mask:0xf
    v_and_b32_dpp v35, v237, v19 row_newbcast:12 row_mask:0xf bank_mask:0xf
    s_waitcnt vmcnt(6)
    s_nop 0
    v_mfma_f32_16x16x32_bf16 v[20:23], v[32:35], v[192:195], v[20:23]
    buffer_load_dwordx4 v[60:63], v7, s[40:43], s69 offen nt
    s_addk_i32 s69, 14336
    v_and_b32_dpp v36, v238, v16 row_newbcast:0 row_mask:0xf bank_mask:0xf
    v_and_b32_dpp v37, v238, v17 row_newbcast:0 row_mask:0xf bank_mask:0xf
    v_and_b32_dpp v38, v238, v18 row_newbcast:0 row_mask:0xf bank_mask:0xf
    v_and_b32_dpp v39, v238, v19 row_newbcast:0 row_mask:0xf bank_mask:0xf
    s_waitcnt vmcnt(6)
    s_nop 0
    v_mfma_f32_16x16x32_bf16 v[20:23], v[36:39], v[196:199], v[20:23]
    s_bitcmp0_b32 s97, 0
    s_cbranch_scc0 L_de242
    s_waitcnt vmcnt(5)
L_de242:
    buffer_load_dwordx4 v[64:67], v7, s[40:43], s69 offen nt
    s_addk_i32 s69, 14336
    v_and_b32_dpp v32, v238, v16 row_newbcast:4 row_mask:0xf bank_mask:0xf
    v_and_b32_dpp v33, v238, v17 row_newbcast:4 row_mask:0xf bank_mask:0xf
    v_and_b32_dpp v34, v238, v18 row_newbcast:4 row_mask:0xf bank_mask:0xf
    v_and_b32_dpp v35, v238, v19 row_newbcast:4 row_mask:0xf bank_mask:0xf
    s_waitcnt vmcnt(6)
    s_nop 0
    v_mfma_f32_16x16x32_bf16 v[20:23], v[32:35], v[200:203], v[20:23]
    buffer_load_dwordx4 v[68:71], v7, s[40:43], s69 offen nt
    s_addk_i32 s69, 14336
    v_and_b32_dpp v36, v238, v16 row_newbcast:8 row_mask:0xf bank_mask:0xf
    v_and_b32_dpp v37, v238, v17 row_newbcast:8 row_mask:0xf bank_mask:0xf
    v_and_b32_dpp v38, v238, v18 row_newbcast:8 row_mask:0xf bank_mask:0xf
    v_and_b32_dpp v39, v238, v19 row_newbcast:8 row_mask:0xf bank_mask:0xf
    s_waitcnt vmcnt(6)
    s_nop 0
    v_mfma_f32_16x16x32_bf16 v[20:23], v[36:39], v[204:207], v[20:23]
    s_bitcmp0_b32 s97, 0
    s_cbranch_scc0 L_de244
    s_waitcnt vmcnt(5)
L_de244:
    buffer_load_dwordx4 v[72:75], v7, s[40:43], s69 offen nt
    s_addk_i32 s69, 14336
    v_and_b32_dpp v32, v238, v16 row_newbcast:12 row_mask:0xf bank_mask:0xf
    v_and_b32_dpp v33, v238, v17 row_newbcast:12 row_mask:0xf bank_mask:0xf
    v_and_b32_dpp v34, v238, v18 row_newbcast:12 row_mask:0xf bank_mask:0xf
    v_and_b32_dpp v35, v238, v19 row_newbcast:12 row_mask:0xf bank_mask:0xf
    s_waitcnt vmcnt(6)
    s_nop 0
    v_mfma_f32_16x16x32_bf16 v[20:23], v[32:35], v[208:211], v[20:23]
    buffer_load_dwordx4 v[76:79], v7, s[40:43], s69 offen nt
    s_addk_i32 s69, 14336
    v_and_b32_dpp v36, v239, v16 row_newbcast:0 row_mask:0xf bank_mask:0xf
    v_and_b32_dpp v37, v239, v17 row_newbcast:0 row_mask:0xf bank_mask:0xf
    v_and_b32_dpp v38, v239, v18 row_newbcast:0 row_mask:0xf bank_mask:0xf
    v_and_b32_dpp v39, v239, v19 row_newbcast:0 row_mask:0xf bank_mask:0xf
    s_waitcnt vmcnt(6)
    s_nop 0
    v_mfma_f32_16x16x32_bf16 v[20:23], v[36:39], v[212:215], v[20:23]
    s_bitcmp0_b32 s97, 0
    s_cbranch_scc0 L_de246
    s_waitcnt vmcnt(5)
L_de246:
    buffer_load_dwordx4 v[80:83], v7, s[40:43], s69 offen nt
    s_addk_i32 s69, 14336
    v_and_b32_dpp v32, v239, v16 row_newbcast:4 row_mask:0xf bank_mask:0xf
    v_and_b32_dpp v33, v239, v17 row_newbcast:4 row_mask:0xf bank_mask:0xf
    v_and_b32_dpp v34, v239, v18 row_newbcast:4 row_mask:0xf bank_mask:0xf
    v_and_b32_dpp v35, v239, v19 row_newbcast:4 row_mask:0xf bank_mask:0xf
    s_waitcnt vmcnt(6)
    s_nop 0
    v_mfma_f32_16x16x32_bf16 v[20:23], v[32:35], v[56:59], v[20:23]
    buffer_load_dwordx4 v[84:87], v7, s[40:43], s69 offen nt
    s_addk_i32 s69, 14336
    v_and_b32_dpp v36, v239, v16 row_newbcast:8 row_mask:0xf bank_mask:0xf
    v_and_b32_dpp v37, v239, v17 row_newbcast:8 row_mask:0xf bank_mask:0xf
    v_and_b32_dpp v38, v239, v18 row_newbcast:8 row_mask:0xf bank_mask:0xf
    v_and_b32_dpp v39, v239, v19 row_newbcast:8 row_mask:0xf bank_mask:0xf
    s_waitcnt vmcnt(6)
    s_nop 0
    v_mfma_f32_16x16x32_bf16 v[20:23], v[36:39], v[60:63], v[20:23]
    s_bitcmp0_b32 s97, 0
    s_cbranch_scc0 L_de248
    s_waitcnt vmcnt(5)
L_de248:
    buffer_load_dwordx4 v[88:91], v7, s[40:43], s69 offen nt
    s_addk_i32 s69, 14336
    v_and_b32_dpp v32, v239, v16 row_newbcast:12 row_mask:0xf bank_mask:0xf
    v_and_b32_dpp v33, v239, v17 row_newbcast:12 row_mask:0xf bank_mask:0xf
    v_and_b32_dpp v34, v239, v18 row_newbcast:12 row_mask:0xf bank_mask:0xf
    v_and_b32_dpp v35, v239, v19 row_newbcast:12 row_mask:0xf bank_mask:0xf
    s_waitcnt vmcnt(6)
    s_nop 0
    v_mfma_f32_16x16x32_bf16 v[20:23], v[32:35], v[64:67], v[20:23]
    buffer_load_dwordx4 v[92:95], v7, s[40:43], s69 offen nt
    s_addk_i32 s69, 14336
    v_and_b32_dpp v36, v240, v16 row_newbcast:0 row_mask:0xf bank_mask:0xf
    v_and_b32_dpp v37, v240, v17 row_newbcast:0 row_mask:0xf bank_mask:0xf
    v_and_b32_dpp v38, v240, v18 row_newbcast:0 row_mask:0xf bank_mask:0xf
    v_and_b32_dpp v39, v240, v19 row_newbcast:0 row_mask:0xf bank_mask:0xf
    s_waitcnt vmcnt(6)
    s_nop 0
    v_mfma_f32_16x16x32_bf16 v[20:23], v[36:39], v[68:71], v[20:23]
    s_bitcmp0_b32 s97, 0
    s_cbranch_scc0 L_de250
    s_waitcnt vmcnt(5)
L_de250:
    buffer_load_dwordx4 v[96:99], v7, s[40:43], s69 offen nt
    s_addk_i32 s69, 14336
    v_and_b32_dpp v32, v240, v16 row_newbcast:4 row_mask:0xf bank_mask:0xf
    v_and_b32_dpp v33, v240, v17 row_newbcast:4 row_mask:0xf bank_mask:0xf
    v_and_b32_dpp v34, v240, v18 row_newbcast:4 row_mask:0xf bank_mask:0xf
    v_and_b32_dpp v35, v240, v19 row_newbcast:4 row_mask:0xf bank_mask:0xf
    s_waitcnt vmcnt(6)
    s_nop 0
    v_mfma_f32_16x16x32_bf16 v[20:23], v[32:35], v[72:75], v[20:23]
    buffer_load_dwordx4 v[100:103], v7, s[40:43], s69 offen nt
    s_addk_i32 s69, 14336
    v_and_b32_dpp v36, v240, v16 row_newbcast:8 row_mask:0xf bank_mask:0xf
    v_and_b32_dpp v37, v240, v17 row_newbcast:8 row_mask:0xf bank_mask:0xf
    v_and_b32_dpp v38, v240, v18 row_newbcast:8 row_mask:0xf bank_mask:0xf
    v_and_b32_dpp v39, v240, v19 row_newbcast:8 row_mask:0xf bank_mask:0xf
    s_waitcnt vmcnt(6)
    s_nop 0
    v_mfma_f32_16x16x32_bf16 v[20:23], v[36:39], v[76:79], v[20:23]
    s_bitcmp0_b32 s97, 0
    s_cbranch_scc0 L_de252
    s_waitcnt vmcnt(5)
L_de252:
    buffer_load_dwordx4 v[104:107], v7, s[40:43], s69 offen nt
    s_addk_i32 s69, 14336
    v_and_b32_dpp v32, v240, v16 row_newbcast:12 row_mask:0xf bank_mask:0xf
    v_and_b32_dpp v33, v240, v17 row_newbcast:12 row_mask:0xf bank_mask:0xf
    v_and_b32_dpp v34, v240, v18 row_newbcast:12 row_mask:0xf bank_mask:0xf
    v_and_b32_dpp v35, v240, v19 row_newbcast:12 row_mask:0xf bank_mask:0xf
    s_waitcnt vmcnt(6)
    s_nop 0
    v_mfma_f32_16x16x32_bf16 v[20:23], v[32:35], v[80:83], v[20:23]
    buffer_load_dwordx4 v[108:111], v7, s[40:43], s69 offen nt
    s_addk_i32 s69, 14336
    v_and_b32_dpp v36, v241, v16 row_newbcast:0 row_mask:0xf bank_mask:0xf
    v_and_b32_dpp v37, v241, v17 row_newbcast:0 row_mask:0xf bank_mask:0xf
    v_and_b32_dpp v38, v241, v18 row_newbcast:0 row_mask:0xf bank_mask:0xf
    v_and_b32_dpp v39, v241, v19 row_newbcast:0 row_mask:0xf bank_mask:0xf
    s_waitcnt vmcnt(6)
    s_nop 0
    v_mfma_f32_16x16x32_bf16 v[20:23], v[36:39], v[84:87], v[20:23]
    s_bitcmp0_b32 s97, 0
    s_cbranch_scc0 L_de254
    s_waitcnt vmcnt(5)
L_de254:
    buffer_load_dwordx4 v[112:115], v7, s[40:43], s69 offen nt
    s_addk_i32 s69, 14336
    v_and_b32_dpp v32, v241, v16 row_newbcast:4 row_mask:0xf bank_mask:0xf
    v_and_b32_dpp v33, v241, v17 row_newbcast:4 row_mask:0xf bank_mask:0xf
    v_and_b32_dpp v34, v241, v18 row_newbcast:4 row_mask:0xf bank_mask:0xf
    v_and_b32_dpp v35, v241, v19 row_newbcast:4 row_mask:0xf bank_mask:0xf
    s_waitcnt vmcnt(6)
    s_nop 0
    v_mfma_f32_16x16x32_bf16 v[20:23], v[32:35], v[88:91], v[20:23]
    buffer_load_dwordx4 v[116:119], v7, s[40:43], s69 offen nt
    s_addk_i32 s69, 14336
    v_and_b32_dpp v36, v241, v16 row_newbcast:8 row_mask:0xf bank_mask:0xf
    v_and_b32_dpp v37, v241, v17 row_newbcast:8 row_mask:0xf bank_mask:0xf
    v_and_b32_dpp v38, v241, v18 row_newbcast:8 row_mask:0xf bank_mask:0xf
    v_and_b32_dpp v39, v241, v19 row_newbcast:8 row_mask:0xf bank_mask:0xf
    s_waitcnt vmcnt(6)
    s_nop 0
    v_mfma_f32_16x16x32_bf16 v[20:23], v[36:39], v[92:95], v[20:23]
    s_bitcmp0_b32 s97, 0
    s_cbranch_scc0 L_de256
    s_waitcnt vmcnt(5)
L_de256:
    buffer_load_dwordx4 v[120:123], v7, s[40:43], s69 offen nt
    s_addk_i32 s69, 14336
    v_and_b32_dpp v32, v241, v16 row_newbcast:12 row_mask:0xf bank_mask:0xf
    v_and_b32_dpp v33, v241, v17 row_newbcast:12 row_mask:0xf bank_mask:0xf
    v_and_b32_dpp v34, v241, v18 row_newbcast:12 row_mask:0xf bank_mask:0xf
    v_and_b32_dpp v35, v241, v19 row_newbcast:12 row_mask:0xf bank_mask:0xf
    s_waitcnt vmcnt(6)
    s_nop 0
    v_mfma_f32_16x16x32_bf16 v[20:23], v[32:35], v[96:99], v[20:23]
    buffer_load_dwordx4 v[124:127], v7, s[40:43], s69 offen nt
    s_addk_i32 s69, 14336
    v_and_b32_dpp v36, v242, v16 row_newbcast:0 row_mask:0xf bank_mask:0xf
    v_and_b32_dpp v37, v242, v17 row_newbcast:0 row_mask:0xf bank_mask:0xf
    v_and_b32_dpp v38, v242, v18 row_newbcast:0 row_mask:0xf bank_mask:0xf
    v_and_b32_dpp v39, v242, v19 row_newbcast:0 row_mask:0xf bank_mask:0xf
    s_waitcnt vmcnt(6)
    s_nop 0
    v_mfma_f32_16x16x32_bf16 v[20:23], v[36:39], v[100:103], v[20:23]
    buffer_load_dwordx4 v[128:131], v7, s[40:43], s69 offen nt
    s_addk_i32 s69, 14336
    v_and_b32_dpp v32, v242, v16 row_newbcast:4 row_mask:0xf bank_mask:0xf
    v_and_b32_dpp v33, v242, v17 row_newbcast:4 row_mask:0xf bank_mask:0xf
    v_and_b32_dpp v34, v242, v18 row_newbcast:4 row_mask:0xf bank_mask:0xf
    v_and_b32_dpp v35, v242, v19 row_newbcast:4 row_mask:0xf bank_mask:0xf
    s_waitcnt vmcnt(6)
    s_nop 0
    v_mfma_f32_16x16x32_bf16 v[20:23], v[32:35], v[104:107], v[20:23]
    buffer_load_dwordx4 v[132:135], v7, s[40:43], s69 offen nt
    s_addk_i32 s69, 14336
    v_and_b32_dpp v36, v242, v16 row_newbcast:8 row_mask:0xf bank_mask:0xf
    v_and_b32_dpp v37, v242, v17 row_newbcast:8 row_mask:0xf bank_mask:0xf
    v_and_b32_dpp v38, v242, v18 row_newbcast:8 row_mask:0xf bank_mask:0xf
    v_and_b32_dpp v39, v242, v19 row_newbcast:8 row_mask:0xf bank_mask:0xf
    s_waitcnt vmcnt(6)
    s_nop 0
    v_mfma_f32_16x16x32_bf16 v[20:23], v[36:39], v[108:111], v[20:23]
    buffer_load_dwordx4 v[136:139], v7, s[40:43], s69 offen nt
    s_addk_i32 s69, 14336
    v_and_b32_dpp v32, v242, v16 row_newbcast:12 row_mask:0xf bank_mask:0xf
    v_and_b32_dpp v33, v242, v17 row_newbcast:12 row_mask:0xf bank_mask:0xf
    v_and_b32_dpp v34, v242, v18 row_newbcast:12 row_mask:0xf bank_mask:0xf
    v_and_b32_dpp v35, v242, v19 row_newbcast:12 row_mask:0xf bank_mask:0xf
    s_waitcnt vmcnt(6)
    s_nop 0
    v_mfma_f32_16x16x32_bf16 v[20:23], v[32:35], v[112:115], v[20:23]
    buffer_load_dwordx4 v[140:143], v7, s[40:43], s69 offen nt
    s_addk_i32 s69, 14336
    v_and_b32_dpp v36, v243, v16 row_newbcast:0 row_mask:0xf bank_mask:0xf
    v_and_b32_dpp v37, v243, v17 row_newbcast:0 row_mask:0xf bank_mask:0xf
    v_and_b32_dpp v38, v243, v18 row_newbcast:0 row_mask:0xf bank_mask:0xf
    v_and_b32_dpp v39, v243, v19 row_newbcast:0 row_mask:0xf bank_mask:0xf
    s_waitcnt vmcnt(6)
    s_nop 0
    v_mfma_f32_16x16x32_bf16 v[20:23], v[36:39], v[116:119], v[20:23]
    buffer_load_dwordx4 v[144:147], v7, s[40:43], s69 offen nt
    s_addk_i32 s69, 14336
    v_and_b32_dpp v32, v243, v16 row_newbcast:4 row_mask:0xf bank_mask:0xf
    v_and_b32_dpp v33, v243, v17 row_newbcast:4 row_mask:0xf bank_mask:0xf
    v_and_b32_dpp v34, v243, v18 row_newbcast:4 row_mask:0xf bank_mask:0xf
    v_and_b32_dpp v35, v243, v19 row_newbcast:4 row_mask:0xf bank_mask:0xf
    s_waitcnt vmcnt(6)
    s_nop 0
    v_mfma_f32_16x16x32_bf16 v[20:23], v[32:35], v[120:123], v[20:23]
    buffer_load_dwordx4 v[148:151], v7, s[40:43], s69 offen nt
    s_addk_i32 s69, 14336
    v_and_b32_dpp v36, v243, v16 row_newbcast:8 row_mask:0xf bank_mask:0xf
    v_and_b32_dpp v37, v243, v17 row_newbcast:8 row_mask:0xf bank_mask:0xf
    v_and_b32_dpp v38, v243, v18 row_newbcast:8 row_mask:0xf bank_mask:0xf
    v_and_b32_dpp v39, v243, v19 row_newbcast:8 row_mask:0xf bank_mask:0xf
    s_waitcnt vmcnt(6)
    s_nop 0
    v_mfma_f32_16x16x32_bf16 v[20:23], v[36:39], v[124:127], v[20:23]
    buffer_load_dwordx4 v[152:155], v7, s[40:43], s69 offen nt
    s_addk_i32 s69, 14336
    buffer_load_dwordx4 v[156:159], v7, s[40:43], s69 offen nt
    s_addk_i32 s69, 14336
    buffer_load_dwordx4 v[160:163], v7, s[40:43], s69 offen nt
    s_addk_i32 s69, 14336
    buffer_load_dwordx4 v[164:167], v7, s[40:43], s69 offen nt
    s_addk_i32 s69, 14336
    v_and_b32_dpp v32, v243, v16 row_newbcast:12 row_mask:0xf bank_mask:0xf
    v_and_b32_dpp v33, v243, v17 row_newbcast:12 row_mask:0xf bank_mask:0xf
    v_and_b32_dpp v34, v243, v18 row_newbcast:12 row_mask:0xf bank_mask:0xf
    v_and_b32_dpp v35, v243, v19 row_newbcast:12 row_mask:0xf bank_mask:0xf
    s_waitcnt vmcnt(9)
    s_nop 0
    v_mfma_f32_16x16x32_bf16 v[20:23], v[32:35], v[128:131], v[20:23]
    buffer_load_dwordx4 v[168:171], v7, s[40:43], s69 offen nt
    s_addk_i32 s69, 14336
    v_and_b32_dpp v36, v244, v16 row_newbcast:0 row_mask:0xf bank_mask:0xf
    v_and_b32_dpp v37, v244, v17 row_newbcast:0 row_mask:0xf bank_mask:0xf
    v_and_b32_dpp v38, v244, v18 row_newbcast:0 row_mask:0xf bank_mask:0xf
    v_and_b32_dpp v39, v244, v19 row_newbcast:0 row_mask:0xf bank_mask:0xf
    s_waitcnt vmcnt(9)
    s_nop 0
    v_mfma_f32_16x16x32_bf16 v[20:23], v[36:39], v[132:135], v[20:23]
    buffer_load_dwordx4 v[172:175], v7, s[40:43], s69 offen nt
    s_addk_i32 s69, 14336
    v_and_b32_dpp v32, v244, v16 row_newbcast:4 row_mask:0xf bank_mask:0xf
    v_and_b32_dpp v33, v244, v17 row_newbcast:4 row_mask:0xf bank_mask:0xf
    v_and_b32_dpp v34, v244, v18 row_newbcast:4 row_mask:0xf bank_mask:0xf
    v_and_b32_dpp v35, v244, v19 row_newbcast:4 row_mask:0xf bank_mask:0xf
    s_waitcnt vmcnt(9)
    s_nop 0
    v_mfma_f32_16x16x32_bf16 v[20:23], v[32:35], v[136:139], v[20:23]
    buffer_load_dwordx4 v[176:179], v7, s[40:43], s69 offen nt
    s_addk_i32 s69, 14336
    v_and_b32_dpp v36, v244, v16 row_newbcast:8 row_mask:0xf bank_mask:0xf
    v_and_b32_dpp v37, v244, v17 row_newbcast:8 row_mask:0xf bank_mask:0xf
    v_and_b32_dpp v38, v244, v18 row_newbcast:8 row_mask:0xf bank_mask:0xf
    v_and_b32_dpp v39, v244, v19 row_newbcast:8 row_mask:0xf bank_mask:0xf
    s_waitcnt vmcnt(9)
    s_nop 0
    v_mfma_f32_16x16x32_bf16 v[20:23], v[36:39], v[140:143], v[20:23]
    buffer_load_dwordx4 v[180:183], v7, s[40:43], s69 offen nt
    s_addk_i32 s69, 14336
    v_and_b32_dpp v32, v244, v16 row_newbcast:12 row_mask:0xf bank_mask:0xf
    v_and_b32_dpp v33, v244, v17 row_newbcast:12 row_mask:0xf bank_mask:0xf
    v_and_b32_dpp v34, v244, v18 row_newbcast:12 row_mask:0xf bank_mask:0xf
    v_and_b32_dpp v35, v244, v19 row_newbcast:12 row_mask:0xf bank_mask:0xf
    s_waitcnt vmcnt(9)
    s_nop 0
    v_mfma_f32_16x16x32_bf16 v[20:23], v[32:35], v[144:147], v[20:23]
    buffer_load_dwordx4 v[184:187], v7, s[40:43], s69 offen nt
    s_addk_i32 s69, 14336
    v_and_b32_dpp v36, v245, v16 row_newbcast:0 row_mask:0xf bank_mask:0xf
    v_and_b32_dpp v37, v245, v17 row_newbcast:0 row_mask:0xf bank_mask:0xf
    v_and_b32_dpp v38, v245, v18 row_newbcast:0 row_mask:0xf bank_mask:0xf
    v_and_b32_dpp v39, v245, v19 row_newbcast:0 row_mask:0xf bank_mask:0xf
    s_waitcnt vmcnt(9)
    s_nop 0
    v_mfma_f32_16x16x32_bf16 v[20:23], v[36:39], v[148:151], v[20:23]
    buffer_load_dwordx4 v[188:191], v7, s[40:43], s69 offen nt
    s_addk_i32 s69, 14336
    v_and_b32_dpp v32, v245, v16 row_newbcast:4 row_mask:0xf bank_mask:0xf
    v_and_b32_dpp v33, v245, v17 row_newbcast:4 row_mask:0xf bank_mask:0xf
    v_and_b32_dpp v34, v245, v18 row_newbcast:4 row_mask:0xf bank_mask:0xf
    v_and_b32_dpp v35, v245, v19 row_newbcast:4 row_mask:0xf bank_mask:0xf
    s_waitcnt vmcnt(9)
    s_nop 0
    v_mfma_f32_16x16x32_bf16 v[20:23], v[32:35], v[152:155], v[20:23]
    buffer_load_dwordx4 v[192:195], v7, s[40:43], s69 offen nt
    s_addk_i32 s69, 14336
    v_and_b32_dpp v36, v245, v16 row_newbcast:8 row_mask:0xf bank_mask:0xf
    v_and_b32_dpp v37, v245, v17 row_newbcast:8 row_mask:0xf bank_mask:0xf
    v_and_b32_dpp v38, v245, v18 row_newbcast:8 row_mask:0xf bank_mask:0xf
    v_and_b32_dpp v39, v245, v19 row_newbcast:8 row_mask:0xf bank_mask:0xf
    s_waitcnt vmcnt(9)
    s_nop 0
    v_mfma_f32_16x16x32_bf16 v[20:23], v[36:39], v[156:159], v[20:23]
    buffer_load_dwordx4 v[196:199], v7, s[40:43], s69 offen nt
    s_addk_i32 s69, 14336
    v_and_b32_dpp v32, v245, v16 row_newbcast:12 row_mask:0xf bank_mask:0xf
    v_and_b32_dpp v33, v245, v17 row_newbcast:12 row_mask:0xf bank_mask:0xf
    v_and_b32_dpp v34, v245, v18 row_newbcast:12 row_mask:0xf bank_mask:0xf
    v_and_b32_dpp v35, v245, v19 row_newbcast:12 row_mask:0xf bank_mask:0xf
    s_waitcnt vmcnt(9)
    s_nop 0
    v_mfma_f32_16x16x32_bf16 v[20:23], v[32:35], v[160:163], v[20:23]
    buffer_load_dwordx4 v[200:203], v7, s[40:43], s69 offen nt
    s_addk_i32 s69, 14336
    v_and_b32_dpp v36, v246, v16 row_newbcast:0 row_mask:0xf bank_mask:0xf
    v_and_b32_dpp v37, v246, v17 row_newbcast:0 row_mask:0xf bank_mask:0xf
    v_and_b32_dpp v38, v246, v18 row_newbcast:0 row_mask:0xf bank_mask:0xf
    v_and_b32_dpp v39, v246, v19 row_newbcast:0 row_mask:0xf bank_mask:0xf
    s_waitcnt vmcnt(9)
    s_nop 0
    v_mfma_f32_16x16x32_bf16 v[20:23], v[36:39], v[164:167], v[20:23]
    buffer_load_dwordx4 v[204:207], v7, s[40:43], s69 offen nt
    s_addk_i32 s69, 14336
    s_mov_b32 exec_hi, 0
    s_mov_b32 exec_lo, 1
    ds_write_b32 v12, v12 offset:544
    s_mov_b64 exec, -1
    v_and_b32_dpp v32, v246, v16 row_newbcast:4 row_mask:0xf bank_mask:0xf
    v_and_b32_dpp v33, v246, v17 row_newbcast:4 row_mask:0xf bank_mask:0xf
    v_and_b32_dpp v34, v246, v18 row_newbcast:4 row_mask:0xf bank_mask:0xf
    v_and_b32_dpp v35, v246, v19 row_newbcast:4 row_mask:0xf bank_mask:0xf
    s_waitcnt vmcnt(9)
    s_nop 0
    v_mfma_f32_16x16x32_bf16 v[20:23], v[32:35], v[168:171], v[20:23]
    buffer_load_dwordx4 v[208:211], v7, s[40:43], s69 offen nt
    s_addk_i32 s69, 14336
    v_and_b32_dpp v36, v246, v16 row_newbcast:8 row_mask:0xf bank_mask:0xf
    v_and_b32_dpp v37, v246, v17 row_newbcast:8 row_mask:0xf bank_mask:0xf
    v_and_b32_dpp v38, v246, v18 row_newbcast:8 row_mask:0xf bank_mask:0xf
    v_and_b32_dpp v39, v246, v19 row_newbcast:8 row_mask:0xf bank_mask:0xf
    s_waitcnt vmcnt(9)
    s_nop 0
    v_mfma_f32_16x16x32_bf16 v[20:23], v[36:39], v[172:175], v[20:23]
    buffer_load_dwordx4 v[212:215], v7, s[40:43], s69 offen nt
    s_addk_i32 s69, 14336
    v_and_b32_dpp v32, v246, v16 row_newbcast:12 row_mask:0xf bank_mask:0xf
    v_and_b32_dpp v33, v246, v17 row_newbcast:12 row_mask:0xf bank_mask:0xf
    v_and_b32_dpp v34, v246, v18 row_newbcast:12 row_mask:0xf bank_mask:0xf
    v_and_b32_dpp v35, v246, v19 row_newbcast:12 row_mask:0xf bank_mask:0xf
    s_waitcnt vmcnt(9)
    s_nop 0
    v_mfma_f32_16x16x32_bf16 v[20:23], v[32:35], v[176:179], v[20:23]
    buffer_load_dwordx4 v[56:59], v7, s[40:43], s69 offen nt
    s_addk_i32 s69, 14336
    v_and_b32_dpp v36, v247, v16 row_newbcast:0 row_mask:0xf bank_mask:0xf
    v_and_b32_dpp v37, v247, v17 row_newbcast:0 row_mask:0xf bank_mask:0xf
    v_and_b32_dpp v38, v247, v18 row_newbcast:0 row_mask:0xf bank_mask:0xf
    v_and_b32_dpp v39, v247, v19 row_newbcast:0 row_mask:0xf bank_mask:0xf
    s_waitcnt vmcnt(9)
    s_nop 0
    v_mfma_f32_16x16x32_bf16 v[20:23], v[36:39], v[180:183], v[20:23]
    buffer_load_dwordx4 v[60:63], v7, s[40:43], s69 offen nt
    s_addk_i32 s69, 14336
    v_and_b32_dpp v32, v247, v16 row_newbcast:4 row_mask:0xf bank_mask:0xf
    v_and_b32_dpp v33, v247, v17 row_newbcast:4 row_mask:0xf bank_mask:0xf
    v_and_b32_dpp v34, v247, v18 row_newbcast:4 row_mask:0xf bank_mask:0xf
    v_and_b32_dpp v35, v247, v19 row_newbcast:4 row_mask:0xf bank_mask:0xf
    s_waitcnt vmcnt(9)
    s_nop 0
    v_mfma_f32_16x16x32_bf16 v[20:23], v[32:35], v[184:187], v[20:23]
    buffer_load_dwordx4 v[64:67], v7, s[40:43], s69 offen nt
    s_addk_i32 s69, 14336
    v_and_b32_dpp v36, v247, v16 row_newbcast:8 row_mask:0xf bank_mask:0xf
    v_and_b32_dpp v37, v247, v17 row_newbcast:8 row_mask:0xf bank_mask:0xf
    v_and_b32_dpp v38, v247, v18 row_newbcast:8 row_mask:0xf bank_mask:0xf
    v_and_b32_dpp v39, v247, v19 row_newbcast:8 row_mask:0xf bank_mask:0xf
    s_waitcnt vmcnt(9)
    s_nop 0
    v_mfma_f32_16x16x32_bf16 v[20:23], v[36:39], v[188:191], v[20:23]
    buffer_load_dwordx4 v[68:71], v7, s[40:43], s69 offen nt
    s_addk_i32 s69, 14336
    v_and_b32_dpp v32, v247, v16 row_newbcast:12 row_mask:0xf bank_mask:0xf
    v_and_b32_dpp v33, v247, v17 row_newbcast:12 row_mask:0xf bank_mask:0xf
    v_and_b32_dpp v34, v247, v18 row_newbcast:12 row_mask:0xf bank_mask:0xf
    v_and_b32_dpp v35, v247, v19 row_newbcast:12 row_mask:0xf bank_mask:0xf
    s_waitcnt vmcnt(9)
    s_nop 0
    v_mfma_f32_16x16x32_bf16 v[20:23], v[32:35], v[192:195], v[20:23]
    buffer_load_dwordx4 v[72:75], v7, s[40:43], s69 offen nt
    s_addk_i32 s69, 14336
    v_and_b32_dpp v36, v248, v16 row_newbcast:0 row_mask:0xf bank_mask:0xf
    v_and_b32_dpp v37, v248, v17 row_newbcast:0 row_mask:0xf bank_mask:0xf
    v_and_b32_dpp v38, v248, v18 row_newbcast:0 row_mask:0xf bank_mask:0xf
    v_and_b32_dpp v39, v248, v19 row_newbcast:0 row_mask:0xf bank_mask:0xf
    s_waitcnt vmcnt(9)
    s_nop 0
    v_mfma_f32_16x16x32_bf16 v[20:23], v[36:39], v[196:199], v[20:23]
    buffer_load_dwordx4 v[76:79], v7, s[40:43], s69 offen nt
    s_addk_i32 s69, 14336
    v_and_b32_dpp v32, v248, v16 row_newbcast:4 row_mask:0xf bank_mask:0xf
    v_and_b32_dpp v33, v248, v17 row_newbcast:4 row_mask:0xf bank_mask:0xf
    v_and_b32_dpp v34, v248, v18 row_newbcast:4 row_mask:0xf bank_mask:0xf
    v_and_b32_dpp v35, v248, v19 row_newbcast:4 row_mask:0xf bank_mask:0xf
    s_waitcnt vmcnt(9)
    s_nop 0
    v_mfma_f32_16x16x32_bf16 v[20:23], v[32:35], v[200:203], v[20:23]
    buffer_load_dwordx4 v[80:83], v7, s[40:43], s69 offen nt
    s_addk_i32 s69, 14336
    v_and_b32_dpp v36, v248, v16 row_newbcast:8 row_mask:0xf bank_mask:0xf
    v_and_b32_dpp v37, v248, v17 row_newbcast:8 row_mask:0xf bank_mask:0xf
    v_and_b32_dpp v38, v248, v18 row_newbcast:8 row_mask:0xf bank_mask:0xf
    v_and_b32_dpp v39, v248, v19 row_newbcast:8 row_mask:0xf bank_mask:0xf
    s_waitcnt vmcnt(9)
    s_nop 0
    v_mfma_f32_16x16x32_bf16 v[20:23], v[36:39], v[204:207], v[20:23]
    buffer_load_dwordx4 v[84:87], v7, s[40:43], s69 offen nt
    s_addk_i32 s69, 14336
    v_and_b32_dpp v32, v248, v16 row_newbcast:12 row_mask:0xf bank_mask:0xf
    v_and_b32_dpp v33, v248, v17 row_newbcast:12 row_mask:0xf bank_mask:0xf
    v_and_b32_dpp v34, v248, v18 row_newbcast:12 row_mask:0xf bank_mask:0xf
    v_and_b32_dpp v35, v248, v19 row_newbcast:12 row_mask:0xf bank_mask:0xf
    s_waitcnt vmcnt(9)
    s_nop 0
    v_mfma_f32_16x16x32_bf16 v[20:23], v[32:35], v[208:211], v[20:23]
    buffer_load_dwordx4 v[88:91], v7, s[40:43], s69 offen nt
    s_addk_i32 s69, 14336
    v_and_b32_dpp v36, v249, v16 row_newbcast:0 row_mask:0xf bank_mask:0xf
    v_and_b32_dpp v37, v249, v17 row_newbcast:0 row_mask:0xf bank_mask:0xf
    v_and_b32_dpp v38, v249, v18 row_newbcast:0 row_mask:0xf bank_mask:0xf
    v_and_b32_dpp v39, v249, v19 row_newbcast:0 row_mask:0xf bank_mask:0xf
    s_waitcnt vmcnt(9)
    s_nop 0
    v_mfma_f32_16x16x32_bf16 v[20:23], v[36:39], v[212:215], v[20:23]
    buffer_load_dwordx4 v[92:95], v7, s[40:43], s69 offen nt
    s_addk_i32 s69, 14336
    v_and_b32_dpp v32, v249, v16 row_newbcast:4 row_mask:0xf bank_mask:0xf
    v_and_b32_dpp v33, v249, v17 row_newbcast:4 row_mask:0xf bank_mask:0xf
    v_and_b32_dpp v34, v249, v18 row_newbcast:4 row_mask:0xf bank_mask:0xf
    v_and_b32_dpp v35, v249, v19 row_newbcast:4 row_mask:0xf bank_mask:0xf
    s_waitcnt vmcnt(9)
    s_nop 0
    v_mfma_f32_16x16x32_bf16 v[20:23], v[32:35], v[56:59], v[20:23]
    buffer_load_dwordx4 v[96:99], v7, s[40:43], s69 offen nt
    s_addk_i32 s69, 14336
    v_and_b32_dpp v36, v249, v16 row_newbcast:8 row_mask:0xf bank_mask:0xf
    v_and_b32_dpp v37, v249, v17 row_newbcast:8 row_mask:0xf bank_mask:0xf
    v_and_b32_dpp v38, v249, v18 row_newbcast:8 row_mask:0xf bank_mask:0xf
    v_and_b32_dpp v39, v249, v19 row_newbcast:8 row_mask:0xf bank_mask:0xf
    s_waitcnt vmcnt(9)
    s_nop 0
    v_mfma_f32_16x16x32_bf16 v[20:23], v[36:39], v[60:63], v[20:23]
    buffer_load_dwordx4 v[100:103], v7, s[40:43], s69 offen nt
    s_addk_i32 s69, 14336
    v_and_b32_dpp v32, v249, v16 row_newbcast:12 row_mask:0xf bank_mask:0xf
    v_and_b32_dpp v33, v249, v17 row_newbcast:12 row_mask:0xf bank_mask:0xf
    v_and_b32_dpp v34, v249, v18 row_newbcast:12 row_mask:0xf bank_mask:0xf
    v_and_b32_dpp v35, v249, v19 row_newbcast:12 row_mask:0xf bank_mask:0xf
    s_waitcnt vmcnt(9)
    s_nop 0
    v_mfma_f32_16x16x32_bf16 v[20:23], v[32:35], v[64:67], v[20:23]
    buffer_load_dwordx4 v[104:107], v7, s[40:43], s69 offen nt
    s_addk_i32 s69, 14336
    v_and_b32_dpp v36, v250, v16 row_newbcast:0 row_mask:0xf bank_mask:0xf
    v_and_b32_dpp v37, v250, v17 row_newbcast:0 row_mask:0xf bank_mask:0xf
    v_and_b32_dpp v38, v250, v18 row_newbcast:0 row_mask:0xf bank_mask:0xf
    v_and_b32_dpp v39, v250, v19 row_newbcast:0 row_mask:0xf bank_mask:0xf
    s_waitcnt vmcnt(9)
    s_nop 0
    v_mfma_f32_16x16x32_bf16 v[20:23], v[36:39], v[68:71], v[20:23]
    buffer_load_dwordx4 v[108:111], v7, s[40:43], s69 offen nt
    s_addk_i32 s69, 14336
    v_and_b32_dpp v32, v250, v16 row_newbcast:4 row_mask:0xf bank_mask:0xf
    v_and_b32_dpp v33, v250, v17 row_newbcast:4 row_mask:0xf bank_mask:0xf
    v_and_b32_dpp v34, v250, v18 row_newbcast:4 row_mask:0xf bank_mask:0xf
    v_and_b32_dpp v35, v250, v19 row_newbcast:4 row_mask:0xf bank_mask:0xf
    s_waitcnt vmcnt(9)
    s_nop 0
    v_mfma_f32_16x16x32_bf16 v[20:23], v[32:35], v[72:75], v[20:23]
    v_and_b32_dpp v36, v250, v16 row_newbcast:8 row_mask:0xf bank_mask:0xf
    v_and_b32_dpp v37, v250, v17 row_newbcast:8 row_mask:0xf bank_mask:0xf
    v_and_b32_dpp v38, v250, v18 row_newbcast:8 row_mask:0xf bank_mask:0xf
    v_and_b32_dpp v39, v250, v19 row_newbcast:8 row_mask:0xf bank_mask:0xf
    s_waitcnt vmcnt(8)
    s_nop 0
    v_mfma_f32_16x16x32_bf16 v[20:23], v[36:39], v[76:79], v[20:23]
    v_and_b32_dpp v32, v250, v16 row_newbcast:12 row_mask:0xf bank_mask:0xf
    v_and_b32_dpp v33, v250, v17 row_newbcast:12 row_mask:0xf bank_mask:0xf
    v_and_b32_dpp v34, v250, v18 row_newbcast:12 row_mask:0xf bank_mask:0xf
    v_and_b32_dpp v35, v250, v19 row_newbcast:12 row_mask:0xf bank_mask:0xf
    s_waitcnt vmcnt(7)
    s_nop 0
    v_mfma_f32_16x16x32_bf16 v[20:23], v[32:35], v[80:83], v[20:23]
    v_and_b32_dpp v36, v251, v16 row_newbcast:0 row_mask:0xf bank_mask:0xf
    v_and_b32_dpp v37, v251, v17 row_newbcast:0 row_mask:0xf bank_mask:0xf
    v_and_b32_dpp v38, v251, v18 row_newbcast:0 row_mask:0xf bank_mask:0xf
    v_and_b32_dpp v39, v251, v19 row_newbcast:0 row_mask:0xf bank_mask:0xf
    s_waitcnt vmcnt(6)
    s_nop 0
    v_mfma_f32_16x16x32_bf16 v[20:23], v[36:39], v[84:87], v[20:23]
    v_and_b32_dpp v32, v251, v16 row_newbcast:4 row_mask:0xf bank_mask:0xf
    v_and_b32_dpp v33, v251, v17 row_newbcast:4 row_mask:0xf bank_mask:0xf
    v_and_b32_dpp v34, v251, v18 row_newbcast:4 row_mask:0xf bank_mask:0xf
    v_and_b32_dpp v35, v251, v19 row_newbcast:4 row_mask:0xf bank_mask:0xf
    s_waitcnt vmcnt(5)
    s_nop 0
    v_mfma_f32_16x16x32_bf16 v[20:23], v[32:35], v[88:91], v[20:23]
    v_and_b32_dpp v36, v251, v16 row_newbcast:8 row_mask:0xf bank_mask:0xf
    v_and_b32_dpp v37, v251, v17 row_newbcast:8 row_mask:0xf bank_mask:0xf
    v_and_b32_dpp v38, v251, v18 row_newbcast:8 row_mask:0xf bank_mask:0xf
    v_and_b32_dpp v39, v251, v19 row_newbcast:8 row_mask:0xf bank_mask:0xf
    s_waitcnt vmcnt(4)
    s_nop 0
    v_mfma_f32_16x16x32_bf16 v[20:23], v[36:39], v[92:95], v[20:23]
    v_and_b32_dpp v32, v251, v16 row_newbcast:12 row_mask:0xf bank_mask:0xf
    v_and_b32_dpp v33, v251, v17 row_newbcast:12 row_mask:0xf bank_mask:0xf
    v_and_b32_dpp v34, v251, v18 row_newbcast:12 row_mask:0xf bank_mask:0xf
    v_and_b32_dpp v35, v251, v19 row_newbcast:12 row_mask:0xf bank_mask:0xf
    s_waitcnt vmcnt(3)
    s_nop 0
    v_mfma_f32_16x16x32_bf16 v[20:23], v[32:35], v[96:99], v[20:23]
    v_and_b32_dpp v36, v252, v16 row_newbcast:0 row_mask:0xf bank_mask:0xf
    v_and_b32_dpp v37, v252, v17 row_newbcast:0 row_mask:0xf bank_mask:0xf
    v_and_b32_dpp v38, v252, v18 row_newbcast:0 row_mask:0xf bank_mask:0xf
    v_and_b32_dpp v39, v252, v19 row_newbcast:0 row_mask:0xf bank_mask:0xf
    s_waitcnt vmcnt(2)
    s_nop 0
    v_mfma_f32_16x16x32_bf16 v[20:23], v[36:39], v[100:103], v[20:23]
    v_and_b32_dpp v32, v252, v16 row_newbcast:4 row_mask:0xf bank_mask:0xf
    v_and_b32_dpp v33, v252, v17 row_newbcast:4 row_mask:0xf bank_mask:0xf
    v_and_b32_dpp v34, v252, v18 row_newbcast:4 row_mask:0xf bank_mask:0xf
    v_and_b32_dpp v35, v252, v19 row_newbcast:4 row_mask:0xf bank_mask:0xf
    s_waitcnt vmcnt(1)
    s_nop 0
    v_mfma_f32_16x16x32_bf16 v[20:23], v[32:35], v[104:107], v[20:23]
    v_and_b32_dpp v36, v252, v16 row_newbcast:8 row_mask:0xf bank_mask:0xf
    v_and_b32_dpp v37, v252, v17 row_newbcast:8 row_mask:0xf bank_mask:0xf
    v_and_b32_dpp v38, v252, v18 row_newbcast:8 row_mask:0xf bank_mask:0xf
    v_and_b32_dpp v39, v252, v19 row_newbcast:8 row_mask:0xf bank_mask:0xf
    s_waitcnt vmcnt(0)
    s_nop 0
    v_mfma_f32_16x16x32_bf16 v[20:23], v[36:39], v[108:111], v[20:23]
    s_mov_b32 exec_hi, 0
    s_nop 6
    ds_write_b128 v11, v[20:23] offset:1024
    s_waitcnt lgkmcnt(0)
    s_barrier
    s_barrier
    s_endpgm
L_helper:
    s_sub_u32 s30, s28, 4
    v_mov_b32 v240, 0
    v_lshlrev_b32 v241, 4, v0
    v_lshlrev_b32 v242, 3, v0
    s_mov_b32 s78, 0
    s_lshl_b32 s64, s32, 14
    s_cmp_eq_u32 s30, 0
    s_cbranch_scc0 L_h_rest
    v_and_b32 v4, 31, v0
    v_lshrrev_b32 v5, 5, v0
    v_mul_u32_u24 v5, 1152, v5
    v_lshl_add_u32 v8, v4, 4, v5
    v_cmp_gt_u32 vcc, 8, v4
    v_mov_b32 v5, 0x80000000
    s_nop 0
    v_cndmask_b32 v9, v5, v8, vcc
    s_mul_i32 s35, s33, 72
    v_lshl_add_u32 v4, v3, 2, v2
    v_add_u32 v4, s35, v4
    v_lshlrev_b32 v10, 1, v4
    v_lshlrev_b32 v4, 13, v2
    v_lshl_add_u32 v11, v3, 4, v4
    s_lshl_b32 s70, s35, 13
    s_lshl_b32 s3, s32, 8
    s_waitcnt lgkmcnt(0)
    s_load_dword s96, s[26:27], 720896
    s_mov_b32 s48, s4
    s_mov_b32 s49, s5
    s_mov_b32 s50, 2304
    s_mov_b32 s51, 0x20000
    s_add_u32 s44, s10, s3
    s_addc_u32 s45, s11, 0
    s_sub_u32 s46, 4718592, s3
    s_mov_b32 s47, 0x20000
    buffer_load_dwordx4 v[20:23], v8, s[48:51], 0 offen
    buffer_load_dwordx4 v[24:27], v8, s[48:51], 0 offen offset:512
    buffer_load_dwordx4 v[28:31], v9, s[48:51], 0 offen offset:1024
    buffer_load_ushort v6, v10, s[48:51], 0 offen
    buffer_load_ushort v7, v10, s[48:51], 0 offen offset:128
    buffer_load_ushort v14, v10, s[48:51], 0 offen offset:1152
    buffer_load_ushort v15, v10, s[48:51], 0 offen offset:1280
    buffer_load_dwordx4 v[64:67], v11, s[44:47], s70 offen nt
    s_add_u32 s70, s70, 0x8000
    buffer_load_dwordx4 v[68:71], v11, s[44:47], s70 offen nt
    s_add_u32 s70, s70, 0x8000
    buffer_load_dwordx4 v[72:75], v11, s[44:47], s70 offen nt
    s_add_u32 s70, s70, 0x8000
    buffer_load_dwordx4 v[76:79], v11, s[44:47], s70 offen nt
    s_add_u32 s70, s70, 0x8000
    buffer_load_dwordx4 v[80:83], v11, s[44:47], s70 offen nt
    s_add_u32 s70, s70, 0x8000
    buffer_load_dwordx4 v[84:87], v11, s[44:47], s70 offen nt
    s_add_u32 s70, s70, 0x8000
    buffer_load_dwordx4 v[88:91], v11, s[44:47], s70 offen nt
    s_add_u32 s70, s70, 0x8000
    buffer_load_dwordx4 v[92:95], v11, s[44:47], s70 offen nt
    s_add_u32 s70, s70, 0x8000
    buffer_load_dwordx4 v[96:99], v11, s[44:47], s70 offen nt
    s_add_u32 s70, s70, 0x8000
    buffer_load_dwordx4 v[100:103], v11, s[44:47], s70 offen nt
    s_add_u32 s70, s70, 0x8000
    buffer_load_dwordx4 v[104:107], v11, s[44:47], s70 offen nt
    s_add_u32 s70, s70, 0x8000
    buffer_load_dwordx4 v[108:111], v11, s[44:47], s70 offen nt
    s_add_u32 s70, s70, 0x8000
    buffer_load_dwordx4 v[112:115], v11, s[44:47], s70 offen nt
    s_add_u32 s70, s70, 0x8000
    buffer_load_dwordx4 v[116:119], v11, s[44:47], s70 offen nt
    s_add_u32 s70, s70, 0x8000
    buffer_load_dwordx4 v[120:123], v11, s[44:47], s70 offen nt
    s_add_u32 s70, s70, 0x8000
    buffer_load_dwordx4 v[124:127], v11, s[44:47], s70 offen nt
    s_add_u32 s70, s70, 0x8000
    buffer_load_dwordx4 v[128:131], v11, s[44:47], s70 offen nt
    s_add_u32 s70, s70, 0x8000
    buffer_load_dwordx4 v[132:135], v11, s[44:47], s70 offen nt
    s_cmp_eq_u32 s33, 7
    s_cselect_b32 s69, 16, 8
    s_mul_i32 s34, s32, 147456
    s_mul_i32 s35, s33, 128
    s_add_u32 s34, s34, s35
    s_add_u32 s52, s12, s34
    s_addc_u32 s53, s13, 0
    s_sub_u32 s54, 147456, s35
    s_mov_b32 s55, 0x20000
    s_lshl_b32 s34, s30, 5
    v_lshl_add_u32 v4, v2, 3, s34
    v_mul_u32_u24 v5, 1152, v4
    v_lshl_add_u32 v5, v3, 4, v5
    v_cmp_gt_u32 vcc, s69, v3
    v_mov_b32 v10, 0x80000000
    s_nop 0
    v_cndmask_b32 v243, v10, v5, vcc
    s_mov_b32 s67, 4608
    buffer_load_dwordx4 v[176:179], v243, s[52:55], 0 offen offset:0 nt
    buffer_load_dwordx4 v[180:183], v243, s[52:55], 0 offen offset:1152 nt
    buffer_load_dwordx4 v[184:187], v243, s[52:55], 0 offen offset:2304 nt
    buffer_load_dwordx4 v[188:191], v243, s[52:55], 0 offen offset:3456 nt
    buffer_load_dwordx4 v[192:195], v243, s[52:55], s67 offen offset:0 nt
    buffer_load_dwordx4 v[196:199], v243, s[52:55], s67 offen offset:1152 nt
    buffer_load_dwordx4 v[200:203], v243, s[52:55], s67 offen offset:2304 nt
    buffer_load_dwordx4 v[204:207], v243, s[52:55], s67 offen offset:3456 nt
    s_barrier
    s_mov_b32 s56, s26
    s_mov_b32 s57, s27
    s_mov_b32 s58, 1703936
    s_mov_b32 s59, 0x20000
    v_and_b32 v4, 1, v0
    v_lshlrev_b32 v4, 4, v4
    v_mov_b32 v5, 0xffff
    v_lshlrev_b32 v4, v4, v5
    v_bfe_u32 v5, v0, 1, 2
    v_cmp_eq_u32 vcc, 0, v5
    s_nop 1
    v_cndmask_b32 v16, 0, v4, vcc
    v_cmp_eq_u32 vcc, 1, v5
    s_nop 1
    v_cndmask_b32 v17, 0, v4, vcc
    v_cmp_eq_u32 vcc, 2, v5
    s_nop 1
    v_cndmask_b32 v18, 0, v4, vcc
    v_cmp_eq_u32 vcc, 3, v5
    s_nop 1
    v_cndmask_b32 v19, 0, v4, vcc
    s_lshl_b32 s3, s33, 10
    s_add_u32 s66, s64, s3
    s_add_u32 s66, s66, 1179648
    s_waitcnt vmcnt(26)
    v_lshlrev_b32 v140, 16, v20
    v_and_b32 v141, 0xffff0000, v20
    v_lshlrev_b32 v142, 16, v21
    v_and_b32 v143, 0xffff0000, v21
    v_lshlrev_b32 v144, 16, v22
    v_and_b32 v145, 0xffff0000, v22
    v_lshlrev_b32 v146, 16, v23
    v_and_b32 v147, 0xffff0000, v23
    v_lshlrev_b32 v148, 16, v24
    v_and_b32 v149, 0xffff0000, v24
    v_lshlrev_b32 v150, 16, v25
    v_and_b32 v151, 0xffff0000, v25
    v_lshlrev_b32 v152, 16, v26
    v_and_b32 v153, 0xffff0000, v26
    v_lshlrev_b32 v154, 16, v27
    v_and_b32 v155, 0xffff0000, v27
    v_lshlrev_b32 v156, 16, v28
    v_and_b32 v157, 0xffff0000, v28
    v_lshlrev_b32 v158, 16, v29
    v_and_b32 v159, 0xffff0000, v29
    v_lshlrev_b32 v160, 16, v30
    v_and_b32 v161, 0xffff0000, v30
    v_lshlrev_b32 v162, 16, v31
    v_and_b32 v163, 0xffff0000, v31
    v_add_f32 v32, v140, v141
    v_add_f32 v33, v142, v143
    v_add_f32 v32, v32, v144
    v_add_f32 v33, v33, v145
    v_add_f32 v32, v32, v146
    v_add_f32 v33, v33, v147
    v_add_f32 v32, v32, v148
    v_add_f32 v33, v33, v149
    v_add_f32 v32, v32, v150
    v_add_f32 v33, v33, v151
    v_add_f32 v32, v32, v152
    v_add_f32 v33, v33, v153
    v_add_f32 v32, v32, v154
    v_add_f32 v33, v33, v155
    v_add_f32 v32, v32, v156
    v_add_f32 v33, v33, v157
    v_add_f32 v32, v32, v158
    v_add_f32 v33, v33, v159
    v_add_f32 v32, v32, v160
    v_add_f32 v33, v33, v161
    v_add_f32 v32, v32, v162
    v_add_f32 v33, v33, v163
    v_add_f32 v32, v32, v33
    s_nop 1
    v_add_f32_dpp v32, v32, v32 row_ror:8 row_mask:0xf bank_mask:0xf
    s_nop 1
    v_add_f32_dpp v32, v32, v32 row_ror:4 row_mask:0xf bank_mask:0xf
    s_nop 1
    v_add_f32_dpp v32, v32, v32 row_ror:2 row_mask:0xf bank_mask:0xf
    s_nop 1
    v_add_f32_dpp v32, v32, v32 row_ror:1 row_mask:0xf bank_mask:0xf
    s_nop 1
    v_add_f32_dpp v32, v32, v32 row_bcast:15 row_mask:0xa bank_mask:0xf
    v_mul_f32 v32, 0x3ae38e39, v32
    s_nop 0
    v_readlane_b32 s72, v32, 31
    v_readlane_b32 s75, v32, 63
    s_nop 0
    v_mov_b32 v34, s72
    s_mov_b32 exec_lo, 0
    v_mov_b32 v34, s75
    s_mov_b32 exec_lo, -1
    v_sub_f32 v33, v140, v34
    v_mul_f32 v32, v33, v33
    v_sub_f32 v33, v141, v34
    v_fmac_f32 v32, v33, v33
    v_sub_f32 v33, v142, v34
    v_fmac_f32 v32, v33, v33
    v_sub_f32 v33, v143, v34
    v_fmac_f32 v32, v33, v33
    v_sub_f32 v33, v144, v34
    v_fmac_f32 v32, v33, v33
    v_sub_f32 v33, v145, v34
    v_fmac_f32 v32, v33, v33
    v_sub_f32 v33, v146, v34
    v_fmac_f32 v32, v33, v33
    v_sub_f32 v33, v147, v34
    v_fmac_f32 v32, v33, v33
    v_sub_f32 v33, v148, v34
    v_fmac_f32 v32, v33, v33
    v_sub_f32 v33, v149, v34
    v_fmac_f32 v32, v33, v33
    v_sub_f32 v33, v150, v34
    v_fmac_f32 v32, v33, v33
    v_sub_f32 v33, v151, v34
    v_fmac_f32 v32, v33, v33
    v_sub_f32 v33, v152, v34
    v_fmac_f32 v32, v33, v33
    v_sub_f32 v33, v153, v34
    v_fmac_f32 v32, v33, v33
    v_sub_f32 v33, v154, v34
    v_fmac_f32 v32, v33, v33
    v_sub_f32 v33, v155, v34
    v_fmac_f32 v32, v33, v33
    s_mov_b32 exec_lo, 0xff
    s_mov_b32 exec_hi, 0xff
    v_sub_f32 v33, v156, v34
    v_fmac_f32 v32, v33, v33
    v_sub_f32 v33, v157, v34
    v_fmac_f32 v32, v33, v33
    v_sub_f32 v33, v158, v34
    v_fmac_f32 v32, v33, v33
    v_sub_f32 v33, v159, v34
    v_fmac_f32 v32, v33, v33
    v_sub_f32 v33, v160, v34
    v_fmac_f32 v32, v33, v33
    v_sub_f32 v33, v161, v34
    v_fmac_f32 v32, v33, v33
    v_sub_f32 v33, v162, v34
    v_fmac_f32 v32, v33, v33
    v_sub_f32 v33, v163, v34
    v_fmac_f32 v32, v33, v33
    s_mov_b64 exec, -1
    v_cvt_pk_bf16_f32 v34, v34, v34
    v_and_b32 v34, 0xffff0000, v34
    v_add_f32_dpp v32, v32, v32 row_ror:8 row_mask:0xf bank_mask:0xf
    s_nop 1
    v_add_f32_dpp v32, v32, v32 row_ror:4 row_mask:0xf bank_mask:0xf
    s_nop 1
    v_add_f32_dpp v32, v32, v32 row_ror:2 row_mask:0xf bank_mask:0xf
    s_nop 1
    v_add_f32_dpp v32, v32, v32 row_ror:1 row_mask:0xf bank_mask:0xf
    s_nop 1
    v_add_f32_dpp v32, v32, v32 row_bcast:15 row_mask:0xa bank_mask:0xf
    v_mul_f32 v32, 0x3ae38e39, v32
    v_cvt_pk_bf16_f32 v32, v32, v32
    v_and_b32 v32, 0xffff0000, v32
    v_add_f32 v32, 0x3727c5ac, v32
    v_cvt_pk_bf16_f32 v32, v32, v32
    v_and_b32 v32, 0xffff0000, v32
    v_sqrt_f32 v32, v32
    s_nop 0
    v_cvt_pk_bf16_f32 v32, v32, v32
    v_and_b32 v32, 0xffff0000, v32
    v_rcp_f32 v33, v32
    v_readlane_b32 s72, v34, 31
    v_readlane_b32 s75, v34, 63
    v_readlane_b32 s73, v32, 31
    v_readlane_b32 s76, v32, 63
    v_readlane_b32 s74, v33, 31
    v_readlane_b32 s77, v33, 63
    v_lshlrev_b32 v6, 16, v6
    v_lshlrev_b32 v7, 16, v7
    v_lshlrev_b32 v14, 16, v14
    v_lshlrev_b32 v15, 16, v15
    v_subrev_f32 v6, s72, v6
    v_cvt_pk_bf16_f32 v6, v6, v6
    v_and_b32 v6, 0xffff0000, v6
    v_mul_f32 v32, s74, v6
    v_fma_f32 v33, -v32, s73, v6
    v_fma_f32 v32, v33, s74, v32
    v_cvt_pk_bf16_f32 v6, v32, v32
    v_subrev_f32 v7, s72, v7
    v_cvt_pk_bf16_f32 v7, v7, v7
    v_and_b32 v7, 0xffff0000, v7
    v_mul_f32 v32, s74, v7
    v_fma_f32 v33, -v32, s73, v7
    v_fma_f32 v32, v33, s74, v32
    v_cvt_pk_bf16_f32 v7, v32, v32
    v_subrev_f32 v14, s75, v14
    v_cvt_pk_bf16_f32 v14, v14, v14
    v_and_b32 v14, 0xffff0000, v14
    v_mul_f32 v32, s77, v14
    v_fma_f32 v33, -v32, s76, v14
    v_fma_f32 v32, v33, s77, v32
    v_cvt_pk_bf16_f32 v14, v32, v32
    v_subrev_f32 v15, s75, v15
    v_cvt_pk_bf16_f32 v15, v15, v15
    v_and_b32 v15, 0xffff0000, v15
    v_mul_f32 v32, s77, v15
    v_fma_f32 v33, -v32, s76, v15
    v_fma_f32 v32, v33, s77, v32
    v_cvt_pk_bf16_f32 v15, v32, v32
    s_waitcnt lgkmcnt(0)
    s_lshl_b32 s3, s32, 2
    s_load_dword s74, s[24:25], s3
    s_mul_i32 s96, s96, 1664525
    s_add_u32 s96, s96, 1013904223
    s_and_b32 s3, s96, 0xff
    s_mul_i32 s3, s3, 0x01010101
    s_cmp_eq_u32 s3, s96
    s_cselect_b32 s3, 0x100, 0
    s_xor_b32 s96, s96, s3
    v_mov_b32 v252, s96
    s_mov_b32 s60, 117835008
    s_mov_b32 s61, 117835009
    s_mov_b32 s62, 117835010
    s_mov_b32 s63, 117835011
    s_mov_b32 s97, 0x0c0c0400
    v_mov_b32 v253, 0x04000c0c
    v_mov_b32_dpp v24, v6 row_newbcast:0 row_mask:0xf bank_mask:0x3
    s_nop 1
    v_mov_b32_dpp v24, v14 row_newbcast:0 row_mask:0xf bank_mask:0xc
    v_and_b32 v32, v24, v16
    v_and_b32 v33, v24, v17
    v_and_b32 v34, v24, v18
    v_and_b32 v35, v24, v19
    s_waitcnt vmcnt(25)
    s_nop 0
    v_mfma_f32_16x16x32_bf16 v[20:23], v[32:35], v[64:67], 0
    v_mov_b32_dpp v25, v6 row_newbcast:1 row_mask:0xf bank_mask:0x3
    s_nop 1
    v_mov_b32_dpp v25, v14 row_newbcast:1 row_mask:0xf bank_mask:0xc
    v_and_b32 v36, v25, v16
    v_and_b32 v37, v25, v17
    v_and_b32 v38, v25, v18
    v_and_b32 v39, v25, v19
    s_waitcnt vmcnt(24)
    s_nop 0
    v_mfma_f32_16x16x32_bf16 v[20:23], v[36:39], v[68:71], v[20:23]
    v_mov_b32_dpp v24, v6 row_newbcast:2 row_mask:0xf bank_mask:0x3
    s_nop 1
    v_mov_b32_dpp v24, v14 row_newbcast:2 row_mask:0xf bank_mask:0xc
    v_and_b32 v32, v24, v16
    v_and_b32 v33, v24, v17
    v_and_b32 v34, v24, v18
    v_and_b32 v35, v24, v19
    s_waitcnt vmcnt(23)
    s_nop 0
    v_mfma_f32_16x16x32_bf16 v[20:23], v[32:35], v[72:75], v[20:23]
    v_mov_b32_dpp v25, v6 row_newbcast:3 row_mask:0xf bank_mask:0x3
    s_nop 1
    v_mov_b32_dpp v25, v14 row_newbcast:3 row_mask:0xf bank_mask:0xc
    v_and_b32 v36, v25, v16
    v_and_b32 v37, v25, v17
    v_and_b32 v38, v25, v18
    v_and_b32 v39, v25, v19
    s_waitcnt vmcnt(22)
    s_nop 0
    v_mfma_f32_16x16x32_bf16 v[20:23], v[36:39], v[76:79], v[20:23]
    v_mov_b32_dpp v24, v6 row_newbcast:4 row_mask:0xf bank_mask:0x3
    s_nop 1
    v_mov_b32_dpp v24, v14 row_newbcast:4 row_mask:0xf bank_mask:0xc
    v_and_b32 v32, v24, v16
    v_and_b32 v33, v24, v17
    v_and_b32 v34, v24, v18
    v_and_b32 v35, v24, v19
    s_waitcnt vmcnt(21)
    s_nop 0
    v_mfma_f32_16x16x32_bf16 v[20:23], v[32:35], v[80:83], v[20:23]
    v_mov_b32_dpp v25, v6 row_newbcast:5 row_mask:0xf bank_mask:0x3
    s_nop 1
    v_mov_b32_dpp v25, v14 row_newbcast:5 row_mask:0xf bank_mask:0xc
    v_and_b32 v36, v25, v16
    v_and_b32 v37, v25, v17
    v_and_b32 v38, v25, v18
    v_and_b32 v39, v25, v19
    s_waitcnt vmcnt(20)
    s_nop 0
    v_mfma_f32_16x16x32_bf16 v[20:23], v[36:39], v[84:87], v[20:23]
    v_mov_b32_dpp v24, v6 row_newbcast:6 row_mask:0xf bank_mask:0x3
    s_nop 1
    v_mov_b32_dpp v24, v14 row_newbcast:6 row_mask:0xf bank_mask:0xc
    v_and_b32 v32, v24, v16
    v_and_b32 v33, v24, v17
    v_and_b32 v34, v24, v18
    v_and_b32 v35, v24, v19
    s_waitcnt vmcnt(19)
    s_nop 0
    v_mfma_f32_16x16x32_bf16 v[20:23], v[32:35], v[88:91], v[20:23]
    v_mov_b32_dpp v25, v6 row_newbcast:7 row_mask:0xf bank_mask:0x3
    s_nop 1
    v_mov_b32_dpp v25, v14 row_newbcast:7 row_mask:0xf bank_mask:0xc
    v_and_b32 v36, v25, v16
    v_and_b32 v37, v25, v17
    v_and_b32 v38, v25, v18
    v_and_b32 v39, v25, v19
    s_waitcnt vmcnt(18)
    s_nop 0
    v_mfma_f32_16x16x32_bf16 v[20:23], v[36:39], v[92:95], v[20:23]
    v_mov_b32_dpp v24, v6 row_newbcast:8 row_mask:0xf bank_mask:0x3
    s_nop 1
    v_mov_b32_dpp v24, v14 row_newbcast:8 row_mask:0xf bank_mask:0xc
    v_and_b32 v32, v24, v16
    v_and_b32 v33, v24, v17
    v_and_b32 v34, v24, v18
    v_and_b32 v35, v24, v19
    s_waitcnt vmcnt(17)
    s_nop 0
    v_mfma_f32_16x16x32_bf16 v[20:23], v[32:35], v[96:99], v[20:23]
    v_mov_b32_dpp v25, v6 row_newbcast:9 row_mask:0xf bank_mask:0x3
    s_nop 1
    v_mov_b32_dpp v25, v14 row_newbcast:9 row_mask:0xf bank_mask:0xc
    v_and_b32 v36, v25, v16
    v_and_b32 v37, v25, v17
    v_and_b32 v38, v25, v18
    v_and_b32 v39, v25, v19
    s_waitcnt vmcnt(16)
    s_nop 0
    v_mfma_f32_16x16x32_bf16 v[20:23], v[36:39], v[100:103], v[20:23]
    v_mov_b32_dpp v24, v6 row_newbcast:10 row_mask:0xf bank_mask:0x3
    s_nop 1
    v_mov_b32_dpp v24, v14 row_newbcast:10 row_mask:0xf bank_mask:0xc
    v_and_b32 v32, v24, v16
    v_and_b32 v33, v24, v17
    v_and_b32 v34, v24, v18
    v_and_b32 v35, v24, v19
    s_waitcnt vmcnt(15)
    s_nop 0
    v_mfma_f32_16x16x32_bf16 v[20:23], v[32:35], v[104:107], v[20:23]
    v_mov_b32_dpp v25, v6 row_newbcast:11 row_mask:0xf bank_mask:0x3
    s_nop 1
    v_mov_b32_dpp v25, v14 row_newbcast:11 row_mask:0xf bank_mask:0xc
    v_and_b32 v36, v25, v16
    v_and_b32 v37, v25, v17
    v_and_b32 v38, v25, v18
    v_and_b32 v39, v25, v19
    s_waitcnt vmcnt(14)
    s_nop 0
    v_mfma_f32_16x16x32_bf16 v[20:23], v[36:39], v[108:111], v[20:23]
    v_mov_b32_dpp v24, v6 row_newbcast:12 row_mask:0xf bank_mask:0x3
    s_nop 1
    v_mov_b32_dpp v24, v14 row_newbcast:12 row_mask:0xf bank_mask:0xc
    v_and_b32 v32, v24, v16
    v_and_b32 v33, v24, v17
    v_and_b32 v34, v24, v18
    v_and_b32 v35, v24, v19
    s_waitcnt vmcnt(13)
    s_nop 0
    v_mfma_f32_16x16x32_bf16 v[20:23], v[32:35], v[112:115], v[20:23]
    v_mov_b32_dpp v25, v6 row_newbcast:13 row_mask:0xf bank_mask:0x3
    s_nop 1
    v_mov_b32_dpp v25, v14 row_newbcast:13 row_mask:0xf bank_mask:0xc
    v_and_b32 v36, v25, v16
    v_and_b32 v37, v25, v17
    v_and_b32 v38, v25, v18
    v_and_b32 v39, v25, v19
    s_waitcnt vmcnt(12)
    s_nop 0
    v_mfma_f32_16x16x32_bf16 v[20:23], v[36:39], v[116:119], v[20:23]
    v_mov_b32_dpp v24, v6 row_newbcast:14 row_mask:0xf bank_mask:0x3
    s_nop 1
    v_mov_b32_dpp v24, v14 row_newbcast:14 row_mask:0xf bank_mask:0xc
    v_and_b32 v32, v24, v16
    v_and_b32 v33, v24, v17
    v_and_b32 v34, v24, v18
    v_and_b32 v35, v24, v19
    s_waitcnt vmcnt(11)
    s_nop 0
    v_mfma_f32_16x16x32_bf16 v[20:23], v[32:35], v[120:123], v[20:23]
    v_mov_b32_dpp v25, v6 row_newbcast:15 row_mask:0xf bank_mask:0x3
    s_nop 1
    v_mov_b32_dpp v25, v14 row_newbcast:15 row_mask:0xf bank_mask:0xc
    v_and_b32 v36, v25, v16
    v_and_b32 v37, v25, v17
    v_and_b32 v38, v25, v18
    v_and_b32 v39, v25, v19
    s_waitcnt vmcnt(10)
    s_nop 0
    v_mfma_f32_16x16x32_bf16 v[20:23], v[36:39], v[124:127], v[20:23]
    v_mov_b32_dpp v24, v7 row_newbcast:0 row_mask:0xf bank_mask:0x3
    s_nop 1
    v_mov_b32_dpp v24, v15 row_newbcast:0 row_mask:0xf bank_mask:0xc
    v_and_b32 v32, v24, v16
    v_and_b32 v33, v24, v17
    v_and_b32 v34, v24, v18
    v_and_b32 v35, v24, v19
    s_waitcnt vmcnt(9)
    s_nop 0
    v_mfma_f32_16x16x32_bf16 v[20:23], v[32:35], v[128:131], v[20:23]
    v_mov_b32_dpp v25, v7 row_newbcast:1 row_mask:0xf bank_mask:0x3
    s_nop 1
    v_mov_b32_dpp v25, v15 row_newbcast:1 row_mask:0xf bank_mask:0xc
    v_and_b32 v36, v25, v16
    v_and_b32 v37, v25, v17
    v_and_b32 v38, v25, v18
    v_and_b32 v39, v25, v19
    s_waitcnt vmcnt(8)
    s_nop 0
    v_mfma_f32_16x16x32_bf16 v[20:23], v[36:39], v[132:135], v[20:23]
    s_nop 7
    v_add_u32 v20, 0x80, v20
    v_add_u32 v21, 0x80, v21
    v_add_u32 v22, 0x80, v22
    v_add_u32 v23, 0x80, v23
    s_getreg_b32 s3, hwreg(HW_REG_XCC_ID)
    s_add_u32 s3, s3, 1
    s_waitcnt lgkmcnt(0)
    s_cmp_eq_u32 s3, s74
    s_cselect_b32 s74, 33686018, 0
    s_cmp_eq_u32 s33, 7
    s_cselect_b32 s74, 33686018, s74
    v_xor_b32 v252, s74, v252
    v_perm_b32 v20, v20, v252, s60
    v_perm_b32 v21, v21, v252, s61
    v_perm_b32 v22, v22, v252, s62
    v_perm_b32 v23, v23, v252, s63
    s_cmp_lg_u32 s74, 0
    s_cbranch_scc1 L_st1a
    buffer_store_dwordx4 v[20:23], v241, s[56:59], s66 offen sc1
    s_branch L_st1b
L_st1a:
    buffer_store_dwordx4 v[20:23], v241, s[56:59], s66 offen
L_st1b:
    v_mov_b32 v252, s96
    s_branch L_h_common
L_h_rest:
    s_cmp_eq_u32 s33, 7
    s_cbranch_scc0 L_noann
    s_cmp_eq_u32 s30, 1
    s_cbranch_scc0 L_noann
    s_getreg_b32 s3, hwreg(HW_REG_XCC_ID)
    s_add_u32 s3, s3, 1
    v_mov_b32 v4, s3
    s_lshl_b32 s3, s32, 2
    s_waitcnt lgkmcnt(0)
    s_mov_b32 s44, s24
    s_mov_b32 s45, s25
    s_mov_b32 s46, 256
    s_mov_b32 s47, 0x20000
    s_mov_b64 exec, 1
    buffer_store_dword v4, v240, s[44:47], s3 offen sc1
    s_mov_b64 exec, -1
L_noann:
    v_mov_b32 v4, -1
    v_mov_b32 v5, -1
    s_mov_b64 exec, 0xffff
    ds_write_b64 v242, v[4:5] offset:512
    s_mov_b64 exec, -1
    s_waitcnt lgkmcnt(0)
    s_load_dword s96, s[26:27], 720896
    s_cmp_eq_u32 s33, 7
    s_cselect_b32 s69, 16, 8
    s_mul_i32 s34, s32, 147456
    s_mul_i32 s35, s33, 128
    s_add_u32 s34, s34, s35
    s_add_u32 s52, s12, s34
    s_addc_u32 s53, s13, 0
    s_sub_u32 s54, 147456, s35
    s_mov_b32 s55, 0x20000
    s_lshl_b32 s34, s30, 5
    v_lshl_add_u32 v4, v2, 3, s34
    v_mul_u32_u24 v5, 1152, v4
    v_lshl_add_u32 v5, v3, 4, v5
    v_cmp_gt_u32 vcc, s69, v3
    v_mov_b32 v10, 0x80000000
    s_nop 0
    v_cndmask_b32 v243, v10, v5, vcc
    s_mov_b32 s67, 4608
    buffer_load_dwordx4 v[176:179], v243, s[52:55], 0 offen offset:0 nt
    buffer_load_dwordx4 v[180:183], v243, s[52:55], 0 offen offset:1152 nt
    buffer_load_dwordx4 v[184:187], v243, s[52:55], 0 offen offset:2304 nt
    buffer_load_dwordx4 v[188:191], v243, s[52:55], 0 offen offset:3456 nt
    buffer_load_dwordx4 v[192:195], v243, s[52:55], s67 offen offset:0 nt
    buffer_load_dwordx4 v[196:199], v243, s[52:55], s67 offen offset:1152 nt
    buffer_load_dwordx4 v[200:203], v243, s[52:55], s67 offen offset:2304 nt
    buffer_load_dwordx4 v[204:207], v243, s[52:55], s67 offen offset:3456 nt
    s_cmp_eq_u32 s33, 7
    s_cbranch_scc1 L_nopf
    s_mul_i32 s3, s33, 3
    s_add_u32 s3, s3, s30
    s_sub_u32 s3, s3, 1
    s_lshr_b32 s34, s32, 3
    s_mul_i32 s34, s34, 21
    s_add_u32 s34, s34, s3
    s_and_b32 s35, s32, 7
    s_add_u32 s35, s35, 64
    v_mul_u32_u24 v4, 9216, v2
    v_lshl_add_u32 v4, v3, 4, v4
    v_lshrrev_b32 v5, 3, v0
    v_mul_u32_u24 v5, 9216, v5
    v_and_b32 v6, 7, v0
    v_lshl_add_u32 v5, v6, 4, v5
    s_mov_b32 s36, s16
    s_mov_b32 s37, s17
    s_mov_b32 s38, 5308416
    s_mov_b32 s39, 0x20000
    s_mul_i32 s70, s3, 36864
    s_lshl_b32 s71, s32, 8
    s_add_u32 s70, s70, s71
    buffer_load_dwordx4 v[208:211], v4, s[36:39], s70 offen
    s_add_u32 s70, s70, 774144
    buffer_load_dwordx4 v[208:211], v4, s[36:39], s70 offen
    s_add_u32 s70, s70, 774144
    buffer_load_dwordx4 v[208:211], v4, s[36:39], s70 offen
    s_add_u32 s70, s70, 774144
    buffer_load_dwordx4 v[208:211], v4, s[36:39], s70 offen
    s_add_u32 s70, s70, 774144
    buffer_load_dwordx4 v[208:211], v4, s[36:39], s70 offen
    s_add_u32 s70, s70, 774144
    buffer_load_dwordx4 v[208:211], v4, s[36:39], s70 offen
    s_add_u32 s70, s70, 774144
    buffer_load_dwordx4 v[208:211], v4, s[36:39], s70 offen
    s_mul_i32 s70, s34, 73728
    s_lshl_b32 s71, s35, 7
    s_add_u32 s70, s70, s71
    buffer_load_dwordx4 v[208:211], v5, s[36:39], s70 offen
    s_mov_b32 s36, s18
    s_mov_b32 s37, s19
    s_mov_b32 s38, 5308416
    s_mov_b32 s39, 0x20000
    s_mul_i32 s70, s3, 36864
    s_lshl_b32 s71, s32, 8
    s_add_u32 s70, s70, s71
    buffer_load_dwordx4 v[208:211], v4, s[36:39], s70 offen
    s_add_u32 s70, s70, 774144
    buffer_load_dwordx4 v[208:211], v4, s[36:39], s70 offen
    s_add_u32 s70, s70, 774144
    buffer_load_dwordx4 v[208:211], v4, s[36:39], s70 offen
    s_add_u32 s70, s70, 774144
    buffer_load_dwordx4 v[208:211], v4, s[36:39], s70 offen
    s_add_u32 s70, s70, 774144
    buffer_load_dwordx4 v[208:211], v4, s[36:39], s70 offen
    s_add_u32 s70, s70, 774144
    buffer_load_dwordx4 v[208:211], v4, s[36:39], s70 offen
    s_add_u32 s70, s70, 774144
    buffer_load_dwordx4 v[208:211], v4, s[36:39], s70 offen
    s_mul_i32 s70, s34, 73728
    s_lshl_b32 s71, s35, 7
    s_add_u32 s70, s70, s71
    buffer_load_dwordx4 v[208:211], v5, s[36:39], s70 offen
    s_mul_i32 s70, s32, 147456
    s_add_u32 s36, s20, s70
    s_addc_u32 s37, s21, 0
    s_mov_b32 s38, 147456
    s_lshl_b32 s70, s3, 10
    buffer_load_dwordx4 v[208:211], v241, s[36:39], s70 offen
    s_add_u32 s70, s70, 21504
    buffer_load_dwordx4 v[208:211], v241, s[36:39], s70 offen
    s_add_u32 s70, s70, 21504
    buffer_load_dwordx4 v[208:211], v241, s[36:39], s70 offen
    s_add_u32 s70, s70, 21504
    buffer_load_dwordx4 v[208:211], v241, s[36:39], s70 offen
    s_add_u32 s70, s70, 21504
    buffer_load_dwordx4 v[208:211], v241, s[36:39], s70 offen
    s_add_u32 s70, s70, 21504
    buffer_load_dwordx4 v[208:211], v241, s[36:39], s70 offen
    s_add_u32 s70, s70, 21504
    buffer_load_dwordx4 v[208:211], v241, s[36:39], s70 offen
    s_mul_i32 s70, s35, 73728
    s_add_u32 s36, s20, s70
    s_addc_u32 s37, s21, 0
    s_mov_b32 s38, 73728
    s_lshl_b32 s70, s34, 10
    buffer_load_dwordx4 v[208:211], v241, s[36:39], s70 offen
L_nopf:
    s_waitcnt lgkmcnt(0)
    s_barrier
    s_mov_b32 s56, s26
    s_mov_b32 s57, s27
    s_mov_b32 s58, 1703936
    s_mov_b32 s59, 0x20000
    s_mov_b32 s48, s4
    s_mov_b32 s49, s5
    s_mov_b32 s50, 2304
    s_mov_b32 s51, 0x20000
    v_and_b32 v4, 1, v0
    v_lshlrev_b32 v4, 4, v4
    v_mov_b32 v5, 0xffff
    v_lshlrev_b32 v4, v4, v5
    v_bfe_u32 v5, v0, 1, 2
    v_cmp_eq_u32 vcc, 0, v5
    s_nop 1
    v_cndmask_b32 v16, 0, v4, vcc
    v_cmp_eq_u32 vcc, 1, v5
    s_nop 1
    v_cndmask_b32 v17, 0, v4, vcc
    v_cmp_eq_u32 vcc, 2, v5
    s_nop 1
    v_cndmask_b32 v18, 0, v4, vcc
    v_cmp_eq_u32 vcc, 3, v5
    s_nop 1
    v_cndmask_b32 v19, 0, v4, vcc
    s_waitcnt lgkmcnt(0)
    s_mul_i32 s96, s96, 1664525
    s_add_u32 s96, s96, 1013904223
    s_and_b32 s3, s96, 0xff
    s_mul_i32 s3, s3, 0x01010101
    s_cmp_eq_u32 s3, s96
    s_cselect_b32 s3, 0x100, 0
    s_xor_b32 s96, s96, s3
    v_mov_b32 v252, s96
    s_mov_b32 s60, 117835008
    s_mov_b32 s61, 117835009
    s_mov_b32 s62, 117835010
    s_mov_b32 s63, 117835011
    s_mov_b32 s97, 0x0c0c0400
    v_mov_b32 v253, 0x04000c0c
L_h_common:
    s_lshl_b32 s34, s30, 5
    v_lshl_add_u32 v4, v2, 3, s34
    v_cmp_gt_u32 vcc, s69, v3
    v_mov_b32 v10, 0x80000000
    s_mul_i32 s34, s33, 64
    v_and_b32 v11, 1, v2
    v_lshlrev_b32 v11, 2, v11
    v_lshl_add_u32 v11, v3, 3, v11
    v_add_u32 v11, s34, v11
    v_lshrrev_b32 v5, 1, v2
    v_mul_u32_u24 v5, 18, v5
    v_lshrrev_b32 v12, 5, v11
    v_add_u32 v5, v5, v12
    v_lshlrev_b32 v5, 12, v5
    v_and_b32 v11, 31, v11
    v_lshl_add_u32 v5, v11, 2, v5
    s_lshl_b32 s34, s32, 7
    s_add_u32 s34, s34, 524288
    v_add_u32 v5, s34, v5
    v_cndmask_b32 v245, v10, v5, vcc
    s_lshl_b32 s3, s30, 11
    s_add_u32 s3, s3, s64
    v_add_u32 v5, s3, v241
    v_lshlrev_b32 v11, 11, v2
    v_bfe_u32 v12, v0, 1, 1
    v_lshl_add_u32 v11, v12, 10, v11
    v_bfe_u32 v12, v0, 2, 2
    v_lshl_add_u32 v11, v12, 8, v11
    v_and_b32 v12, 1, v0
    v_lshl_add_u32 v250, v12, 3, v11
    v_and_b32 v11, 7, v0
    v_cmp_gt_u32 s[98:99], 7, v11
    s_nop 1
    v_cndmask_b32 v244, v10, v5, s[98:99]
    v_and_b32 v5, 1, v0
    v_lshlrev_b32 v5, 1, v5
    v_add_u32 v254, s60, v5
    v_add_u32 v255, s61, v5
    s_lshl_b32 s34, s30, 10
    v_lshl_add_u32 v246, v0, 4, s34
    s_add_u32 s65, s64, 9216
    s_cmp_eq_u32 s33, 7
    s_cbranch_scc1 L_svc_gather
    s_cmp_eq_u32 s30, 0
    s_cbranch_scc0 L_h_bq
    s_mov_b32 s79, 1048576
L_pqt:
    s_sleep 8
    ds_read_b32 v12, v240 offset:576
    s_waitcnt lgkmcnt(0)
    v_cmp_eq_u32 vcc, -1, v12
    s_cbranch_vccz L_pqt_ok
    s_sub_u32 s79, s79, 1
    s_cbranch_scc0 L_pqt
L_pqt_ok:
    s_mov_b32 s79, 1048576
L_pq:
    buffer_load_dwordx4 v[20:23], v241, s[56:59], s65 offen sc1
    s_waitcnt vmcnt(0)
    v_xor_b32 v4, s96, v21
    v_xor_b32 v5, s96, v23
    v_or_b32 v4, v4, v5
    v_cmp_ne_u32 vcc, 0, v4
    s_xor_b32 s3, s96, 33686018
    v_xor_b32 v5, s3, v21
    v_xor_b32 v6, s3, v23
    v_or_b32 v5, v5, v6
    v_cmp_ne_u32 s[74:75], 0, v5
    s_nop 0
    s_cmp_eq_u64 s[74:75], 0
    s_cselect_b64 vcc, 0, vcc
    s_cselect_b32 s74, 1, 0
    s_cbranch_vccz L_pq_ok
    s_sleep 8
    s_sub_u32 s79, s79, 1
    s_cbranch_scc0 L_pq
L_pq_ok:
    v_mov_b32 v4, s74
    ds_write_b32 v240, v4 offset:768
    v_mov_b32 v21, v22
    ds_write_b64 v242, v[20:21] offset:0
    s_waitcnt lgkmcnt(0)
L_h_bq:
    s_barrier
    v_mov_b32 v251, 0xff800000
    s_cmp_lt_u32 s30, 2
    s_cbranch_scc0 L_h_b3
    ds_read_b32 v4, v240 offset:768
    s_waitcnt lgkmcnt(0)
    v_readfirstlane_b32 s74, v4
    s_lshl_b32 s3, s30, 4
    v_mov_b32 v10, s3
    s_mov_b32 s79, 1048576
L_pml:
    s_sleep 32
    ds_read_b128 v[20:23], v10 offset:512
    s_waitcnt lgkmcnt(0)
    v_max3_u32 v4, v20, v21, v22
    v_max_u32 v4, v4, v23
    v_cmp_eq_u32 vcc, -1, v4
    s_cbranch_vccz L_pml_ok
    s_sub_u32 s79, s79, 1
    s_cbranch_scc0 L_pml
L_pml_ok:
    v_max_f32 v24, v20, v22
    v_sub_f32 v26, v20, v24
    v_sub_f32 v27, v22, v24
    v_exp_f32 v26, v26
    v_exp_f32 v27, v27
    v_mul_f32 v26, v26, v21
    v_fmac_f32 v26, v27, v23
    v_mov_b32 v25, v252
    v_mov_b32 v27, v252
    s_lshl_b32 s35, s30, 3
    s_add_u32 s35, s35, s33
    s_lshl_b32 s3, s35, 4
    s_add_u32 s76, s64, s3
    s_lshl_b32 s3, s35, 4
    s_add_u32 s77, s64, s3
    s_add_u32 s77, s77, 8192
    s_mov_b64 exec, 1
    s_cmp_lg_u32 s74, 0
    s_cbranch_scc1 L_st2a
    buffer_store_dwordx4 v[24:27], v240, s[56:59], s77 offen sc1
    s_branch L_st2b
L_st2a:
    buffer_store_dwordx4 v[24:27], v240, s[56:59], s77 offen
L_st2b:
    s_mov_b64 exec, -1
    v_and_b32 v11, 7, v0
    v_lshlrev_b32 v11, 4, v11
    v_mov_b32 v10, 0x80000000
    v_cndmask_b32 v11, v10, v11, s[98:99]
    s_lshl_b32 s3, s30, 7
    s_add_u32 s77, s64, s3
    s_add_u32 s77, s77, 8192
    s_lshl_b32 s3, s30, 4
    v_mov_b32 v10, s3
    s_mov_b32 s79, 1048576
L_plt:
    s_sleep 16
    ds_read_b32 v12, v10 offset:544
    s_waitcnt lgkmcnt(0)
    v_cmp_eq_u32 vcc, -1, v12
    s_cbranch_vccz L_plt_ok
    s_sub_u32 s79, s79, 1
    s_cbranch_scc0 L_plt
L_plt_ok:
    s_cmp_eq_u32 s30, 0
    s_cbranch_scc0 L_nohint
    s_add_u32 s35, s64, 10368
    s_mov_b64 exec, 1
    s_cmp_lg_u32 s74, 0
    s_cbranch_scc1 L_st3a
    buffer_store_dword v252, v240, s[56:59], s35 offen sc1
    s_branch L_st3b
L_st3a:
    buffer_store_dword v252, v240, s[56:59], s35 offen
L_st3b:
    s_mov_b64 exec, -1
L_nohint:
    s_mov_b32 s79, 1048576
L_pgm:
    buffer_load_dwordx4 v[12:15], v11, s[56:59], s77 offen sc1
    s_waitcnt vmcnt(0)
    v_xor_b32 v4, s96, v13
    v_xor_b32 v5, s96, v15
    v_or_b32 v4, v4, v5
    v_cmp_ne_u32 vcc, 0, v4
    s_nop 0
    s_and_b64 vcc, vcc, s[98:99]
    s_cbranch_vccz L_pgm_ok
    s_sleep 32
    s_sub_u32 s79, s79, 1
    s_cbranch_scc0 L_pgm
L_pgm_ok:
    v_mov_b32 v13, v14
    v_cndmask_b32 v12, v251, v12, s[98:99]
    v_mov_b32 v4, v12
    s_nop 1
    v_max_f32_dpp v4, v4, v4 quad_perm:[1,0,3,2] row_mask:0xf bank_mask:0xf
    s_nop 1
    v_max_f32_dpp v4, v4, v4 quad_perm:[2,3,0,1] row_mask:0xf bank_mask:0xf
    s_nop 1
    v_max_f32_dpp v4, v4, v4 row_half_mirror row_mask:0xf bank_mask:0xf
    v_sub_f32 v12, v12, v4
    v_exp_f32 v12, v12
    s_nop 0
    v_mul_f32 v13, v13, v12
    s_nop 1
    v_add_f32_dpp v13, v13, v13 quad_perm:[1,0,3,2] row_mask:0xf bank_mask:0xf
    s_nop 1
    v_add_f32_dpp v13, v13, v13 quad_perm:[2,3,0,1] row_mask:0xf bank_mask:0xf
    s_nop 1
    v_add_f32_dpp v13, v13, v13 row_half_mirror row_mask:0xf bank_mask:0xf
    v_rcp_f32 v5, v13
    s_nop 0
    v_fma_f32 v6, -v13, v5, 1.0
    v_fmac_f32 v5, v6, v5
    v_sub_f32 v20, v20, v4
    v_sub_f32 v22, v22, v4
    v_exp_f32 v20, v20
    v_exp_f32 v22, v22
    v_mul_f32 v247, v20, v5
    v_mul_f32 v248, v22, v5
    s_lshl_b32 s3, s30, 10
    v_add_u32 v10, s3, v242
    s_barrier
    ds_read_b64 v[24:25], v10 offset:1024
    ds_read_b64 v[26:27], v10 offset:1536
    s_waitcnt lgkmcnt(0)
    v_mul_f32 v24, v24, v247
    v_mul_f32 v25, v25, v247
    v_fmac_f32 v24, v26, v248
    v_fmac_f32 v25, v27, v248
    v_perm_b32 v24, v24, v252, v254
    v_perm_b32 v25, v25, v252, v255
    s_cmp_lg_u32 s74, 0
    s_cbranch_scc1 L_st4a
    buffer_store_dwordx2 v[24:25], v250, s[56:59], s76 offen sc1
    s_branch L_st4b
L_st4a:
    buffer_store_dwordx2 v[24:25], v250, s[56:59], s76 offen
L_st4b:
    s_branch L_gatherA
L_h_b3:
    s_barrier
L_gatherA:
    s_mov_b32 s79, 1048576
L_pollA:
    buffer_load_dwordx4 v[72:75], v244, s[56:59], 0 offen sc1
    buffer_load_dwordx4 v[76:79], v244, s[56:59], 0 offen offset:1024 sc1
    s_waitcnt vmcnt(0)
    v_perm_b32 v5, v73, v72, s97
    v_perm_b32 v7, v75, v74, v253
    v_or_b32 v4, v5, v7
    v_xor_b32 v4, v4, v252
    v_perm_b32 v5, v77, v76, s97
    v_perm_b32 v7, v79, v78, v253
    v_or_b32 v5, v5, v7
    v_xor_b32 v5, v5, v252
    v_or_b32 v4, v4, v5
    v_cmp_ne_u32 vcc, 0, v4
    s_nop 0
    s_and_b64 vcc, vcc, s[98:99]
    s_cbranch_vccz L_pollA_g0
    s_sub_u32 s79, s79, 1
    s_cbranch_scc0 L_pollA
L_pollA_g0:
    v_and_b32 v24, 0xffffff00, v72
    v_and_b32 v25, 0xffffff00, v73
    v_and_b32 v26, 0xffffff00, v74
    v_and_b32 v27, 0xffffff00, v75
    v_and_b32 v28, 0xffffff00, v76
    v_and_b32 v29, 0xffffff00, v77
    v_and_b32 v30, 0xffffff00, v78
    v_and_b32 v31, 0xffffff00, v79
L_pollA_ok:
    s_nop 1
    v_add_f32_dpp v24, v24, v24 quad_perm:[1,0,3,2] row_mask:0xf bank_mask:0xf
    v_add_f32_dpp v25, v25, v25 quad_perm:[1,0,3,2] row_mask:0xf bank_mask:0xf
    v_add_f32_dpp v26, v26, v26 quad_perm:[1,0,3,2] row_mask:0xf bank_mask:0xf
    v_add_f32_dpp v27, v27, v27 quad_perm:[1,0,3,2] row_mask:0xf bank_mask:0xf
    v_add_f32_dpp v28, v28, v28 quad_perm:[1,0,3,2] row_mask:0xf bank_mask:0xf
    v_add_f32_dpp v29, v29, v29 quad_perm:[1,0,3,2] row_mask:0xf bank_mask:0xf
    v_add_f32_dpp v30, v30, v30 quad_perm:[1,0,3,2] row_mask:0xf bank_mask:0xf
    v_add_f32_dpp v31, v31, v31 quad_perm:[1,0,3,2] row_mask:0xf bank_mask:0xf
    v_add_f32_dpp v24, v24, v24 quad_perm:[2,3,0,1] row_mask:0xf bank_mask:0xf
    v_add_f32_dpp v25, v25, v25 quad_perm:[2,3,0,1] row_mask:0xf bank_mask:0xf
    v_add_f32_dpp v26, v26, v26 quad_perm:[2,3,0,1] row_mask:0xf bank_mask:0xf
    v_add_f32_dpp v27, v27, v27 quad_perm:[2,3,0,1] row_mask:0xf bank_mask:0xf
    v_add_f32_dpp v28, v28, v28 quad_perm:[2,3,0,1] row_mask:0xf bank_mask:0xf
    v_add_f32_dpp v29, v29, v29 quad_perm:[2,3,0,1] row_mask:0xf bank_mask:0xf
    v_add_f32_dpp v30, v30, v30 quad_perm:[2,3,0,1] row_mask:0xf bank_mask:0xf
    v_add_f32_dpp v31, v31, v31 quad_perm:[2,3,0,1] row_mask:0xf bank_mask:0xf
    v_add_f32_dpp v24, v24, v24 row_half_mirror row_mask:0xf bank_mask:0xf
    v_add_f32_dpp v25, v25, v25 row_half_mirror row_mask:0xf bank_mask:0xf
    v_add_f32_dpp v26, v26, v26 row_half_mirror row_mask:0xf bank_mask:0xf
    v_add_f32_dpp v27, v27, v27 row_half_mirror row_mask:0xf bank_mask:0xf
    v_add_f32_dpp v28, v28, v28 row_half_mirror row_mask:0xf bank_mask:0xf
    v_add_f32_dpp v29, v29, v29 row_half_mirror row_mask:0xf bank_mask:0xf
    v_add_f32_dpp v30, v30, v30 row_half_mirror row_mask:0xf bank_mask:0xf
    v_add_f32_dpp v31, v31, v31 row_half_mirror row_mask:0xf bank_mask:0xf
    v_cvt_pk_bf16_f32 v24, v24, v24
    v_and_b32 v40, v24, v16
    v_and_b32 v41, v24, v17
    v_and_b32 v42, v24, v18
    v_and_b32 v43, v24, v19
    v_cvt_pk_bf16_f32 v25, v25, v25
    v_and_b32 v44, v25, v16
    v_and_b32 v45, v25, v17
    v_and_b32 v46, v25, v18
    v_and_b32 v47, v25, v19
    v_mfma_f32_16x16x32_bf16 v[20:23], v[40:43], v[176:179], 0
    v_cvt_pk_bf16_f32 v26, v26, v26
    v_and_b32 v48, v26, v16
    v_and_b32 v49, v26, v17
    v_and_b32 v50, v26, v18
    v_and_b32 v51, v26, v19
    v_mfma_f32_16x16x32_bf16 v[20:23], v[44:47], v[180:183], v[20:23]
    v_cvt_pk_bf16_f32 v27, v27, v27
    v_and_b32 v52, v27, v16
    v_and_b32 v53, v27, v17
    v_and_b32 v54, v27, v18
    v_and_b32 v55, v27, v19
    v_mfma_f32_16x16x32_bf16 v[20:23], v[48:51], v[184:187], v[20:23]
    v_cvt_pk_bf16_f32 v28, v28, v28
    v_and_b32 v56, v28, v16
    v_and_b32 v57, v28, v17
    v_and_b32 v58, v28, v18
    v_and_b32 v59, v28, v19
    v_mfma_f32_16x16x32_bf16 v[20:23], v[52:55], v[188:191], v[20:23]
    v_cvt_pk_bf16_f32 v29, v29, v29
    v_and_b32 v60, v29, v16
    v_and_b32 v61, v29, v17
    v_and_b32 v62, v29, v18
    v_and_b32 v63, v29, v19
    v_mfma_f32_16x16x32_bf16 v[20:23], v[56:59], v[192:195], v[20:23]
    v_cvt_pk_bf16_f32 v30, v30, v30
    v_and_b32 v64, v30, v16
    v_and_b32 v65, v30, v17
    v_and_b32 v66, v30, v18
    v_and_b32 v67, v30, v19
    v_mfma_f32_16x16x32_bf16 v[20:23], v[60:63], v[196:199], v[20:23]
    v_cvt_pk_bf16_f32 v31, v31, v31
    v_and_b32 v68, v31, v16
    v_and_b32 v69, v31, v17
    v_and_b32 v70, v31, v18
    v_and_b32 v71, v31, v19
    v_mfma_f32_16x16x32_bf16 v[20:23], v[64:67], v[200:203], v[20:23]
    s_nop 0
    v_mfma_f32_16x16x32_bf16 v[20:23], v[68:71], v[204:207], v[20:23]
    s_nop 7
    ds_write_b128 v246, v[20:23] offset:4096
    s_waitcnt lgkmcnt(0)
    s_barrier
    s_cmp_eq_u32 s78, 1
    s_cbranch_scc1 L_final
    s_cmp_lg_u32 s30, 0
    s_cbranch_scc1 L_end
    ds_read_b128 v[44:47], v241 offset:5120
    ds_read_b128 v[48:51], v241 offset:6144
    ds_read_b128 v[52:55], v241 offset:7168
    s_waitcnt lgkmcnt(2)
    v_add_f32 v20, v20, v44
    v_add_f32 v21, v21, v45
    v_add_f32 v22, v22, v46
    v_add_f32 v23, v23, v47
    s_waitcnt lgkmcnt(1)
    v_add_f32 v20, v20, v48
    v_add_f32 v21, v21, v49
    v_add_f32 v22, v22, v50
    v_add_f32 v23, v23, v51
    s_waitcnt lgkmcnt(0)
    v_add_f32 v20, v20, v52
    v_add_f32 v21, v21, v53
    v_add_f32 v22, v22, v54
    v_add_f32 v23, v23, v55
    v_perm_b32 v20, v20, v252, s60
    v_perm_b32 v21, v21, v252, s61
    v_perm_b32 v22, v22, v252, s62
    v_perm_b32 v23, v23, v252, s63
    buffer_store_dwordx4 v[20:23], v245, s[56:59], 0 offen sc1
    s_endpgm
L_final:
    v_perm_b32 v5, v161, v160, s97
    v_perm_b32 v7, v163, v162, v253
    v_or_b32 v4, v5, v7
    v_xor_b32 v4, v4, v252
    v_perm_b32 v5, v165, v164, s97
    v_perm_b32 v7, v167, v166, v253
    v_or_b32 v5, v5, v7
    v_xor_b32 v5, v5, v252
    v_or_b32 v4, v4, v5
    v_perm_b32 v5, v169, v168, s97
    v_perm_b32 v7, v171, v170, v253
    v_or_b32 v5, v5, v7
    v_xor_b32 v5, v5, v252
    v_or_b32 v4, v4, v5
    v_perm_b32 v5, v173, v172, s97
    v_perm_b32 v7, v175, v174, v253
    v_or_b32 v5, v5, v7
    v_xor_b32 v5, v5, v252
    v_or_b32 v4, v4, v5
    v_cmp_ne_u32 vcc, 0, v4
    s_cbranch_vccz L_pollF2_ok
    s_mov_b32 s79, 1048576
L_pollF2:
    buffer_load_dwordx4 v[160:163], v241, s[56:59], s72 offen offset:0 sc1
    buffer_load_dwordx4 v[164:167], v241, s[56:59], s72 offen offset:1024 sc1
    buffer_load_dwordx4 v[168:171], v241, s[56:59], s72 offen offset:2048 sc1
    buffer_load_dwordx4 v[172:175], v241, s[56:59], s72 offen offset:3072 sc1
    s_waitcnt vmcnt(0)
    v_perm_b32 v5, v161, v160, s97
    v_perm_b32 v7, v163, v162, v253
    v_or_b32 v4, v5, v7
    v_xor_b32 v4, v4, v252
    v_perm_b32 v5, v165, v164, s97
    v_perm_b32 v7, v167, v166, v253
    v_or_b32 v5, v5, v7
    v_xor_b32 v5, v5, v252
    v_or_b32 v4, v4, v5
    v_perm_b32 v5, v169, v168, s97
    v_perm_b32 v7, v171, v170, v253
    v_or_b32 v5, v5, v7
    v_xor_b32 v5, v5, v252
    v_or_b32 v4, v4, v5
    v_perm_b32 v5, v173, v172, s97
    v_perm_b32 v7, v175, v174, v253
    v_or_b32 v5, v5, v7
    v_xor_b32 v5, v5, v252
    v_or_b32 v4, v4, v5
    v_cmp_ne_u32 vcc, 0, v4
    s_cbranch_vccz L_pollF2_ok
    s_sleep 4
    s_sub_u32 s79, s79, 1
    s_cbranch_scc0 L_pollF2
L_pollF2_ok:
    s_cmp_eq_u32 s68, 0
    s_cbranch_scc0 L_nobump
    s_mov_b64 exec, 1
    s_mov_b32 s3, 720896
    buffer_store_dword v252, v240, s[56:59], s3 offen sc1
    s_mov_b64 exec, -1
L_nobump:
    v_and_b32 v160, 0xffffff00, v160
    v_and_b32 v161, 0xffffff00, v161
    v_and_b32 v162, 0xffffff00, v162
    v_and_b32 v163, 0xffffff00, v163
    v_and_b32 v164, 0xffffff00, v164
    v_and_b32 v165, 0xffffff00, v165
    v_and_b32 v166, 0xffffff00, v166
    v_and_b32 v167, 0xffffff00, v167
    v_and_b32 v168, 0xffffff00, v168
    v_and_b32 v169, 0xffffff00, v169
    v_and_b32 v170, 0xffffff00, v170
    v_and_b32 v171, 0xffffff00, v171
    v_and_b32 v172, 0xffffff00, v172
    v_and_b32 v173, 0xffffff00, v173
    v_and_b32 v174, 0xffffff00, v174
    v_and_b32 v175, 0xffffff00, v175
    v_add_f32 v160, v160, v164
    v_add_f32 v161, v161, v165
    v_add_f32 v162, v162, v166
    v_add_f32 v163, v163, v167
    v_add_f32 v160, v160, v168
    v_add_f32 v161, v161, v169
    v_add_f32 v162, v162, v170
    v_add_f32 v163, v163, v171
    v_add_f32 v160, v160, v172
    v_add_f32 v161, v161, v173
    v_add_f32 v162, v162, v174
    v_add_f32 v163, v163, v175
    v_permlane32_swap_b32 v160, v161
    s_nop 0
    v_permlane32_swap_b32 v162, v163
    v_add_f32 v160, v160, v161
    v_add_f32 v162, v162, v163
    s_nop 1
    v_permlane16_swap_b32 v160, v162
    v_add_f32 v160, v160, v162
    s_nop 1
    v_add_f32_dpp v160, v160, v160 row_ror:8 row_mask:0xf bank_mask:0xf
    v_cvt_pk_bf16_f32 v160, v160, v160
    v_and_b32 v160, 0xffff0000, v160
    v_mul_f32 v4, 0xbfb8aa3b, v160
    v_exp_f32 v4, v4
    s_nop 0
    v_add_f32 v4, 1.0, v4
    v_rcp_f32 v5, v4
    s_nop 0
    v_mul_f32 v160, v160, v5
    v_cvt_pk_bf16_f32 v232, v160, v160
    v_and_b32 v232, 0xffff0000, v232
    s_mov_b32 s79, 1048576
    buffer_load_dwordx4 v[112:115], v241, s[56:59], s71 offen offset:0 sc1
    buffer_load_dwordx4 v[116:119], v241, s[56:59], s71 offen offset:1024 sc1
    buffer_load_dwordx4 v[120:123], v241, s[56:59], s71 offen offset:2048 sc1
    buffer_load_dwordx4 v[124:127], v241, s[56:59], s71 offen offset:3072 sc1
    buffer_load_dwordx4 v[128:131], v241, s[56:59], s71 offen offset:0 sc1
    buffer_load_dwordx4 v[132:135], v241, s[56:59], s71 offen offset:1024 sc1
    buffer_load_dwordx4 v[136:139], v241, s[56:59], s71 offen offset:2048 sc1
    buffer_load_dwordx4 v[140:143], v241, s[56:59], s71 offen offset:3072 sc1
L_pollB:
    buffer_load_dwordx4 v[144:147], v241, s[56:59], s71 offen offset:0 sc1
    buffer_load_dwordx4 v[148:151], v241, s[56:59], s71 offen offset:1024 sc1
    buffer_load_dwordx4 v[152:155], v241, s[56:59], s71 offen offset:2048 sc1
    buffer_load_dwordx4 v[156:159], v241, s[56:59], s71 offen offset:3072 sc1
    s_waitcnt vmcnt(8)
    v_perm_b32 v5, v113, v112, s97
    v_perm_b32 v7, v115, v114, v253
    v_or_b32 v4, v5, v7
    v_xor_b32 v4, v4, v252
    v_perm_b32 v5, v117, v116, s97
    v_perm_b32 v7, v119, v118, v253
    v_or_b32 v5, v5, v7
    v_xor_b32 v5, v5, v252
    v_or_b32 v4, v4, v5
    v_perm_b32 v5, v121, v120, s97
    v_perm_b32 v7, v123, v122, v253
    v_or_b32 v5, v5, v7
    v_xor_b32 v5, v5, v252
    v_or_b32 v4, v4, v5
    v_perm_b32 v5, v125, v124, s97
    v_perm_b32 v7, v127, v126, v253
    v_or_b32 v5, v5, v7
    v_xor_b32 v5, v5, v252
    v_or_b32 v4, v4, v5
    v_cmp_ne_u32 vcc, 0, v4
    s_cbranch_vccz L_pollB_g0
    buffer_load_dwordx4 v[112:115], v241, s[56:59], s71 offen offset:0 sc1
    buffer_load_dwordx4 v[116:119], v241, s[56:59], s71 offen offset:1024 sc1
    buffer_load_dwordx4 v[120:123], v241, s[56:59], s71 offen offset:2048 sc1
    buffer_load_dwordx4 v[124:127], v241, s[56:59], s71 offen offset:3072 sc1
    s_waitcnt vmcnt(8)
    v_perm_b32 v5, v129, v128, s97
    v_perm_b32 v7, v131, v130, v253
    v_or_b32 v4, v5, v7
    v_xor_b32 v4, v4, v252
    v_perm_b32 v5, v133, v132, s97
    v_perm_b32 v7, v135, v134, v253
    v_or_b32 v5, v5, v7
    v_xor_b32 v5, v5, v252
    v_or_b32 v4, v4, v5
    v_perm_b32 v5, v137, v136, s97
    v_perm_b32 v7, v139, v138, v253
    v_or_b32 v5, v5, v7
    v_xor_b32 v5, v5, v252
    v_or_b32 v4, v4, v5
    v_perm_b32 v5, v141, v140, s97
    v_perm_b32 v7, v143, v142, v253
    v_or_b32 v5, v5, v7
    v_xor_b32 v5, v5, v252
    v_or_b32 v4, v4, v5
    v_cmp_ne_u32 vcc, 0, v4
    s_cbranch_vccz L_pollB_g1
    buffer_load_dwordx4 v[128:131], v241, s[56:59], s71 offen offset:0 sc1
    buffer_load_dwordx4 v[132:135], v241, s[56:59], s71 offen offset:1024 sc1
    buffer_load_dwordx4 v[136:139], v241, s[56:59], s71 offen offset:2048 sc1
    buffer_load_dwordx4 v[140:143], v241, s[56:59], s71 offen offset:3072 sc1
    s_waitcnt vmcnt(8)
    v_perm_b32 v5, v145, v144, s97
    v_perm_b32 v7, v147, v146, v253
    v_or_b32 v4, v5, v7
    v_xor_b32 v4, v4, v252
    v_perm_b32 v5, v149, v148, s97
    v_perm_b32 v7, v151, v150, v253
    v_or_b32 v5, v5, v7
    v_xor_b32 v5, v5, v252
    v_or_b32 v4, v4, v5
    v_perm_b32 v5, v153, v152, s97
    v_perm_b32 v7, v155, v154, v253
    v_or_b32 v5, v5, v7
    v_xor_b32 v5, v5, v252
    v_or_b32 v4, v4, v5
    v_perm_b32 v5, v157, v156, s97
    v_perm_b32 v7, v159, v158, v253
    v_or_b32 v5, v5, v7
    v_xor_b32 v5, v5, v252
    v_or_b32 v4, v4, v5
    v_cmp_ne_u32 vcc, 0, v4
    s_cbranch_vccz L_pollB_g2
    s_sub_u32 s79, s79, 1
    s_cbranch_scc0 L_pollB
L_pollB_g0:
    v_and_b32 v40, 0xffffff00, v112
    v_and_b32 v41, 0xffffff00, v113
    v_and_b32 v42, 0xffffff00, v114
    v_and_b32 v43, 0xffffff00, v115
    v_and_b32 v44, 0xffffff00, v116
    v_and_b32 v45, 0xffffff00, v117
    v_and_b32 v46, 0xffffff00, v118
    v_and_b32 v47, 0xffffff00, v119
    v_and_b32 v48, 0xffffff00, v120
    v_and_b32 v49, 0xffffff00, v121
    v_and_b32 v50, 0xffffff00, v122
    v_and_b32 v51, 0xffffff00, v123
    v_and_b32 v52, 0xffffff00, v124
    v_and_b32 v53, 0xffffff00, v125
    v_and_b32 v54, 0xffffff00, v126
    v_and_b32 v55, 0xffffff00, v127
    s_branch L_pollB_ok
L_pollB_g1:
    v_and_b32 v40, 0xffffff00, v128
    v_and_b32 v41, 0xffffff00, v129
    v_and_b32 v42, 0xffffff00, v130
    v_and_b32 v43, 0xffffff00, v131
    v_and_b32 v44, 0xffffff00, v132
    v_and_b32 v45, 0xffffff00, v133
    v_and_b32 v46, 0xffffff00, v134
    v_and_b32 v47, 0xffffff00, v135
    v_and_b32 v48, 0xffffff00, v136
    v_and_b32 v49, 0xffffff00, v137
    v_and_b32 v50, 0xffffff00, v138
    v_and_b32 v51, 0xffffff00, v139
    v_and_b32 v52, 0xffffff00, v140
    v_and_b32 v53, 0xffffff00, v141
    v_and_b32 v54, 0xffffff00, v142
    v_and_b32 v55, 0xffffff00, v143
    s_branch L_pollB_ok
L_pollB_g2:
    v_and_b32 v40, 0xffffff00, v144
    v_and_b32 v41, 0xffffff00, v145
    v_and_b32 v42, 0xffffff00, v146
    v_and_b32 v43, 0xffffff00, v147
    v_and_b32 v44, 0xffffff00, v148
    v_and_b32 v45, 0xffffff00, v149
    v_and_b32 v46, 0xffffff00, v150
    v_and_b32 v47, 0xffffff00, v151
    v_and_b32 v48, 0xffffff00, v152
    v_and_b32 v49, 0xffffff00, v153
    v_and_b32 v50, 0xffffff00, v154
    v_and_b32 v51, 0xffffff00, v155
    v_and_b32 v52, 0xffffff00, v156
    v_and_b32 v53, 0xffffff00, v157
    v_and_b32 v54, 0xffffff00, v158
    v_and_b32 v55, 0xffffff00, v159
L_pollB_ok:
    s_nop 1
    v_add_f32 v40, v40, v44
    v_add_f32 v41, v41, v45
    v_add_f32 v42, v42, v46
    v_add_f32 v43, v43, v47
    v_add_f32 v48, v48, v52
    v_add_f32 v49, v49, v53
    v_add_f32 v50, v50, v54
    v_add_f32 v51, v51, v55
    v_add_f32 v40, v40, v48
    v_add_f32 v41, v41, v49
    v_add_f32 v42, v42, v50
    v_add_f32 v43, v43, v51
    v_permlane32_swap_b32 v40, v41
    s_nop 0
    v_permlane32_swap_b32 v42, v43
    v_add_f32 v40, v40, v41
    v_add_f32 v42, v42, v43
    s_nop 1
    v_permlane16_swap_b32 v40, v42
    v_add_f32 v40, v40, v42
    s_nop 1
    v_add_f32_dpp v40, v40, v40 row_ror:8 row_mask:0xf bank_mask:0xf
    v_cvt_pk_bf16_f32 v40, v40, v40
    v_and_b32 v40, 0xffff0000, v40
    v_mul_f32 v40, v40, v232
    v_cvt_pk_bf16_f32 v40, v40, v40
    v_and_b32 v40, 0xffff0000, v40
    v_add_f32 v40, v40, v236
    v_cvt_pk_bf16_f32 v40, v40, v40
    buffer_store_short v40, v249, s[44:47], s73 offen
L_fin_end:
    s_endpgm
L_svc_gather:
    s_mov_b32 s44, s22
    s_mov_b32 s45, s23
    s_mov_b32 s46, 2304
    s_mov_b32 s47, 0x20000
    v_mov_b32 v251, 0xff800000
    s_cmp_eq_u32 s30, 0
    s_cbranch_scc1 L_s_g
    s_cmp_eq_u32 s30, 3
    s_cbranch_scc1 L_s_g
    s_sub_u32 s68, s30, 1
    s_lshl_b32 s68, s68, 5
    s_add_u32 s68, s68, s32
    s_cmp_ge_u32 s68, 36
    s_cbranch_scc1 L_s_g
    s_mov_b32 s78, 1
    s_lshl_b32 s71, s68, 12
    s_add_u32 s72, s71, 786432
    s_add_u32 s71, s71, 524288
    s_cmp_ge_u32 s68, 18
    s_cselect_b32 s73, 18, 0
    s_cselect_b32 s3, 1152, 0
    s_sub_u32 s73, s68, s73
    s_lshl_b32 s73, s73, 6
    s_add_u32 s73, s73, s3
    v_and_b32 v4, 7, v0
    v_lshlrev_b32 v4, 3, v4
    v_and_b32 v5, 1, v2
    v_lshl_add_u32 v4, v5, 2, v4
    v_lshrrev_b32 v5, 1, v2
    v_lshl_add_u32 v4, v5, 1, v4
    v_and_b32 v5, 8, v0
    v_lshlrev_b32 v5, 28, v5
    v_or_b32 v249, v4, v5
    buffer_load_ushort v6, v4, s[48:51], s73 offen
    s_waitcnt vmcnt(0)
    v_lshlrev_b32 v236, 16, v6
L_s_g:
    s_lshl_b32 s3, s28, 10
    s_add_u32 s66, s64, s3
    s_add_u32 s66, s66, 1179648
    v_lshlrev_b32 v12, 4, v0
    v_and_b32 v4, 1, v2
    v_lshlrev_b32 v4, 4, v4
    v_lshl_add_u32 v4, v3, 5, v4
    v_lshrrev_b32 v5, 5, v0
    v_lshl_add_u32 v4, v5, 9, v4
    s_lshl_b32 s3, s28, 10
    v_add_u32 v13, s3, v4
    s_mov_b32 s79, 1048576
L_pg1:
    buffer_load_dwordx4 v[20:23], v12, s[56:59], s66 offen sc1
    s_waitcnt vmcnt(0)
    v_perm_b32 v5, v21, v20, s97
    v_perm_b32 v7, v23, v22, v253
    v_or_b32 v4, v5, v7
    v_xor_b32 v4, v4, v252
    v_cmp_ne_u32 vcc, 0, v4
    v_xor_b32 v5, 33686018, v4
    v_cmp_ne_u32 s[74:75], 0, v5
    s_nop 0
    s_cmp_eq_u64 s[74:75], 0
    s_cselect_b64 vcc, 0, vcc
    s_cselect_b32 s74, 1, 0
    s_cbranch_vccz L_pg1_ok
    s_sleep 8
    s_sub_u32 s79, s79, 1
    s_cbranch_scc0 L_pg1
L_pg1_ok:
    v_mov_b32 v4, s74
    s_lshl_b32 s3, s28, 2
    v_mov_b32 v5, s3
    ds_write_b32 v5, v4 offset:768
    v_and_b32 v20, 0xffffff00, v20
    v_and_b32 v21, 0xffffff00, v21
    v_and_b32 v22, 0xffffff00, v22
    v_and_b32 v23, 0xffffff00, v23
    ds_write_b128 v13, v[20:23] offset:8192
    s_waitcnt lgkmcnt(0)
    s_barrier
    s_cmp_eq_u32 s30, 0
    s_cbranch_scc0 L_svc_common
    ds_read_b128 v[40:43], v241 offset:8192
    ds_read_b128 v[44:47], v241 offset:9216
    ds_read_b128 v[48:51], v241 offset:10240
    ds_read_b128 v[52:55], v241 offset:11264
    ds_read_b128 v[56:59], v241 offset:12288
    ds_read_b128 v[60:63], v241 offset:13312
    ds_read_b128 v[64:67], v241 offset:14336
    ds_read_b128 v[68:71], v241 offset:15360
    ds_read_b128 v[24:27], v240 offset:768
    ds_read_b128 v[28:31], v240 offset:784
    s_waitcnt lgkmcnt(8)
    v_add_f32 v40, v40, v44
    v_add_f32 v41, v41, v45
    v_add_f32 v42, v42, v46
    v_add_f32 v43, v43, v47
    s_waitcnt lgkmcnt(7)
    v_add_f32 v40, v40, v48
    v_add_f32 v41, v41, v49
    v_add_f32 v42, v42, v50
    v_add_f32 v43, v43, v51
    s_waitcnt lgkmcnt(6)
    v_add_f32 v40, v40, v52
    v_add_f32 v41, v41, v53
    v_add_f32 v42, v42, v54
    v_add_f32 v43, v43, v55
    s_waitcnt lgkmcnt(5)
    v_add_f32 v40, v40, v56
    v_add_f32 v41, v41, v57
    v_add_f32 v42, v42, v58
    v_add_f32 v43, v43, v59
    s_waitcnt lgkmcnt(4)
    v_add_f32 v40, v40, v60
    v_add_f32 v41, v41, v61
    v_add_f32 v42, v42, v62
    v_add_f32 v43, v43, v63
    s_waitcnt lgkmcnt(3)
    v_add_f32 v40, v40, v64
    v_add_f32 v41, v41, v65
    v_add_f32 v42, v42, v66
    v_add_f32 v43, v43, v67
    s_waitcnt lgkmcnt(2)
    v_add_f32 v40, v40, v68
    v_add_f32 v41, v41, v69
    v_add_f32 v42, v42, v70
    v_add_f32 v43, v43, v71
    v_cvt_pk_bf16_f32 v20, v40, v41
    v_cvt_pk_bf16_f32 v22, v42, v43
    s_waitcnt lgkmcnt(0)
    v_min3_u32 v24, v24, v25, v26
    v_min3_u32 v24, v24, v27, v28
    v_min3_u32 v24, v24, v29, v30
    v_min_u32 v24, v24, v31
    s_nop 0
    v_readfirstlane_b32 s74, v24
    s_nop 0
    s_mul_i32 s74, s74, 33686018
    s_xor_b32 s3, s96, s74
    v_mov_b32 v21, s3
    v_mov_b32 v23, s3
    s_cmp_lg_u32 s74, 0
    s_cbranch_scc1 L_st5a
    buffer_store_dwordx4 v[20:23], v241, s[56:59], s65 offen sc1
    s_branch L_st5b
L_st5a:
    buffer_store_dwordx4 v[20:23], v241, s[56:59], s65 offen
L_st5b:
L_svc_common:
    s_barrier
    s_cmp_eq_u32 s30, 0
    s_cbranch_scc0 L_nofp
    ds_read_b128 v[20:23], v241 offset:22528
    ds_read_b128 v[24:27], v241 offset:23552
    ds_read_b128 v[28:31], v241 offset:24576
    ds_read_b128 v[36:39], v241 offset:25600
    ds_read_b128 v[40:43], v241 offset:26624
    ds_read_b128 v[44:47], v241 offset:27648
    ds_read_b128 v[48:51], v241 offset:28672
    ds_read_b128 v[52:55], v241 offset:29696
    ds_read_b128 v[56:59], v241 offset:30720
    ds_read_b128 v[60:63], v241 offset:31744
    s_waitcnt lgkmcnt(0)
    v_add_f32 v20, v20, v44
    v_add_f32 v21, v21, v45
    v_add_f32 v22, v22, v46
    v_add_f32 v23, v23, v47
    v_add_f32 v24, v24, v48
    v_add_f32 v25, v25, v49
    v_add_f32 v26, v26, v50
    v_add_f32 v27, v27, v51
    v_add_f32 v28, v28, v52
    v_add_f32 v29, v29, v53
    v_add_f32 v30, v30, v54
    v_add_f32 v31, v31, v55
    v_add_f32 v36, v36, v56
    v_add_f32 v37, v37, v57
    v_add_f32 v38, v38, v58
    v_add_f32 v39, v39, v59
    v_add_f32 v40, v40, v60
    v_add_f32 v41, v41, v61
    v_add_f32 v42, v42, v62
    v_add_f32 v43, v43, v63
    s_cmp_lt_u32 s32, 8
    s_cbranch_scc0 L_fp2
    ds_read_b128 v[44:47], v241 offset:32768
    ds_read_b128 v[48:51], v241 offset:33792
    ds_read_b128 v[52:55], v241 offset:34816
    ds_read_b128 v[56:59], v241 offset:35840
    ds_read_b128 v[60:63], v241 offset:36864
    s_waitcnt lgkmcnt(0)
    v_add_f32 v20, v20, v44
    v_add_f32 v21, v21, v45
    v_add_f32 v22, v22, v46
    v_add_f32 v23, v23, v47
    v_add_f32 v24, v24, v48
    v_add_f32 v25, v25, v49
    v_add_f32 v26, v26, v50
    v_add_f32 v27, v27, v51
    v_add_f32 v28, v28, v52
    v_add_f32 v29, v29, v53
    v_add_f32 v30, v30, v54
    v_add_f32 v31, v31, v55
    v_add_f32 v36, v36, v56
    v_add_f32 v37, v37, v57
    v_add_f32 v38, v38, v58
    v_add_f32 v39, v39, v59
    v_add_f32 v40, v40, v60
    v_add_f32 v41, v41, v61
    v_add_f32 v42, v42, v62
    v_add_f32 v43, v43, v63
L_fp2:
    v_and_b32 v4, 1, v2
    v_lshlrev_b32 v4, 2, v4
    v_lshl_add_u32 v4, v3, 3, v4
    v_lshrrev_b32 v5, 1, v2
    v_mul_u32_u24 v5, 18, v5
    v_lshrrev_b32 v6, 5, v4
    v_add_u32 v5, v5, v6
    v_mul_u32_u24 v5, 4096, v5
    v_and_b32 v4, 31, v4
    v_lshl_add_u32 v5, v4, 2, v5
    v_cmp_gt_u32 vcc, 8, v3
    v_mov_b32 v4, 0x80000000
    s_nop 0
    v_cndmask_b32 v6, v4, v5, vcc
    s_lshl_b32 s3, s32, 7
    s_add_u32 s3, s3, 786432
    v_perm_b32 v20, v20, v252, s60
    v_perm_b32 v21, v21, v252, s61
    v_perm_b32 v22, v22, v252, s62
    v_perm_b32 v23, v23, v252, s63
    buffer_store_dwordx4 v[20:23], v5, s[56:59], s3 offen sc1
    s_add_u32 s3, s3, 16384
    v_perm_b32 v24, v24, v252, s60
    v_perm_b32 v25, v25, v252, s61
    v_perm_b32 v26, v26, v252, s62
    v_perm_b32 v27, v27, v252, s63
    buffer_store_dwordx4 v[24:27], v5, s[56:59], s3 offen sc1
    s_add_u32 s3, s3, 16384
    v_perm_b32 v28, v28, v252, s60
    v_perm_b32 v29, v29, v252, s61
    v_perm_b32 v30, v30, v252, s62
    v_perm_b32 v31, v31, v252, s63
    buffer_store_dwordx4 v[28:31], v5, s[56:59], s3 offen sc1
    s_add_u32 s3, s3, 16384
    v_perm_b32 v36, v36, v252, s60
    v_perm_b32 v37, v37, v252, s61
    v_perm_b32 v38, v38, v252, s62
    v_perm_b32 v39, v39, v252, s63
    buffer_store_dwordx4 v[36:39], v5, s[56:59], s3 offen sc1
    s_add_u32 s3, s3, 16384
    v_perm_b32 v40, v40, v252, s60
    v_perm_b32 v41, v41, v252, s61
    v_perm_b32 v42, v42, v252, s62
    v_perm_b32 v43, v43, v252, s63
    buffer_store_dwordx4 v[40:43], v6, s[56:59], s3 offen sc1
    s_add_u32 s3, s3, 16384
L_nofp:
L_noF:
    s_cmp_eq_u32 s30, 3
    s_cbranch_scc0 L_noprobe
    s_mov_b64 exec, 0x7f
    s_add_u32 s35, s64, 10368
    s_mov_b32 s79, 1048576
L_probe:
    buffer_load_dword v24, v240, s[56:59], s35 offen sc1
    s_waitcnt vmcnt(0)
    v_cmp_ne_u32 vcc, v24, v252
    s_cbranch_vccz L_probe_ok
    s_sleep 8
    s_sub_u32 s79, s79, 1
    s_cbranch_scc0 L_probe
L_probe_ok:
    s_mov_b64 exec, -1
L_noprobe:
    s_barrier
    s_cmp_eq_u32 s78, 1
    s_cbranch_scc0 L_gatherA
    buffer_load_dwordx4 v[160:163], v241, s[56:59], s72 offen offset:0 sc1
    buffer_load_dwordx4 v[164:167], v241, s[56:59], s72 offen offset:1024 sc1
    buffer_load_dwordx4 v[168:171], v241, s[56:59], s72 offen offset:2048 sc1
    buffer_load_dwordx4 v[172:175], v241, s[56:59], s72 offen offset:3072 sc1
    s_branch L_gatherA
L_svc_lo:
    s_barrier
    v_mov_b32 v240, 0
    s_lshl_b32 s64, s32, 14
    v_and_b32 v4, 31, v0
    v_lshrrev_b32 v5, 5, v0
    v_mul_u32_u24 v5, 1152, v5
    v_lshl_add_u32 v8, v4, 4, v5
    v_cmp_gt_u32 vcc, 8, v4
    v_mov_b32 v5, 0x80000000
    s_nop 0
    v_cndmask_b32 v9, v5, v8, vcc
    s_waitcnt lgkmcnt(0)
    s_load_dword s96, s[26:27], 720896
    s_mov_b32 s48, s4
    s_mov_b32 s49, s5
    s_mov_b32 s50, 2304
    s_mov_b32 s51, 0x20000
    buffer_load_dwordx4 v[20:23], v8, s[48:51], 0 offen
    buffer_load_dwordx4 v[24:27], v8, s[48:51], 0 offen offset:512
    buffer_load_dwordx4 v[28:31], v9, s[48:51], 0 offen offset:1024
    s_mov_b32 s56, s26
    s_mov_b32 s57, s27
    s_mov_b32 s58, 1703936
    s_mov_b32 s59, 0x20000
    v_and_b32 v4, 1, v0
    v_lshlrev_b32 v4, 4, v4
    v_mov_b32 v5, 0xffff
    v_lshlrev_b32 v4, v4, v5
    v_bfe_u32 v5, v0, 1, 2
    v_cmp_eq_u32 vcc, 0, v5
    s_nop 1
    v_cndmask_b32 v16, 0, v4, vcc
    v_cmp_eq_u32 vcc, 1, v5
    s_nop 1
    v_cndmask_b32 v17, 0, v4, vcc
    v_cmp_eq_u32 vcc, 2, v5
    s_nop 1
    v_cndmask_b32 v18, 0, v4, vcc
    v_cmp_eq_u32 vcc, 3, v5
    s_nop 1
    v_cndmask_b32 v19, 0, v4, vcc
    s_waitcnt vmcnt(0) lgkmcnt(0)
    s_mul_i32 s96, s96, 1664525
    s_add_u32 s96, s96, 1013904223
    s_and_b32 s3, s96, 0xff
    s_mul_i32 s3, s3, 0x01010101
    s_cmp_eq_u32 s3, s96
    s_cselect_b32 s3, 0x100, 0
    s_xor_b32 s96, s96, s3
    v_mov_b32 v252, s96
    s_mov_b32 s60, 117835008
    s_mov_b32 s61, 117835009
    s_mov_b32 s62, 117835010
    s_mov_b32 s63, 117835011
    s_mov_b32 s97, 0x0c0c0400
    v_mov_b32 v253, 0x04000c0c
    v_lshlrev_b32 v200, 16, v20
    v_and_b32 v201, 0xffff0000, v20
    v_lshlrev_b32 v202, 16, v21
    v_and_b32 v203, 0xffff0000, v21
    v_lshlrev_b32 v204, 16, v22
    v_and_b32 v205, 0xffff0000, v22
    v_lshlrev_b32 v206, 16, v23
    v_and_b32 v207, 0xffff0000, v23
    v_lshlrev_b32 v208, 16, v24
    v_and_b32 v209, 0xffff0000, v24
    v_lshlrev_b32 v210, 16, v25
    v_and_b32 v211, 0xffff0000, v25
    v_lshlrev_b32 v212, 16, v26
    v_and_b32 v213, 0xffff0000, v26
    v_lshlrev_b32 v214, 16, v27
    v_and_b32 v215, 0xffff0000, v27
    v_lshlrev_b32 v216, 16, v28
    v_and_b32 v217, 0xffff0000, v28
    v_lshlrev_b32 v218, 16, v29
    v_and_b32 v219, 0xffff0000, v29
    v_lshlrev_b32 v220, 16, v30
    v_and_b32 v221, 0xffff0000, v30
    v_lshlrev_b32 v222, 16, v31
    v_and_b32 v223, 0xffff0000, v31
    v_add_f32 v32, v200, v201
    v_add_f32 v33, v202, v203
    v_add_f32 v32, v32, v204
    v_add_f32 v33, v33, v205
    v_add_f32 v32, v32, v206
    v_add_f32 v33, v33, v207
    v_add_f32 v32, v32, v208
    v_add_f32 v33, v33, v209
    v_add_f32 v32, v32, v210
    v_add_f32 v33, v33, v211
    v_add_f32 v32, v32, v212
    v_add_f32 v33, v33, v213
    v_add_f32 v32, v32, v214
    v_add_f32 v33, v33, v215
    v_add_f32 v32, v32, v216
    v_add_f32 v33, v33, v217
    v_add_f32 v32, v32, v218
    v_add_f32 v33, v33, v219
    v_add_f32 v32, v32, v220
    v_add_f32 v33, v33, v221
    v_add_f32 v32, v32, v222
    v_add_f32 v33, v33, v223
    v_add_f32 v32, v32, v33
    s_nop 1
    v_add_f32_dpp v32, v32, v32 row_ror:8 row_mask:0xf bank_mask:0xf
    s_nop 1
    v_add_f32_dpp v32, v32, v32 row_ror:4 row_mask:0xf bank_mask:0xf
    s_nop 1
    v_add_f32_dpp v32, v32, v32 row_ror:2 row_mask:0xf bank_mask:0xf
    s_nop 1
    v_add_f32_dpp v32, v32, v32 row_ror:1 row_mask:0xf bank_mask:0xf
    s_nop 1
    v_add_f32_dpp v32, v32, v32 row_bcast:15 row_mask:0xa bank_mask:0xf
    v_mul_f32 v32, 0x3ae38e39, v32
    s_nop 0
    v_readlane_b32 s72, v32, 31
    v_readlane_b32 s75, v32, 63
    s_nop 0
    v_mov_b32 v34, s72
    s_mov_b32 exec_lo, 0
    v_mov_b32 v34, s75
    s_mov_b32 exec_lo, -1
    v_sub_f32 v33, v200, v34
    v_mul_f32 v32, v33, v33
    v_sub_f32 v33, v201, v34
    v_fmac_f32 v32, v33, v33
    v_sub_f32 v33, v202, v34
    v_fmac_f32 v32, v33, v33
    v_sub_f32 v33, v203, v34
    v_fmac_f32 v32, v33, v33
    v_sub_f32 v33, v204, v34
    v_fmac_f32 v32, v33, v33
    v_sub_f32 v33, v205, v34
    v_fmac_f32 v32, v33, v33
    v_sub_f32 v33, v206, v34
    v_fmac_f32 v32, v33, v33
    v_sub_f32 v33, v207, v34
    v_fmac_f32 v32, v33, v33
    v_sub_f32 v33, v208, v34
    v_fmac_f32 v32, v33, v33
    v_sub_f32 v33, v209, v34
    v_fmac_f32 v32, v33, v33
    v_sub_f32 v33, v210, v34
    v_fmac_f32 v32, v33, v33
    v_sub_f32 v33, v211, v34
    v_fmac_f32 v32, v33, v33
    v_sub_f32 v33, v212, v34
    v_fmac_f32 v32, v33, v33
    v_sub_f32 v33, v213, v34
    v_fmac_f32 v32, v33, v33
    v_sub_f32 v33, v214, v34
    v_fmac_f32 v32, v33, v33
    v_sub_f32 v33, v215, v34
    v_fmac_f32 v32, v33, v33
    s_mov_b32 exec_lo, 0xff
    s_mov_b32 exec_hi, 0xff
    v_sub_f32 v33, v216, v34
    v_fmac_f32 v32, v33, v33
    v_sub_f32 v33, v217, v34
    v_fmac_f32 v32, v33, v33
    v_sub_f32 v33, v218, v34
    v_fmac_f32 v32, v33, v33
    v_sub_f32 v33, v219, v34
    v_fmac_f32 v32, v33, v33
    v_sub_f32 v33, v220, v34
    v_fmac_f32 v32, v33, v33
    v_sub_f32 v33, v221, v34
    v_fmac_f32 v32, v33, v33
    v_sub_f32 v33, v222, v34
    v_fmac_f32 v32, v33, v33
    v_sub_f32 v33, v223, v34
    v_fmac_f32 v32, v33, v33
    s_mov_b64 exec, -1
    v_cvt_pk_bf16_f32 v34, v34, v34
    v_and_b32 v34, 0xffff0000, v34
    v_add_f32_dpp v32, v32, v32 row_ror:8 row_mask:0xf bank_mask:0xf
    s_nop 1
    v_add_f32_dpp v32, v32, v32 row_ror:4 row_mask:0xf bank_mask:0xf
    s_nop 1
    v_add_f32_dpp v32, v32, v32 row_ror:2 row_mask:0xf bank_mask:0xf
    s_nop 1
    v_add_f32_dpp v32, v32, v32 row_ror:1 row_mask:0xf bank_mask:0xf
    s_nop 1
    v_add_f32_dpp v32, v32, v32 row_bcast:15 row_mask:0xa bank_mask:0xf
    v_mul_f32 v32, 0x3ae38e39, v32
    v_cvt_pk_bf16_f32 v32, v32, v32
    v_and_b32 v32, 0xffff0000, v32
    v_add_f32 v32, 0x3727c5ac, v32
    v_cvt_pk_bf16_f32 v32, v32, v32
    v_and_b32 v32, 0xffff0000, v32
    v_sqrt_f32 v32, v32
    s_nop 0
    v_cvt_pk_bf16_f32 v32, v32, v32
    v_and_b32 v32, 0xffff0000, v32
    v_rcp_f32 v33, v32
    v_readlane_b32 s72, v34, 31
    v_readlane_b32 s75, v34, 63
    v_readlane_b32 s73, v32, 31
    v_readlane_b32 s76, v32, 63
    v_readlane_b32 s74, v33, 31
    v_readlane_b32 s77, v33, 63
    v_mov_b32 v35, s72
    s_mov_b32 exec_lo, 0
    v_mov_b32 v35, s75
    s_mov_b32 exec_lo, -1
    v_mov_b32 v36, s73
    s_mov_b32 exec_lo, 0
    v_mov_b32 v36, s76
    s_mov_b32 exec_lo, -1
    v_mov_b32 v37, s74
    s_mov_b32 exec_lo, 0
    v_mov_b32 v37, s77
    s_mov_b32 exec_lo, -1
    v_subrev_f32 v200, v35, v200
    v_cvt_pk_bf16_f32 v200, v200, v200
    v_and_b32 v200, 0xffff0000, v200
    v_mul_f32 v32, v37, v200
    v_fma_f32 v33, -v32, v36, v200
    v_fma_f32 v32, v33, v37, v32
    v_cvt_pk_bf16_f32 v200, v32, v32
    v_subrev_f32 v201, v35, v201
    v_cvt_pk_bf16_f32 v201, v201, v201
    v_and_b32 v201, 0xffff0000, v201
    v_mul_f32 v32, v37, v201
    v_fma_f32 v33, -v32, v36, v201
    v_fma_f32 v32, v33, v37, v32
    v_cvt_pk_bf16_f32 v201, v32, v32
    v_subrev_f32 v202, v35, v202
    v_cvt_pk_bf16_f32 v202, v202, v202
    v_and_b32 v202, 0xffff0000, v202
    v_mul_f32 v32, v37, v202
    v_fma_f32 v33, -v32, v36, v202
    v_fma_f32 v32, v33, v37, v32
    v_cvt_pk_bf16_f32 v202, v32, v32
    v_subrev_f32 v203, v35, v203
    v_cvt_pk_bf16_f32 v203, v203, v203
    v_and_b32 v203, 0xffff0000, v203
    v_mul_f32 v32, v37, v203
    v_fma_f32 v33, -v32, v36, v203
    v_fma_f32 v32, v33, v37, v32
    v_cvt_pk_bf16_f32 v203, v32, v32
    v_subrev_f32 v204, v35, v204
    v_cvt_pk_bf16_f32 v204, v204, v204
    v_and_b32 v204, 0xffff0000, v204
    v_mul_f32 v32, v37, v204
    v_fma_f32 v33, -v32, v36, v204
    v_fma_f32 v32, v33, v37, v32
    v_cvt_pk_bf16_f32 v204, v32, v32
    v_subrev_f32 v205, v35, v205
    v_cvt_pk_bf16_f32 v205, v205, v205
    v_and_b32 v205, 0xffff0000, v205
    v_mul_f32 v32, v37, v205
    v_fma_f32 v33, -v32, v36, v205
    v_fma_f32 v32, v33, v37, v32
    v_cvt_pk_bf16_f32 v205, v32, v32
    v_subrev_f32 v206, v35, v206
    v_cvt_pk_bf16_f32 v206, v206, v206
    v_and_b32 v206, 0xffff0000, v206
    v_mul_f32 v32, v37, v206
    v_fma_f32 v33, -v32, v36, v206
    v_fma_f32 v32, v33, v37, v32
    v_cvt_pk_bf16_f32 v206, v32, v32
    v_subrev_f32 v207, v35, v207
    v_cvt_pk_bf16_f32 v207, v207, v207
    v_and_b32 v207, 0xffff0000, v207
    v_mul_f32 v32, v37, v207
    v_fma_f32 v33, -v32, v36, v207
    v_fma_f32 v32, v33, v37, v32
    v_cvt_pk_bf16_f32 v207, v32, v32
    v_subrev_f32 v208, v35, v208
    v_cvt_pk_bf16_f32 v208, v208, v208
    v_and_b32 v208, 0xffff0000, v208
    v_mul_f32 v32, v37, v208
    v_fma_f32 v33, -v32, v36, v208
    v_fma_f32 v32, v33, v37, v32
    v_cvt_pk_bf16_f32 v208, v32, v32
    v_subrev_f32 v209, v35, v209
    v_cvt_pk_bf16_f32 v209, v209, v209
    v_and_b32 v209, 0xffff0000, v209
    v_mul_f32 v32, v37, v209
    v_fma_f32 v33, -v32, v36, v209
    v_fma_f32 v32, v33, v37, v32
    v_cvt_pk_bf16_f32 v209, v32, v32
    v_subrev_f32 v210, v35, v210
    v_cvt_pk_bf16_f32 v210, v210, v210
    v_and_b32 v210, 0xffff0000, v210
    v_mul_f32 v32, v37, v210
    v_fma_f32 v33, -v32, v36, v210
    v_fma_f32 v32, v33, v37, v32
    v_cvt_pk_bf16_f32 v210, v32, v32
    v_subrev_f32 v211, v35, v211
    v_cvt_pk_bf16_f32 v211, v211, v211
    v_and_b32 v211, 0xffff0000, v211
    v_mul_f32 v32, v37, v211
    v_fma_f32 v33, -v32, v36, v211
    v_fma_f32 v32, v33, v37, v32
    v_cvt_pk_bf16_f32 v211, v32, v32
    v_subrev_f32 v212, v35, v212
    v_cvt_pk_bf16_f32 v212, v212, v212
    v_and_b32 v212, 0xffff0000, v212
    v_mul_f32 v32, v37, v212
    v_fma_f32 v33, -v32, v36, v212
    v_fma_f32 v32, v33, v37, v32
    v_cvt_pk_bf16_f32 v212, v32, v32
    v_subrev_f32 v213, v35, v213
    v_cvt_pk_bf16_f32 v213, v213, v213
    v_and_b32 v213, 0xffff0000, v213
    v_mul_f32 v32, v37, v213
    v_fma_f32 v33, -v32, v36, v213
    v_fma_f32 v32, v33, v37, v32
    v_cvt_pk_bf16_f32 v213, v32, v32
    v_subrev_f32 v214, v35, v214
    v_cvt_pk_bf16_f32 v214, v214, v214
    v_and_b32 v214, 0xffff0000, v214
    v_mul_f32 v32, v37, v214
    v_fma_f32 v33, -v32, v36, v214
    v_fma_f32 v32, v33, v37, v32
    v_cvt_pk_bf16_f32 v214, v32, v32
    v_subrev_f32 v215, v35, v215
    v_cvt_pk_bf16_f32 v215, v215, v215
    v_and_b32 v215, 0xffff0000, v215
    v_mul_f32 v32, v37, v215
    v_fma_f32 v33, -v32, v36, v215
    v_fma_f32 v32, v33, v37, v32
    v_cvt_pk_bf16_f32 v215, v32, v32
    v_subrev_f32 v216, v35, v216
    v_cvt_pk_bf16_f32 v216, v216, v216
    v_and_b32 v216, 0xffff0000, v216
    v_mul_f32 v32, v37, v216
    v_fma_f32 v33, -v32, v36, v216
    v_fma_f32 v32, v33, v37, v32
    v_cvt_pk_bf16_f32 v216, v32, v32
    v_subrev_f32 v217, v35, v217
    v_cvt_pk_bf16_f32 v217, v217, v217
    v_and_b32 v217, 0xffff0000, v217
    v_mul_f32 v32, v37, v217
    v_fma_f32 v33, -v32, v36, v217
    v_fma_f32 v32, v33, v37, v32
    v_cvt_pk_bf16_f32 v217, v32, v32
    v_subrev_f32 v218, v35, v218
    v_cvt_pk_bf16_f32 v218, v218, v218
    v_and_b32 v218, 0xffff0000, v218
    v_mul_f32 v32, v37, v218
    v_fma_f32 v33, -v32, v36, v218
    v_fma_f32 v32, v33, v37, v32
    v_cvt_pk_bf16_f32 v218, v32, v32
    v_subrev_f32 v219, v35, v219
    v_cvt_pk_bf16_f32 v219, v219, v219
    v_and_b32 v219, 0xffff0000, v219
    v_mul_f32 v32, v37, v219
    v_fma_f32 v33, -v32, v36, v219
    v_fma_f32 v32, v33, v37, v32
    v_cvt_pk_bf16_f32 v219, v32, v32
    v_subrev_f32 v220, v35, v220
    v_cvt_pk_bf16_f32 v220, v220, v220
    v_and_b32 v220, 0xffff0000, v220
    v_mul_f32 v32, v37, v220
    v_fma_f32 v33, -v32, v36, v220
    v_fma_f32 v32, v33, v37, v32
    v_cvt_pk_bf16_f32 v220, v32, v32
    v_subrev_f32 v221, v35, v221
    v_cvt_pk_bf16_f32 v221, v221, v221
    v_and_b32 v221, 0xffff0000, v221
    v_mul_f32 v32, v37, v221
    v_fma_f32 v33, -v32, v36, v221
    v_fma_f32 v32, v33, v37, v32
    v_cvt_pk_bf16_f32 v221, v32, v32
    v_subrev_f32 v222, v35, v222
    v_cvt_pk_bf16_f32 v222, v222, v222
    v_and_b32 v222, 0xffff0000, v222
    v_mul_f32 v32, v37, v222
    v_fma_f32 v33, -v32, v36, v222
    v_fma_f32 v32, v33, v37, v32
    v_cvt_pk_bf16_f32 v222, v32, v32
    v_subrev_f32 v223, v35, v223
    v_cvt_pk_bf16_f32 v223, v223, v223
    v_and_b32 v223, 0xffff0000, v223
    v_mul_f32 v32, v37, v223
    v_fma_f32 v33, -v32, v36, v223
    v_fma_f32 v32, v33, v37, v32
    v_cvt_pk_bf16_f32 v223, v32, v32
    v_and_b32 v4, 31, v0
    v_lshrrev_b32 v5, 5, v0
    v_mul_u32_u24 v5, 2304, v5
    v_lshl_add_u32 v11, v4, 3, v5
    v_mov_b32 v32, v200
    v_mov_b32 v33, v204
    ds_write_b64 v11, v[32:33] offset:16384
    v_mov_b32 v32, v201
    v_mov_b32 v33, v205
    ds_write_b64 v11, v[32:33] offset:16960
    v_mov_b32 v32, v202
    v_mov_b32 v33, v206
    ds_write_b64 v11, v[32:33] offset:17536
    v_mov_b32 v32, v203
    v_mov_b32 v33, v207
    ds_write_b64 v11, v[32:33] offset:18112
    v_mov_b32 v32, v208
    v_mov_b32 v33, v212
    ds_write_b64 v11, v[32:33] offset:16640
    v_mov_b32 v32, v209
    v_mov_b32 v33, v213
    ds_write_b64 v11, v[32:33] offset:17216
    v_mov_b32 v32, v210
    v_mov_b32 v33, v214
    ds_write_b64 v11, v[32:33] offset:17792
    v_mov_b32 v32, v211
    v_mov_b32 v33, v215
    ds_write_b64 v11, v[32:33] offset:18368
    s_mov_b32 exec_lo, 0xff
    s_mov_b32 exec_hi, 0xff
    v_mov_b32 v32, v216
    v_mov_b32 v33, v220
    ds_write_b64 v11, v[32:33] offset:16896
    v_mov_b32 v32, v217
    v_mov_b32 v33, v221
    ds_write_b64 v11, v[32:33] offset:17472
    v_mov_b32 v32, v218
    v_mov_b32 v33, v222
    ds_write_b64 v11, v[32:33] offset:18048
    v_mov_b32 v32, v219
    v_mov_b32 v33, v223
    ds_write_b64 v11, v[32:33] offset:18624
    s_mov_b64 exec, -1
    s_lshl_b32 s3, s28, 10
    s_add_u32 s66, s64, s3
    s_add_u32 s66, s66, 1179648
    v_lshlrev_b32 v12, 4, v0
    v_and_b32 v4, 1, v2
    v_lshlrev_b32 v4, 4, v4
    v_lshl_add_u32 v4, v3, 5, v4
    v_lshrrev_b32 v5, 5, v0
    v_lshl_add_u32 v4, v5, 9, v4
    s_lshl_b32 s3, s28, 10
    v_add_u32 v13, s3, v4
    s_mov_b32 s79, 1048576
L_pg0:
    buffer_load_dwordx4 v[20:23], v12, s[56:59], s66 offen sc1
    s_waitcnt vmcnt(0)
    v_perm_b32 v5, v21, v20, s97
    v_perm_b32 v7, v23, v22, v253
    v_or_b32 v4, v5, v7
    v_xor_b32 v4, v4, v252
    v_cmp_ne_u32 vcc, 0, v4
    v_xor_b32 v5, 33686018, v4
    v_cmp_ne_u32 s[74:75], 0, v5
    s_nop 0
    s_cmp_eq_u64 s[74:75], 0
    s_cselect_b64 vcc, 0, vcc
    s_cselect_b32 s74, 1, 0
    s_cbranch_vccz L_pg0_ok
    s_sleep 8
    s_sub_u32 s79, s79, 1
    s_cbranch_scc0 L_pg0
L_pg0_ok:
    v_mov_b32 v4, s74
    s_lshl_b32 s3, s28, 2
    v_mov_b32 v5, s3
    ds_write_b32 v5, v4 offset:768
    v_and_b32 v20, 0xffffff00, v20
    v_and_b32 v21, 0xffffff00, v21
    v_and_b32 v22, 0xffffff00, v22
    v_and_b32 v23, 0xffffff00, v23
    ds_write_b128 v13, v[20:23] offset:8192
    s_waitcnt lgkmcnt(0)
    s_barrier
    s_cmp_eq_u32 s28, 3
    s_cbranch_scc1 L_lo_end
    s_lshl_b32 s68, s32, 1
    s_add_u32 s68, s68, s28
    s_cmp_lt_u32 s28, 2
    s_cbranch_scc1 L_ffn
    s_add_u32 s68, s32, 64
    s_cmp_ge_u32 s32, 8
    s_cbranch_scc1 L_lo_end
L_ffn:
    v_bfe_u32 v4, v0, 3, 1
    v_cmp_eq_u32 vcc, 1, v4
    v_mov_b32 v4, s16
    v_mov_b32 v5, s18
    v_cndmask_b32 v60, v4, v5, vcc
    v_mov_b32 v4, s17
    v_mov_b32 v5, s19
    v_cndmask_b32 v61, v4, v5, vcc
    v_and_b32 v4, 7, v0
    v_lshlrev_b32 v4, 4, v4
    v_mul_u32_u24 v5, 9216, v2
    s_lshl_b32 s3, s68, 7
    v_add3_u32 v4, v4, v5, s3
    v_add_co_u32 v60, vcc, v60, v4
    s_nop 1
    v_addc_co_u32 v61, vcc, 0, v61, vcc
    s_mov_b32 s66, 36864
    s_mov_b32 s67, 0
    s_mul_i32 s3, s68, 73728
    s_add_u32 s36, s20, s3
    s_addc_u32 s37, s21, 0
    s_mov_b32 s38, 73728
    s_mov_b32 s39, 0x20000
    v_mul_u32_u24 v62, 1152, v2
    v_lshl_add_u32 v62, v3, 4, v62
    v_cmp_gt_u32 vcc, 8, v3
    v_mov_b32 v4, 0x80000000
    s_nop 0
    v_cndmask_b32 v63, v4, v62, vcc
    s_mov_b32 s69, 0
    global_load_dwordx4 v[64:67], v[60:61], off nt
    v_lshl_add_u64 v[60:61], v[60:61], 0, s[66:67]
    global_load_dwordx4 v[68:71], v[60:61], off nt
    v_lshl_add_u64 v[60:61], v[60:61], 0, s[66:67]
    global_load_dwordx4 v[72:75], v[60:61], off nt
    v_lshl_add_u64 v[60:61], v[60:61], 0, s[66:67]
    global_load_dwordx4 v[76:79], v[60:61], off nt
    v_lshl_add_u64 v[60:61], v[60:61], 0, s[66:67]
    global_load_dwordx4 v[80:83], v[60:61], off nt
    v_lshl_add_u64 v[60:61], v[60:61], 0, s[66:67]
    global_load_dwordx4 v[84:87], v[60:61], off nt
    v_lshl_add_u64 v[60:61], v[60:61], 0, s[66:67]
    global_load_dwordx4 v[88:91], v[60:61], off nt
    v_lshl_add_u64 v[60:61], v[60:61], 0, s[66:67]
    global_load_dwordx4 v[92:95], v[60:61], off nt
    v_lshl_add_u64 v[60:61], v[60:61], 0, s[66:67]
    global_load_dwordx4 v[96:99], v[60:61], off nt
    v_lshl_add_u64 v[60:61], v[60:61], 0, s[66:67]
    global_load_dwordx4 v[100:103], v[60:61], off nt
    v_lshl_add_u64 v[60:61], v[60:61], 0, s[66:67]
    v_bfe_u32 v4, v0, 3, 1
    v_lshl_add_u32 v4, v4, 2, v2
    v_mul_u32_u24 v11, 576, v4
    s_lshl_b32 s3, s28, 9
    v_lshl_add_u32 v10, v4, 6, s3
    ds_read_b128 v[40:43], v11 offset:16384
    s_waitcnt lgkmcnt(0)
    ds_read_b128 v[44:47], v11 offset:16400
    v_and_b32 v32, v40, v16
    v_and_b32 v33, v40, v17
    v_and_b32 v34, v40, v18
    v_and_b32 v35, v40, v19
    s_waitcnt vmcnt(9)
    s_nop 0
    v_mfma_f32_16x16x32_bf16 v[20:23], v[32:35], v[64:67], 0
    global_load_dwordx4 v[64:67], v[60:61], off nt
    v_lshl_add_u64 v[60:61], v[60:61], 0, s[66:67]
    v_and_b32 v36, v41, v16
    v_and_b32 v37, v41, v17
    v_and_b32 v38, v41, v18
    v_and_b32 v39, v41, v19
    s_waitcnt vmcnt(9)
    s_nop 0
    v_mfma_f32_16x16x32_bf16 v[20:23], v[36:39], v[68:71], v[20:23]
    global_load_dwordx4 v[68:71], v[60:61], off nt
    v_lshl_add_u64 v[60:61], v[60:61], 0, s[66:67]
    v_and_b32 v32, v42, v16
    v_and_b32 v33, v42, v17
    v_and_b32 v34, v42, v18
    v_and_b32 v35, v42, v19
    s_waitcnt vmcnt(9)
    s_nop 0
    v_mfma_f32_16x16x32_bf16 v[20:23], v[32:35], v[72:75], v[20:23]
    global_load_dwordx4 v[72:75], v[60:61], off nt
    v_lshl_add_u64 v[60:61], v[60:61], 0, s[66:67]
    v_and_b32 v36, v43, v16
    v_and_b32 v37, v43, v17
    v_and_b32 v38, v43, v18
    v_and_b32 v39, v43, v19
    s_waitcnt vmcnt(9)
    s_nop 0
    v_mfma_f32_16x16x32_bf16 v[20:23], v[36:39], v[76:79], v[20:23]
    global_load_dwordx4 v[76:79], v[60:61], off nt
    v_lshl_add_u64 v[60:61], v[60:61], 0, s[66:67]
    s_waitcnt lgkmcnt(0)
    ds_read_b128 v[40:43], v11 offset:16416
    v_and_b32 v32, v44, v16
    v_and_b32 v33, v44, v17
    v_and_b32 v34, v44, v18
    v_and_b32 v35, v44, v19
    s_waitcnt vmcnt(9)
    s_nop 0
    v_mfma_f32_16x16x32_bf16 v[20:23], v[32:35], v[80:83], v[20:23]
    global_load_dwordx4 v[80:83], v[60:61], off nt
    v_lshl_add_u64 v[60:61], v[60:61], 0, s[66:67]
    v_and_b32 v36, v45, v16
    v_and_b32 v37, v45, v17
    v_and_b32 v38, v45, v18
    v_and_b32 v39, v45, v19
    s_waitcnt vmcnt(9)
    s_nop 0
    v_mfma_f32_16x16x32_bf16 v[20:23], v[36:39], v[84:87], v[20:23]
    global_load_dwordx4 v[84:87], v[60:61], off nt
    v_lshl_add_u64 v[60:61], v[60:61], 0, s[66:67]
    v_and_b32 v32, v46, v16
    v_and_b32 v33, v46, v17
    v_and_b32 v34, v46, v18
    v_and_b32 v35, v46, v19
    s_waitcnt vmcnt(9)
    s_nop 0
    v_mfma_f32_16x16x32_bf16 v[20:23], v[32:35], v[88:91], v[20:23]
    global_load_dwordx4 v[88:91], v[60:61], off nt
    v_lshl_add_u64 v[60:61], v[60:61], 0, s[66:67]
    v_and_b32 v36, v47, v16
    v_and_b32 v37, v47, v17
    v_and_b32 v38, v47, v18
    v_and_b32 v39, v47, v19
    s_waitcnt vmcnt(9)
    s_nop 0
    v_mfma_f32_16x16x32_bf16 v[20:23], v[36:39], v[92:95], v[20:23]
    global_load_dwordx4 v[92:95], v[60:61], off nt
    v_lshl_add_u64 v[60:61], v[60:61], 0, s[66:67]
    s_waitcnt lgkmcnt(0)
    ds_read_b128 v[44:47], v11 offset:16432
    v_and_b32 v32, v40, v16
    v_and_b32 v33, v40, v17
    v_and_b32 v34, v40, v18
    v_and_b32 v35, v40, v19
    s_waitcnt vmcnt(9)
    s_nop 0
    v_mfma_f32_16x16x32_bf16 v[20:23], v[32:35], v[96:99], v[20:23]
    global_load_dwordx4 v[96:99], v[60:61], off nt
    v_lshl_add_u64 v[60:61], v[60:61], 0, s[66:67]
    v_and_b32 v36, v41, v16
    v_and_b32 v37, v41, v17
    v_and_b32 v38, v41, v18
    v_and_b32 v39, v41, v19
    s_waitcnt vmcnt(9)
    s_nop 0
    v_mfma_f32_16x16x32_bf16 v[20:23], v[36:39], v[100:103], v[20:23]
    global_load_dwordx4 v[100:103], v[60:61], off nt
    v_lshl_add_u64 v[60:61], v[60:61], 0, s[66:67]
    v_and_b32 v32, v42, v16
    v_and_b32 v33, v42, v17
    v_and_b32 v34, v42, v18
    v_and_b32 v35, v42, v19
    s_waitcnt vmcnt(9)
    s_nop 0
    v_mfma_f32_16x16x32_bf16 v[20:23], v[32:35], v[64:67], v[20:23]
    global_load_dwordx4 v[64:67], v[60:61], off nt
    v_lshl_add_u64 v[60:61], v[60:61], 0, s[66:67]
    v_and_b32 v36, v43, v16
    v_and_b32 v37, v43, v17
    v_and_b32 v38, v43, v18
    v_and_b32 v39, v43, v19
    s_waitcnt vmcnt(9)
    s_nop 0
    v_mfma_f32_16x16x32_bf16 v[20:23], v[36:39], v[68:71], v[20:23]
    global_load_dwordx4 v[68:71], v[60:61], off nt
    v_lshl_add_u64 v[60:61], v[60:61], 0, s[66:67]
    s_waitcnt lgkmcnt(0)
    ds_read_b128 v[40:43], v11 offset:16448
    v_and_b32 v32, v44, v16
    v_and_b32 v33, v44, v17
    v_and_b32 v34, v44, v18
    v_and_b32 v35, v44, v19
    s_waitcnt vmcnt(9)
    s_nop 0
    v_mfma_f32_16x16x32_bf16 v[20:23], v[32:35], v[72:75], v[20:23]
    global_load_dwordx4 v[72:75], v[60:61], off nt
    v_lshl_add_u64 v[60:61], v[60:61], 0, s[66:67]
    v_and_b32 v36, v45, v16
    v_and_b32 v37, v45, v17
    v_and_b32 v38, v45, v18
    v_and_b32 v39, v45, v19
    s_waitcnt vmcnt(9)
    s_nop 0
    v_mfma_f32_16x16x32_bf16 v[20:23], v[36:39], v[76:79], v[20:23]
    global_load_dwordx4 v[76:79], v[60:61], off nt
    v_lshl_add_u64 v[60:61], v[60:61], 0, s[66:67]
    v_and_b32 v32, v46, v16
    v_and_b32 v33, v46, v17
    v_and_b32 v34, v46, v18
    v_and_b32 v35, v46, v19
    s_waitcnt vmcnt(9)
    s_nop 0
    v_mfma_f32_16x16x32_bf16 v[20:23], v[32:35], v[80:83], v[20:23]
    global_load_dwordx4 v[80:83], v[60:61], off nt
    v_lshl_add_u64 v[60:61], v[60:61], 0, s[66:67]
    v_and_b32 v36, v47, v16
    v_and_b32 v37, v47, v17
    v_and_b32 v38, v47, v18
    v_and_b32 v39, v47, v19
    s_waitcnt vmcnt(9)
    s_nop 0
    v_mfma_f32_16x16x32_bf16 v[20:23], v[36:39], v[84:87], v[20:23]
    global_load_dwordx4 v[84:87], v[60:61], off nt
    v_lshl_add_u64 v[60:61], v[60:61], 0, s[66:67]
    s_waitcnt lgkmcnt(0)
    ds_read_b128 v[44:47], v11 offset:16464
    v_and_b32 v32, v40, v16
    v_and_b32 v33, v40, v17
    v_and_b32 v34, v40, v18
    v_and_b32 v35, v40, v19
    s_waitcnt vmcnt(9)
    s_nop 0
    v_mfma_f32_16x16x32_bf16 v[20:23], v[32:35], v[88:91], v[20:23]
    global_load_dwordx4 v[88:91], v[60:61], off nt
    v_lshl_add_u64 v[60:61], v[60:61], 0, s[66:67]
    v_and_b32 v36, v41, v16
    v_and_b32 v37, v41, v17
    v_and_b32 v38, v41, v18
    v_and_b32 v39, v41, v19
    s_waitcnt vmcnt(9)
    s_nop 0
    v_mfma_f32_16x16x32_bf16 v[20:23], v[36:39], v[92:95], v[20:23]
    global_load_dwordx4 v[92:95], v[60:61], off nt
    v_lshl_add_u64 v[60:61], v[60:61], 0, s[66:67]
    v_and_b32 v32, v42, v16
    v_and_b32 v33, v42, v17
    v_and_b32 v34, v42, v18
    v_and_b32 v35, v42, v19
    s_waitcnt vmcnt(9)
    s_nop 0
    v_mfma_f32_16x16x32_bf16 v[20:23], v[32:35], v[96:99], v[20:23]
    global_load_dwordx4 v[96:99], v[60:61], off nt
    v_lshl_add_u64 v[60:61], v[60:61], 0, s[66:67]
    v_and_b32 v36, v43, v16
    v_and_b32 v37, v43, v17
    v_and_b32 v38, v43, v18
    v_and_b32 v39, v43, v19
    s_waitcnt vmcnt(9)
    s_nop 0
    v_mfma_f32_16x16x32_bf16 v[20:23], v[36:39], v[100:103], v[20:23]
    global_load_dwordx4 v[100:103], v[60:61], off nt
    v_lshl_add_u64 v[60:61], v[60:61], 0, s[66:67]
    s_waitcnt lgkmcnt(0)
    ds_read_b128 v[40:43], v11 offset:16480
    v_and_b32 v32, v44, v16
    v_and_b32 v33, v44, v17
    v_and_b32 v34, v44, v18
    v_and_b32 v35, v44, v19
    s_waitcnt vmcnt(9)
    s_nop 0
    v_mfma_f32_16x16x32_bf16 v[20:23], v[32:35], v[64:67], v[20:23]
    global_load_dwordx4 v[64:67], v[60:61], off nt
    v_lshl_add_u64 v[60:61], v[60:61], 0, s[66:67]
    v_and_b32 v36, v45, v16
    v_and_b32 v37, v45, v17
    v_and_b32 v38, v45, v18
    v_and_b32 v39, v45, v19
    s_waitcnt vmcnt(9)
    s_nop 0
    v_mfma_f32_16x16x32_bf16 v[20:23], v[36:39], v[68:71], v[20:23]
    global_load_dwordx4 v[68:71], v[60:61], off nt
    v_lshl_add_u64 v[60:61], v[60:61], 0, s[66:67]
    v_and_b32 v32, v46, v16
    v_and_b32 v33, v46, v17
    v_and_b32 v34, v46, v18
    v_and_b32 v35, v46, v19
    s_waitcnt vmcnt(9)
    s_nop 0
    v_mfma_f32_16x16x32_bf16 v[20:23], v[32:35], v[72:75], v[20:23]
    global_load_dwordx4 v[72:75], v[60:61], off nt
    v_lshl_add_u64 v[60:61], v[60:61], 0, s[66:67]
    v_and_b32 v36, v47, v16
    v_and_b32 v37, v47, v17
    v_and_b32 v38, v47, v18
    v_and_b32 v39, v47, v19
    s_waitcnt vmcnt(9)
    s_nop 0
    v_mfma_f32_16x16x32_bf16 v[20:23], v[36:39], v[76:79], v[20:23]
    global_load_dwordx4 v[76:79], v[60:61], off nt
    v_lshl_add_u64 v[60:61], v[60:61], 0, s[66:67]
    s_waitcnt lgkmcnt(0)
    ds_read_b128 v[44:47], v11 offset:16496
    v_and_b32 v32, v40, v16
    v_and_b32 v33, v40, v17
    v_and_b32 v34, v40, v18
    v_and_b32 v35, v40, v19
    s_waitcnt vmcnt(9)
    s_nop 0
    v_mfma_f32_16x16x32_bf16 v[20:23], v[32:35], v[80:83], v[20:23]
    global_load_dwordx4 v[80:83], v[60:61], off nt
    v_lshl_add_u64 v[60:61], v[60:61], 0, s[66:67]
    v_and_b32 v36, v41, v16
    v_and_b32 v37, v41, v17
    v_and_b32 v38, v41, v18
    v_and_b32 v39, v41, v19
    s_waitcnt vmcnt(9)
    s_nop 0
    v_mfma_f32_16x16x32_bf16 v[20:23], v[36:39], v[84:87], v[20:23]
    global_load_dwordx4 v[84:87], v[60:61], off nt
    v_lshl_add_u64 v[60:61], v[60:61], 0, s[66:67]
    v_and_b32 v32, v42, v16
    v_and_b32 v33, v42, v17
    v_and_b32 v34, v42, v18
    v_and_b32 v35, v42, v19
    s_waitcnt vmcnt(9)
    s_nop 0
    v_mfma_f32_16x16x32_bf16 v[20:23], v[32:35], v[88:91], v[20:23]
    global_load_dwordx4 v[88:91], v[60:61], off nt
    v_lshl_add_u64 v[60:61], v[60:61], 0, s[66:67]
    v_and_b32 v36, v43, v16
    v_and_b32 v37, v43, v17
    v_and_b32 v38, v43, v18
    v_and_b32 v39, v43, v19
    s_waitcnt vmcnt(9)
    s_nop 0
    v_mfma_f32_16x16x32_bf16 v[20:23], v[36:39], v[92:95], v[20:23]
    global_load_dwordx4 v[92:95], v[60:61], off nt
    v_lshl_add_u64 v[60:61], v[60:61], 0, s[66:67]
    s_waitcnt lgkmcnt(0)
    ds_read_b128 v[40:43], v11 offset:16512
    v_and_b32 v32, v44, v16
    v_and_b32 v33, v44, v17
    v_and_b32 v34, v44, v18
    v_and_b32 v35, v44, v19
    s_waitcnt vmcnt(9)
    s_nop 0
    v_mfma_f32_16x16x32_bf16 v[20:23], v[32:35], v[96:99], v[20:23]
    global_load_dwordx4 v[96:99], v[60:61], off nt
    v_lshl_add_u64 v[60:61], v[60:61], 0, s[66:67]
    v_and_b32 v36, v45, v16
    v_and_b32 v37, v45, v17
    v_and_b32 v38, v45, v18
    v_and_b32 v39, v45, v19
    s_waitcnt vmcnt(9)
    s_nop 0
    v_mfma_f32_16x16x32_bf16 v[20:23], v[36:39], v[100:103], v[20:23]
    global_load_dwordx4 v[100:103], v[60:61], off nt
    v_lshl_add_u64 v[60:61], v[60:61], 0, s[66:67]
    v_and_b32 v32, v46, v16
    v_and_b32 v33, v46, v17
    v_and_b32 v34, v46, v18
    v_and_b32 v35, v46, v19
    s_waitcnt vmcnt(9)
    s_nop 0
    v_mfma_f32_16x16x32_bf16 v[20:23], v[32:35], v[64:67], v[20:23]
    global_load_dwordx4 v[64:67], v[60:61], off nt
    v_lshl_add_u64 v[60:61], v[60:61], 0, s[66:67]
    v_and_b32 v36, v47, v16
    v_and_b32 v37, v47, v17
    v_and_b32 v38, v47, v18
    v_and_b32 v39, v47, v19
    s_waitcnt vmcnt(9)
    s_nop 0
    v_mfma_f32_16x16x32_bf16 v[20:23], v[36:39], v[68:71], v[20:23]
    global_load_dwordx4 v[68:71], v[60:61], off nt
    v_lshl_add_u64 v[60:61], v[60:61], 0, s[66:67]
    s_waitcnt lgkmcnt(0)
    ds_read_b128 v[44:47], v11 offset:16528
    v_and_b32 v32, v40, v16
    v_and_b32 v33, v40, v17
    v_and_b32 v34, v40, v18
    v_and_b32 v35, v40, v19
    s_waitcnt vmcnt(9)
    s_nop 0
    v_mfma_f32_16x16x32_bf16 v[20:23], v[32:35], v[72:75], v[20:23]
    global_load_dwordx4 v[72:75], v[60:61], off nt
    v_lshl_add_u64 v[60:61], v[60:61], 0, s[66:67]
    v_and_b32 v36, v41, v16
    v_and_b32 v37, v41, v17
    v_and_b32 v38, v41, v18
    v_and_b32 v39, v41, v19
    s_waitcnt vmcnt(9)
    s_nop 0
    v_mfma_f32_16x16x32_bf16 v[20:23], v[36:39], v[76:79], v[20:23]
    global_load_dwordx4 v[76:79], v[60:61], off nt
    v_lshl_add_u64 v[60:61], v[60:61], 0, s[66:67]
    v_and_b32 v32, v42, v16
    v_and_b32 v33, v42, v17
    v_and_b32 v34, v42, v18
    v_and_b32 v35, v42, v19
    s_waitcnt vmcnt(9)
    s_nop 0
    v_mfma_f32_16x16x32_bf16 v[20:23], v[32:35], v[80:83], v[20:23]
    global_load_dwordx4 v[80:83], v[60:61], off nt
    v_lshl_add_u64 v[60:61], v[60:61], 0, s[66:67]
    v_and_b32 v36, v43, v16
    v_and_b32 v37, v43, v17
    v_and_b32 v38, v43, v18
    v_and_b32 v39, v43, v19
    s_waitcnt vmcnt(9)
    s_nop 0
    v_mfma_f32_16x16x32_bf16 v[20:23], v[36:39], v[84:87], v[20:23]
    global_load_dwordx4 v[84:87], v[60:61], off nt
    v_lshl_add_u64 v[60:61], v[60:61], 0, s[66:67]
    s_waitcnt lgkmcnt(0)
    ds_read_b128 v[40:43], v11 offset:16544
    v_and_b32 v32, v44, v16
    v_and_b32 v33, v44, v17
    v_and_b32 v34, v44, v18
    v_and_b32 v35, v44, v19
    s_waitcnt vmcnt(9)
    s_nop 0
    v_mfma_f32_16x16x32_bf16 v[20:23], v[32:35], v[88:91], v[20:23]
    global_load_dwordx4 v[88:91], v[60:61], off nt
    v_lshl_add_u64 v[60:61], v[60:61], 0, s[66:67]
    v_and_b32 v36, v45, v16
    v_and_b32 v37, v45, v17
    v_and_b32 v38, v45, v18
    v_and_b32 v39, v45, v19
    s_waitcnt vmcnt(9)
    s_nop 0
    v_mfma_f32_16x16x32_bf16 v[20:23], v[36:39], v[92:95], v[20:23]
    global_load_dwordx4 v[92:95], v[60:61], off nt
    v_lshl_add_u64 v[60:61], v[60:61], 0, s[66:67]
    v_and_b32 v32, v46, v16
    v_and_b32 v33, v46, v17
    v_and_b32 v34, v46, v18
    v_and_b32 v35, v46, v19
    s_waitcnt vmcnt(9)
    s_nop 0
    v_mfma_f32_16x16x32_bf16 v[20:23], v[32:35], v[96:99], v[20:23]
    global_load_dwordx4 v[96:99], v[60:61], off nt
    v_lshl_add_u64 v[60:61], v[60:61], 0, s[66:67]
    v_and_b32 v36, v47, v16
    v_and_b32 v37, v47, v17
    v_and_b32 v38, v47, v18
    v_and_b32 v39, v47, v19
    s_waitcnt vmcnt(9)
    s_nop 0
    v_mfma_f32_16x16x32_bf16 v[20:23], v[36:39], v[100:103], v[20:23]
    global_load_dwordx4 v[100:103], v[60:61], off nt
    v_lshl_add_u64 v[60:61], v[60:61], 0, s[66:67]
    s_waitcnt lgkmcnt(0)
    ds_read_b128 v[44:47], v11 offset:16560
    v_and_b32 v32, v40, v16
    v_and_b32 v33, v40, v17
    v_and_b32 v34, v40, v18
    v_and_b32 v35, v40, v19
    s_waitcnt vmcnt(9)
    s_nop 0
    v_mfma_f32_16x16x32_bf16 v[20:23], v[32:35], v[64:67], v[20:23]
    global_load_dwordx4 v[64:67], v[60:61], off nt
    v_lshl_add_u64 v[60:61], v[60:61], 0, s[66:67]
    v_and_b32 v36, v41, v16
    v_and_b32 v37, v41, v17
    v_and_b32 v38, v41, v18
    v_and_b32 v39, v41, v19
    s_waitcnt vmcnt(9)
    s_nop 0
    v_mfma_f32_16x16x32_bf16 v[20:23], v[36:39], v[68:71], v[20:23]
    global_load_dwordx4 v[68:71], v[60:61], off nt
    v_lshl_add_u64 v[60:61], v[60:61], 0, s[66:67]
    v_and_b32 v32, v42, v16
    v_and_b32 v33, v42, v17
    v_and_b32 v34, v42, v18
    v_and_b32 v35, v42, v19
    s_waitcnt vmcnt(9)
    s_nop 0
    v_mfma_f32_16x16x32_bf16 v[20:23], v[32:35], v[72:75], v[20:23]
    global_load_dwordx4 v[72:75], v[60:61], off nt
    v_lshl_add_u64 v[60:61], v[60:61], 0, s[66:67]
    v_and_b32 v36, v43, v16
    v_and_b32 v37, v43, v17
    v_and_b32 v38, v43, v18
    v_and_b32 v39, v43, v19
    s_waitcnt vmcnt(9)
    s_nop 0
    v_mfma_f32_16x16x32_bf16 v[20:23], v[36:39], v[76:79], v[20:23]
    global_load_dwordx4 v[76:79], v[60:61], off nt
    v_lshl_add_u64 v[60:61], v[60:61], 0, s[66:67]
    s_waitcnt lgkmcnt(0)
    ds_read_b128 v[40:43], v11 offset:16576
    v_and_b32 v32, v44, v16
    v_and_b32 v33, v44, v17
    v_and_b32 v34, v44, v18
    v_and_b32 v35, v44, v19
    s_waitcnt vmcnt(9)
    s_nop 0
    v_mfma_f32_16x16x32_bf16 v[20:23], v[32:35], v[80:83], v[20:23]
    global_load_dwordx4 v[80:83], v[60:61], off nt
    v_lshl_add_u64 v[60:61], v[60:61], 0, s[66:67]
    v_and_b32 v36, v45, v16
    v_and_b32 v37, v45, v17
    v_and_b32 v38, v45, v18
    v_and_b32 v39, v45, v19
    s_waitcnt vmcnt(9)
    s_nop 0
    v_mfma_f32_16x16x32_bf16 v[20:23], v[36:39], v[84:87], v[20:23]
    global_load_dwordx4 v[84:87], v[60:61], off nt
    v_lshl_add_u64 v[60:61], v[60:61], 0, s[66:67]
    v_and_b32 v32, v46, v16
    v_and_b32 v33, v46, v17
    v_and_b32 v34, v46, v18
    v_and_b32 v35, v46, v19
    s_waitcnt vmcnt(9)
    s_nop 0
    v_mfma_f32_16x16x32_bf16 v[20:23], v[32:35], v[88:91], v[20:23]
    global_load_dwordx4 v[88:91], v[60:61], off nt
    v_lshl_add_u64 v[60:61], v[60:61], 0, s[66:67]
    v_and_b32 v36, v47, v16
    v_and_b32 v37, v47, v17
    v_and_b32 v38, v47, v18
    v_and_b32 v39, v47, v19
    s_waitcnt vmcnt(9)
    s_nop 0
    v_mfma_f32_16x16x32_bf16 v[20:23], v[36:39], v[92:95], v[20:23]
    global_load_dwordx4 v[92:95], v[60:61], off nt
    v_lshl_add_u64 v[60:61], v[60:61], 0, s[66:67]
    s_waitcnt lgkmcnt(0)
    ds_read_b128 v[44:47], v11 offset:16592
    v_and_b32 v32, v40, v16
    v_and_b32 v33, v40, v17
    v_and_b32 v34, v40, v18
    v_and_b32 v35, v40, v19
    s_waitcnt vmcnt(9)
    s_nop 0
    v_mfma_f32_16x16x32_bf16 v[20:23], v[32:35], v[96:99], v[20:23]
    global_load_dwordx4 v[96:99], v[60:61], off nt
    v_lshl_add_u64 v[60:61], v[60:61], 0, s[66:67]
    v_and_b32 v36, v41, v16
    v_and_b32 v37, v41, v17
    v_and_b32 v38, v41, v18
    v_and_b32 v39, v41, v19
    s_waitcnt vmcnt(9)
    s_nop 0
    v_mfma_f32_16x16x32_bf16 v[20:23], v[36:39], v[100:103], v[20:23]
    global_load_dwordx4 v[100:103], v[60:61], off nt
    v_lshl_add_u64 v[60:61], v[60:61], 0, s[66:67]
    v_and_b32 v32, v42, v16
    v_and_b32 v33, v42, v17
    v_and_b32 v34, v42, v18
    v_and_b32 v35, v42, v19
    s_waitcnt vmcnt(9)
    s_nop 0
    v_mfma_f32_16x16x32_bf16 v[20:23], v[32:35], v[64:67], v[20:23]
    global_load_dwordx4 v[64:67], v[60:61], off nt
    v_lshl_add_u64 v[60:61], v[60:61], 0, s[66:67]
    v_and_b32 v36, v43, v16
    v_and_b32 v37, v43, v17
    v_and_b32 v38, v43, v18
    v_and_b32 v39, v43, v19
    s_waitcnt vmcnt(9)
    s_nop 0
    v_mfma_f32_16x16x32_bf16 v[20:23], v[36:39], v[68:71], v[20:23]
    global_load_dwordx4 v[68:71], v[60:61], off nt
    v_lshl_add_u64 v[60:61], v[60:61], 0, s[66:67]
    s_waitcnt lgkmcnt(0)
    ds_read_b128 v[40:43], v11 offset:16608
    v_and_b32 v32, v44, v16
    v_and_b32 v33, v44, v17
    v_and_b32 v34, v44, v18
    v_and_b32 v35, v44, v19
    s_waitcnt vmcnt(9)
    s_nop 0
    v_mfma_f32_16x16x32_bf16 v[20:23], v[32:35], v[72:75], v[20:23]
    global_load_dwordx4 v[72:75], v[60:61], off nt
    v_lshl_add_u64 v[60:61], v[60:61], 0, s[66:67]
    v_and_b32 v36, v45, v16
    v_and_b32 v37, v45, v17
    v_and_b32 v38, v45, v18
    v_and_b32 v39, v45, v19
    s_waitcnt vmcnt(9)
    s_nop 0
    v_mfma_f32_16x16x32_bf16 v[20:23], v[36:39], v[76:79], v[20:23]
    global_load_dwordx4 v[76:79], v[60:61], off nt
    v_lshl_add_u64 v[60:61], v[60:61], 0, s[66:67]
    v_and_b32 v32, v46, v16
    v_and_b32 v33, v46, v17
    v_and_b32 v34, v46, v18
    v_and_b32 v35, v46, v19
    s_waitcnt vmcnt(9)
    s_nop 0
    v_mfma_f32_16x16x32_bf16 v[20:23], v[32:35], v[80:83], v[20:23]
    global_load_dwordx4 v[80:83], v[60:61], off nt
    v_lshl_add_u64 v[60:61], v[60:61], 0, s[66:67]
    v_and_b32 v36, v47, v16
    v_and_b32 v37, v47, v17
    v_and_b32 v38, v47, v18
    v_and_b32 v39, v47, v19
    s_waitcnt vmcnt(9)
    s_nop 0
    v_mfma_f32_16x16x32_bf16 v[20:23], v[36:39], v[84:87], v[20:23]
    global_load_dwordx4 v[84:87], v[60:61], off nt
    v_lshl_add_u64 v[60:61], v[60:61], 0, s[66:67]
    s_waitcnt lgkmcnt(0)
    ds_read_b128 v[44:47], v11 offset:16624
    v_and_b32 v32, v40, v16
    v_and_b32 v33, v40, v17
    v_and_b32 v34, v40, v18
    v_and_b32 v35, v40, v19
    s_waitcnt vmcnt(9)
    s_nop 0
    v_mfma_f32_16x16x32_bf16 v[20:23], v[32:35], v[88:91], v[20:23]
    global_load_dwordx4 v[88:91], v[60:61], off nt
    v_lshl_add_u64 v[60:61], v[60:61], 0, s[66:67]
    v_and_b32 v36, v41, v16
    v_and_b32 v37, v41, v17
    v_and_b32 v38, v41, v18
    v_and_b32 v39, v41, v19
    s_waitcnt vmcnt(9)
    s_nop 0
    v_mfma_f32_16x16x32_bf16 v[20:23], v[36:39], v[92:95], v[20:23]
    global_load_dwordx4 v[92:95], v[60:61], off nt
    v_lshl_add_u64 v[60:61], v[60:61], 0, s[66:67]
    v_and_b32 v32, v42, v16
    v_and_b32 v33, v42, v17
    v_and_b32 v34, v42, v18
    v_and_b32 v35, v42, v19
    s_waitcnt vmcnt(9)
    s_nop 0
    v_mfma_f32_16x16x32_bf16 v[20:23], v[32:35], v[96:99], v[20:23]
    global_load_dwordx4 v[96:99], v[60:61], off nt
    v_lshl_add_u64 v[60:61], v[60:61], 0, s[66:67]
    v_and_b32 v36, v43, v16
    v_and_b32 v37, v43, v17
    v_and_b32 v38, v43, v18
    v_and_b32 v39, v43, v19
    s_waitcnt vmcnt(9)
    s_nop 0
    v_mfma_f32_16x16x32_bf16 v[20:23], v[36:39], v[100:103], v[20:23]
    global_load_dwordx4 v[100:103], v[60:61], off nt
    v_lshl_add_u64 v[60:61], v[60:61], 0, s[66:67]
    s_waitcnt lgkmcnt(0)
    ds_read_b128 v[40:43], v11 offset:16640
    v_and_b32 v32, v44, v16
    v_and_b32 v33, v44, v17
    v_and_b32 v34, v44, v18
    v_and_b32 v35, v44, v19
    s_waitcnt vmcnt(9)
    s_nop 0
    v_mfma_f32_16x16x32_bf16 v[20:23], v[32:35], v[64:67], v[20:23]
    global_load_dwordx4 v[64:67], v[60:61], off nt
    v_lshl_add_u64 v[60:61], v[60:61], 0, s[66:67]
    v_and_b32 v36, v45, v16
    v_and_b32 v37, v45, v17
    v_and_b32 v38, v45, v18
    v_and_b32 v39, v45, v19
    s_waitcnt vmcnt(9)
    s_nop 0
    v_mfma_f32_16x16x32_bf16 v[20:23], v[36:39], v[68:71], v[20:23]
    global_load_dwordx4 v[68:71], v[60:61], off nt
    v_lshl_add_u64 v[60:61], v[60:61], 0, s[66:67]
    v_and_b32 v32, v46, v16
    v_and_b32 v33, v46, v17
    v_and_b32 v34, v46, v18
    v_and_b32 v35, v46, v19
    s_waitcnt vmcnt(9)
    s_nop 0
    v_mfma_f32_16x16x32_bf16 v[20:23], v[32:35], v[72:75], v[20:23]
    global_load_dwordx4 v[72:75], v[60:61], off nt
    v_lshl_add_u64 v[60:61], v[60:61], 0, s[66:67]
    v_and_b32 v36, v47, v16
    v_and_b32 v37, v47, v17
    v_and_b32 v38, v47, v18
    v_and_b32 v39, v47, v19
    s_waitcnt vmcnt(9)
    s_nop 0
    v_mfma_f32_16x16x32_bf16 v[20:23], v[36:39], v[76:79], v[20:23]
    global_load_dwordx4 v[76:79], v[60:61], off nt
    v_lshl_add_u64 v[60:61], v[60:61], 0, s[66:67]
    s_waitcnt lgkmcnt(0)
    ds_read_b128 v[44:47], v11 offset:16656
    v_and_b32 v32, v40, v16
    v_and_b32 v33, v40, v17
    v_and_b32 v34, v40, v18
    v_and_b32 v35, v40, v19
    s_waitcnt vmcnt(9)
    s_nop 0
    v_mfma_f32_16x16x32_bf16 v[20:23], v[32:35], v[80:83], v[20:23]
    global_load_dwordx4 v[80:83], v[60:61], off nt
    v_lshl_add_u64 v[60:61], v[60:61], 0, s[66:67]
    v_and_b32 v36, v41, v16
    v_and_b32 v37, v41, v17
    v_and_b32 v38, v41, v18
    v_and_b32 v39, v41, v19
    s_waitcnt vmcnt(9)
    s_nop 0
    v_mfma_f32_16x16x32_bf16 v[20:23], v[36:39], v[84:87], v[20:23]
    global_load_dwordx4 v[84:87], v[60:61], off nt
    v_lshl_add_u64 v[60:61], v[60:61], 0, s[66:67]
    v_and_b32 v32, v42, v16
    v_and_b32 v33, v42, v17
    v_and_b32 v34, v42, v18
    v_and_b32 v35, v42, v19
    s_waitcnt vmcnt(9)
    s_nop 0
    v_mfma_f32_16x16x32_bf16 v[20:23], v[32:35], v[88:91], v[20:23]
    global_load_dwordx4 v[88:91], v[60:61], off nt
    v_lshl_add_u64 v[60:61], v[60:61], 0, s[66:67]
    v_and_b32 v36, v43, v16
    v_and_b32 v37, v43, v17
    v_and_b32 v38, v43, v18
    v_and_b32 v39, v43, v19
    s_waitcnt vmcnt(9)
    s_nop 0
    v_mfma_f32_16x16x32_bf16 v[20:23], v[36:39], v[92:95], v[20:23]
    global_load_dwordx4 v[92:95], v[60:61], off nt
    v_lshl_add_u64 v[60:61], v[60:61], 0, s[66:67]
    s_waitcnt lgkmcnt(0)
    ds_read_b128 v[40:43], v11 offset:16672
    v_and_b32 v32, v44, v16
    v_and_b32 v33, v44, v17
    v_and_b32 v34, v44, v18
    v_and_b32 v35, v44, v19
    s_waitcnt vmcnt(9)
    s_nop 0
    v_mfma_f32_16x16x32_bf16 v[20:23], v[32:35], v[96:99], v[20:23]
    global_load_dwordx4 v[96:99], v[60:61], off nt
    v_lshl_add_u64 v[60:61], v[60:61], 0, s[66:67]
    v_and_b32 v36, v45, v16
    v_and_b32 v37, v45, v17
    v_and_b32 v38, v45, v18
    v_and_b32 v39, v45, v19
    s_waitcnt vmcnt(9)
    s_nop 0
    v_mfma_f32_16x16x32_bf16 v[20:23], v[36:39], v[100:103], v[20:23]
    global_load_dwordx4 v[100:103], v[60:61], off nt
    v_lshl_add_u64 v[60:61], v[60:61], 0, s[66:67]
    v_and_b32 v32, v46, v16
    v_and_b32 v33, v46, v17
    v_and_b32 v34, v46, v18
    v_and_b32 v35, v46, v19
    s_waitcnt vmcnt(9)
    s_nop 0
    v_mfma_f32_16x16x32_bf16 v[20:23], v[32:35], v[64:67], v[20:23]
    global_load_dwordx4 v[64:67], v[60:61], off nt
    v_lshl_add_u64 v[60:61], v[60:61], 0, s[66:67]
    v_and_b32 v36, v47, v16
    v_and_b32 v37, v47, v17
    v_and_b32 v38, v47, v18
    v_and_b32 v39, v47, v19
    s_waitcnt vmcnt(9)
    s_nop 0
    v_mfma_f32_16x16x32_bf16 v[20:23], v[36:39], v[68:71], v[20:23]
    global_load_dwordx4 v[68:71], v[60:61], off nt
    v_lshl_add_u64 v[60:61], v[60:61], 0, s[66:67]
    s_waitcnt lgkmcnt(0)
    ds_read_b128 v[44:47], v11 offset:16688
    v_and_b32 v32, v40, v16
    v_and_b32 v33, v40, v17
    v_and_b32 v34, v40, v18
    v_and_b32 v35, v40, v19
    s_waitcnt vmcnt(9)
    s_nop 0
    v_mfma_f32_16x16x32_bf16 v[20:23], v[32:35], v[72:75], v[20:23]
    global_load_dwordx4 v[72:75], v[60:61], off nt
    v_lshl_add_u64 v[60:61], v[60:61], 0, s[66:67]
    v_and_b32 v36, v41, v16
    v_and_b32 v37, v41, v17
    v_and_b32 v38, v41, v18
    v_and_b32 v39, v41, v19
    s_waitcnt vmcnt(9)
    s_nop 0
    v_mfma_f32_16x16x32_bf16 v[20:23], v[36:39], v[76:79], v[20:23]
    global_load_dwordx4 v[76:79], v[60:61], off nt
    v_lshl_add_u64 v[60:61], v[60:61], 0, s[66:67]
    v_and_b32 v32, v42, v16
    v_and_b32 v33, v42, v17
    v_and_b32 v34, v42, v18
    v_and_b32 v35, v42, v19
    s_waitcnt vmcnt(9)
    s_nop 0
    v_mfma_f32_16x16x32_bf16 v[20:23], v[32:35], v[80:83], v[20:23]
    global_load_dwordx4 v[80:83], v[60:61], off nt
    v_lshl_add_u64 v[60:61], v[60:61], 0, s[66:67]
    v_and_b32 v36, v43, v16
    v_and_b32 v37, v43, v17
    v_and_b32 v38, v43, v18
    v_and_b32 v39, v43, v19
    s_waitcnt vmcnt(9)
    s_nop 0
    v_mfma_f32_16x16x32_bf16 v[20:23], v[36:39], v[84:87], v[20:23]
    global_load_dwordx4 v[84:87], v[60:61], off nt
    v_lshl_add_u64 v[60:61], v[60:61], 0, s[66:67]
    s_waitcnt lgkmcnt(0)
    ds_read_b128 v[40:43], v11 offset:16704
    v_and_b32 v32, v44, v16
    v_and_b32 v33, v44, v17
    v_and_b32 v34, v44, v18
    v_and_b32 v35, v44, v19
    s_waitcnt vmcnt(9)
    s_nop 0
    v_mfma_f32_16x16x32_bf16 v[20:23], v[32:35], v[88:91], v[20:23]
    global_load_dwordx4 v[88:91], v[60:61], off nt
    v_lshl_add_u64 v[60:61], v[60:61], 0, s[66:67]
    v_and_b32 v36, v45, v16
    v_and_b32 v37, v45, v17
    v_and_b32 v38, v45, v18
    v_and_b32 v39, v45, v19
    s_waitcnt vmcnt(9)
    s_nop 0
    v_mfma_f32_16x16x32_bf16 v[20:23], v[36:39], v[92:95], v[20:23]
    global_load_dwordx4 v[92:95], v[60:61], off nt
    v_lshl_add_u64 v[60:61], v[60:61], 0, s[66:67]
    v_and_b32 v32, v46, v16
    v_and_b32 v33, v46, v17
    v_and_b32 v34, v46, v18
    v_and_b32 v35, v46, v19
    s_waitcnt vmcnt(9)
    s_nop 0
    v_mfma_f32_16x16x32_bf16 v[20:23], v[32:35], v[96:99], v[20:23]
    global_load_dwordx4 v[96:99], v[60:61], off nt
    v_lshl_add_u64 v[60:61], v[60:61], 0, s[66:67]
    v_and_b32 v36, v47, v16
    v_and_b32 v37, v47, v17
    v_and_b32 v38, v47, v18
    v_and_b32 v39, v47, v19
    s_waitcnt vmcnt(9)
    s_nop 0
    v_mfma_f32_16x16x32_bf16 v[20:23], v[36:39], v[100:103], v[20:23]
    global_load_dwordx4 v[100:103], v[60:61], off nt
    v_lshl_add_u64 v[60:61], v[60:61], 0, s[66:67]
    s_waitcnt lgkmcnt(0)
    ds_read_b128 v[44:47], v11 offset:16720
    v_and_b32 v32, v40, v16
    v_and_b32 v33, v40, v17
    v_and_b32 v34, v40, v18
    v_and_b32 v35, v40, v19
    s_waitcnt vmcnt(9)
    s_nop 0
    v_mfma_f32_16x16x32_bf16 v[20:23], v[32:35], v[64:67], v[20:23]
    global_load_dwordx4 v[64:67], v[60:61], off nt
    v_lshl_add_u64 v[60:61], v[60:61], 0, s[66:67]
    v_and_b32 v36, v41, v16
    v_and_b32 v37, v41, v17
    v_and_b32 v38, v41, v18
    v_and_b32 v39, v41, v19
    s_waitcnt vmcnt(9)
    s_nop 0
    v_mfma_f32_16x16x32_bf16 v[20:23], v[36:39], v[68:71], v[20:23]
    global_load_dwordx4 v[68:71], v[60:61], off nt
    v_lshl_add_u64 v[60:61], v[60:61], 0, s[66:67]
    v_and_b32 v32, v42, v16
    v_and_b32 v33, v42, v17
    v_and_b32 v34, v42, v18
    v_and_b32 v35, v42, v19
    s_waitcnt vmcnt(9)
    s_nop 0
    v_mfma_f32_16x16x32_bf16 v[20:23], v[32:35], v[72:75], v[20:23]
    global_load_dwordx4 v[72:75], v[60:61], off nt
    v_lshl_add_u64 v[60:61], v[60:61], 0, s[66:67]
    v_and_b32 v36, v43, v16
    v_and_b32 v37, v43, v17
    v_and_b32 v38, v43, v18
    v_and_b32 v39, v43, v19
    s_waitcnt vmcnt(9)
    s_nop 0
    v_mfma_f32_16x16x32_bf16 v[20:23], v[36:39], v[76:79], v[20:23]
    global_load_dwordx4 v[76:79], v[60:61], off nt
    v_lshl_add_u64 v[60:61], v[60:61], 0, s[66:67]
    s_waitcnt lgkmcnt(0)
    ds_read_b128 v[40:43], v11 offset:16736
    v_and_b32 v32, v44, v16
    v_and_b32 v33, v44, v17
    v_and_b32 v34, v44, v18
    v_and_b32 v35, v44, v19
    s_waitcnt vmcnt(9)
    s_nop 0
    v_mfma_f32_16x16x32_bf16 v[20:23], v[32:35], v[80:83], v[20:23]
    global_load_dwordx4 v[80:83], v[60:61], off nt
    v_lshl_add_u64 v[60:61], v[60:61], 0, s[66:67]
    v_and_b32 v36, v45, v16
    v_and_b32 v37, v45, v17
    v_and_b32 v38, v45, v18
    v_and_b32 v39, v45, v19
    s_waitcnt vmcnt(9)
    s_nop 0
    v_mfma_f32_16x16x32_bf16 v[20:23], v[36:39], v[84:87], v[20:23]
    global_load_dwordx4 v[84:87], v[60:61], off nt
    v_lshl_add_u64 v[60:61], v[60:61], 0, s[66:67]
    v_and_b32 v32, v46, v16
    v_and_b32 v33, v46, v17
    v_and_b32 v34, v46, v18
    v_and_b32 v35, v46, v19
    s_waitcnt vmcnt(9)
    s_nop 0
    v_mfma_f32_16x16x32_bf16 v[20:23], v[32:35], v[88:91], v[20:23]
    global_load_dwordx4 v[88:91], v[60:61], off nt
    v_lshl_add_u64 v[60:61], v[60:61], 0, s[66:67]
    v_and_b32 v36, v47, v16
    v_and_b32 v37, v47, v17
    v_and_b32 v38, v47, v18
    v_and_b32 v39, v47, v19
    s_waitcnt vmcnt(9)
    s_nop 0
    v_mfma_f32_16x16x32_bf16 v[20:23], v[36:39], v[92:95], v[20:23]
    global_load_dwordx4 v[92:95], v[60:61], off nt
    v_lshl_add_u64 v[60:61], v[60:61], 0, s[66:67]
    s_waitcnt lgkmcnt(0)
    ds_read_b128 v[44:47], v11 offset:16752
    v_and_b32 v32, v40, v16
    v_and_b32 v33, v40, v17
    v_and_b32 v34, v40, v18
    v_and_b32 v35, v40, v19
    s_waitcnt vmcnt(9)
    s_nop 0
    v_mfma_f32_16x16x32_bf16 v[20:23], v[32:35], v[96:99], v[20:23]
    global_load_dwordx4 v[96:99], v[60:61], off nt
    v_lshl_add_u64 v[60:61], v[60:61], 0, s[66:67]
    v_and_b32 v36, v41, v16
    v_and_b32 v37, v41, v17
    v_and_b32 v38, v41, v18
    v_and_b32 v39, v41, v19
    s_waitcnt vmcnt(9)
    s_nop 0
    v_mfma_f32_16x16x32_bf16 v[20:23], v[36:39], v[100:103], v[20:23]
    global_load_dwordx4 v[100:103], v[60:61], off nt
    v_lshl_add_u64 v[60:61], v[60:61], 0, s[66:67]
    v_and_b32 v32, v42, v16
    v_and_b32 v33, v42, v17
    v_and_b32 v34, v42, v18
    v_and_b32 v35, v42, v19
    s_waitcnt vmcnt(9)
    s_nop 0
    v_mfma_f32_16x16x32_bf16 v[20:23], v[32:35], v[64:67], v[20:23]
    global_load_dwordx4 v[64:67], v[60:61], off nt
    v_lshl_add_u64 v[60:61], v[60:61], 0, s[66:67]
    v_and_b32 v36, v43, v16
    v_and_b32 v37, v43, v17
    v_and_b32 v38, v43, v18
    v_and_b32 v39, v43, v19
    s_waitcnt vmcnt(9)
    s_nop 0
    v_mfma_f32_16x16x32_bf16 v[20:23], v[36:39], v[68:71], v[20:23]
    global_load_dwordx4 v[68:71], v[60:61], off nt
    v_lshl_add_u64 v[60:61], v[60:61], 0, s[66:67]
    s_waitcnt lgkmcnt(0)
    ds_read_b128 v[40:43], v11 offset:16768
    v_and_b32 v32, v44, v16
    v_and_b32 v33, v44, v17
    v_and_b32 v34, v44, v18
    v_and_b32 v35, v44, v19
    s_waitcnt vmcnt(9)
    s_nop 0
    v_mfma_f32_16x16x32_bf16 v[20:23], v[32:35], v[72:75], v[20:23]
    global_load_dwordx4 v[72:75], v[60:61], off nt
    v_lshl_add_u64 v[60:61], v[60:61], 0, s[66:67]
    v_and_b32 v36, v45, v16
    v_and_b32 v37, v45, v17
    v_and_b32 v38, v45, v18
    v_and_b32 v39, v45, v19
    s_waitcnt vmcnt(9)
    s_nop 0
    v_mfma_f32_16x16x32_bf16 v[20:23], v[36:39], v[76:79], v[20:23]
    global_load_dwordx4 v[76:79], v[60:61], off nt
    v_lshl_add_u64 v[60:61], v[60:61], 0, s[66:67]
    v_and_b32 v32, v46, v16
    v_and_b32 v33, v46, v17
    v_and_b32 v34, v46, v18
    v_and_b32 v35, v46, v19
    s_waitcnt vmcnt(9)
    s_nop 0
    v_mfma_f32_16x16x32_bf16 v[20:23], v[32:35], v[80:83], v[20:23]
    global_load_dwordx4 v[80:83], v[60:61], off nt
    v_lshl_add_u64 v[60:61], v[60:61], 0, s[66:67]
    v_and_b32 v36, v47, v16
    v_and_b32 v37, v47, v17
    v_and_b32 v38, v47, v18
    v_and_b32 v39, v47, v19
    s_waitcnt vmcnt(9)
    s_nop 0
    v_mfma_f32_16x16x32_bf16 v[20:23], v[36:39], v[84:87], v[20:23]
    global_load_dwordx4 v[84:87], v[60:61], off nt
    v_lshl_add_u64 v[60:61], v[60:61], 0, s[66:67]
    s_waitcnt lgkmcnt(0)
    ds_read_b128 v[44:47], v11 offset:16784
    v_and_b32 v32, v40, v16
    v_and_b32 v33, v40, v17
    v_and_b32 v34, v40, v18
    v_and_b32 v35, v40, v19
    s_waitcnt vmcnt(9)
    s_nop 0
    v_mfma_f32_16x16x32_bf16 v[20:23], v[32:35], v[88:91], v[20:23]
    global_load_dwordx4 v[88:91], v[60:61], off nt
    v_lshl_add_u64 v[60:61], v[60:61], 0, s[66:67]
    v_and_b32 v36, v41, v16
    v_and_b32 v37, v41, v17
    v_and_b32 v38, v41, v18
    v_and_b32 v39, v41, v19
    s_waitcnt vmcnt(9)
    s_nop 0
    v_mfma_f32_16x16x32_bf16 v[20:23], v[36:39], v[92:95], v[20:23]
    global_load_dwordx4 v[92:95], v[60:61], off nt
    v_lshl_add_u64 v[60:61], v[60:61], 0, s[66:67]
    v_and_b32 v32, v42, v16
    v_and_b32 v33, v42, v17
    v_and_b32 v34, v42, v18
    v_and_b32 v35, v42, v19
    s_waitcnt vmcnt(9)
    s_nop 0
    v_mfma_f32_16x16x32_bf16 v[20:23], v[32:35], v[96:99], v[20:23]
    global_load_dwordx4 v[96:99], v[60:61], off nt
    v_lshl_add_u64 v[60:61], v[60:61], 0, s[66:67]
    v_and_b32 v36, v43, v16
    v_and_b32 v37, v43, v17
    v_and_b32 v38, v43, v18
    v_and_b32 v39, v43, v19
    s_waitcnt vmcnt(9)
    s_nop 0
    v_mfma_f32_16x16x32_bf16 v[20:23], v[36:39], v[100:103], v[20:23]
    global_load_dwordx4 v[100:103], v[60:61], off nt
    v_lshl_add_u64 v[60:61], v[60:61], 0, s[66:67]
    s_waitcnt lgkmcnt(0)
    ds_read_b128 v[40:43], v11 offset:16800
    v_and_b32 v32, v44, v16
    v_and_b32 v33, v44, v17
    v_and_b32 v34, v44, v18
    v_and_b32 v35, v44, v19
    s_waitcnt vmcnt(9)
    s_nop 0
    v_mfma_f32_16x16x32_bf16 v[20:23], v[32:35], v[64:67], v[20:23]
    global_load_dwordx4 v[64:67], v[60:61], off nt
    v_lshl_add_u64 v[60:61], v[60:61], 0, s[66:67]
    v_and_b32 v36, v45, v16
    v_and_b32 v37, v45, v17
    v_and_b32 v38, v45, v18
    v_and_b32 v39, v45, v19
    s_waitcnt vmcnt(9)
    s_nop 0
    v_mfma_f32_16x16x32_bf16 v[20:23], v[36:39], v[68:71], v[20:23]
    global_load_dwordx4 v[68:71], v[60:61], off nt
    v_lshl_add_u64 v[60:61], v[60:61], 0, s[66:67]
    v_and_b32 v32, v46, v16
    v_and_b32 v33, v46, v17
    v_and_b32 v34, v46, v18
    v_and_b32 v35, v46, v19
    s_waitcnt vmcnt(9)
    s_nop 0
    v_mfma_f32_16x16x32_bf16 v[20:23], v[32:35], v[72:75], v[20:23]
    global_load_dwordx4 v[72:75], v[60:61], off nt
    v_lshl_add_u64 v[60:61], v[60:61], 0, s[66:67]
    v_and_b32 v36, v47, v16
    v_and_b32 v37, v47, v17
    v_and_b32 v38, v47, v18
    v_and_b32 v39, v47, v19
    s_waitcnt vmcnt(9)
    s_nop 0
    v_mfma_f32_16x16x32_bf16 v[20:23], v[36:39], v[76:79], v[20:23]
    global_load_dwordx4 v[76:79], v[60:61], off nt
    v_lshl_add_u64 v[60:61], v[60:61], 0, s[66:67]
    s_waitcnt lgkmcnt(0)
    ds_read_b128 v[44:47], v11 offset:16816
    v_and_b32 v32, v40, v16
    v_and_b32 v33, v40, v17
    v_and_b32 v34, v40, v18
    v_and_b32 v35, v40, v19
    s_waitcnt vmcnt(9)
    s_nop 0
    v_mfma_f32_16x16x32_bf16 v[20:23], v[32:35], v[80:83], v[20:23]
    global_load_dwordx4 v[80:83], v[60:61], off nt
    v_lshl_add_u64 v[60:61], v[60:61], 0, s[66:67]
    v_and_b32 v36, v41, v16
    v_and_b32 v37, v41, v17
    v_and_b32 v38, v41, v18
    v_and_b32 v39, v41, v19
    s_waitcnt vmcnt(9)
    s_nop 0
    v_mfma_f32_16x16x32_bf16 v[20:23], v[36:39], v[84:87], v[20:23]
    global_load_dwordx4 v[84:87], v[60:61], off nt
    v_lshl_add_u64 v[60:61], v[60:61], 0, s[66:67]
    v_and_b32 v32, v42, v16
    v_and_b32 v33, v42, v17
    v_and_b32 v34, v42, v18
    v_and_b32 v35, v42, v19
    s_waitcnt vmcnt(9)
    s_nop 0
    v_mfma_f32_16x16x32_bf16 v[20:23], v[32:35], v[88:91], v[20:23]
    global_load_dwordx4 v[88:91], v[60:61], off nt
    v_lshl_add_u64 v[60:61], v[60:61], 0, s[66:67]
    v_and_b32 v36, v43, v16
    v_and_b32 v37, v43, v17
    v_and_b32 v38, v43, v18
    v_and_b32 v39, v43, v19
    s_waitcnt vmcnt(9)
    s_nop 0
    v_mfma_f32_16x16x32_bf16 v[20:23], v[36:39], v[92:95], v[20:23]
    global_load_dwordx4 v[92:95], v[60:61], off nt
    v_lshl_add_u64 v[60:61], v[60:61], 0, s[66:67]
    s_waitcnt lgkmcnt(0)
    ds_read_b128 v[40:43], v11 offset:16832
    v_and_b32 v32, v44, v16
    v_and_b32 v33, v44, v17
    v_and_b32 v34, v44, v18
    v_and_b32 v35, v44, v19
    s_waitcnt vmcnt(9)
    s_nop 0
    v_mfma_f32_16x16x32_bf16 v[20:23], v[32:35], v[96:99], v[20:23]
    global_load_dwordx4 v[96:99], v[60:61], off nt
    v_lshl_add_u64 v[60:61], v[60:61], 0, s[66:67]
    v_and_b32 v36, v45, v16
    v_and_b32 v37, v45, v17
    v_and_b32 v38, v45, v18
    v_and_b32 v39, v45, v19
    s_waitcnt vmcnt(9)
    s_nop 0
    v_mfma_f32_16x16x32_bf16 v[20:23], v[36:39], v[100:103], v[20:23]
    global_load_dwordx4 v[100:103], v[60:61], off nt
    v_lshl_add_u64 v[60:61], v[60:61], 0, s[66:67]
    v_and_b32 v32, v46, v16
    v_and_b32 v33, v46, v17
    v_and_b32 v34, v46, v18
    v_and_b32 v35, v46, v19
    s_waitcnt vmcnt(9)
    s_nop 0
    v_mfma_f32_16x16x32_bf16 v[20:23], v[32:35], v[64:67], v[20:23]
    global_load_dwordx4 v[64:67], v[60:61], off nt
    v_lshl_add_u64 v[60:61], v[60:61], 0, s[66:67]
    v_and_b32 v36, v47, v16
    v_and_b32 v37, v47, v17
    v_and_b32 v38, v47, v18
    v_and_b32 v39, v47, v19
    s_waitcnt vmcnt(9)
    s_nop 0
    v_mfma_f32_16x16x32_bf16 v[20:23], v[36:39], v[68:71], v[20:23]
    global_load_dwordx4 v[68:71], v[60:61], off nt
    v_lshl_add_u64 v[60:61], v[60:61], 0, s[66:67]
    s_waitcnt lgkmcnt(0)
    ds_read_b128 v[44:47], v11 offset:16848
    v_and_b32 v32, v40, v16
    v_and_b32 v33, v40, v17
    v_and_b32 v34, v40, v18
    v_and_b32 v35, v40, v19
    s_waitcnt vmcnt(9)
    s_nop 0
    v_mfma_f32_16x16x32_bf16 v[20:23], v[32:35], v[72:75], v[20:23]
    global_load_dwordx4 v[72:75], v[60:61], off nt
    v_lshl_add_u64 v[60:61], v[60:61], 0, s[66:67]
    v_and_b32 v36, v41, v16
    v_and_b32 v37, v41, v17
    v_and_b32 v38, v41, v18
    v_and_b32 v39, v41, v19
    s_waitcnt vmcnt(9)
    s_nop 0
    v_mfma_f32_16x16x32_bf16 v[20:23], v[36:39], v[76:79], v[20:23]
    global_load_dwordx4 v[76:79], v[60:61], off nt
    v_lshl_add_u64 v[60:61], v[60:61], 0, s[66:67]
    v_and_b32 v32, v42, v16
    v_and_b32 v33, v42, v17
    v_and_b32 v34, v42, v18
    v_and_b32 v35, v42, v19
    s_waitcnt vmcnt(9)
    s_nop 0
    v_mfma_f32_16x16x32_bf16 v[20:23], v[32:35], v[80:83], v[20:23]
    global_load_dwordx4 v[80:83], v[60:61], off nt
    v_lshl_add_u64 v[60:61], v[60:61], 0, s[66:67]
    v_and_b32 v36, v43, v16
    v_and_b32 v37, v43, v17
    v_and_b32 v38, v43, v18
    v_and_b32 v39, v43, v19
    s_waitcnt vmcnt(9)
    s_nop 0
    v_mfma_f32_16x16x32_bf16 v[20:23], v[36:39], v[84:87], v[20:23]
    global_load_dwordx4 v[84:87], v[60:61], off nt
    v_lshl_add_u64 v[60:61], v[60:61], 0, s[66:67]
    s_waitcnt lgkmcnt(0)
    ds_read_b128 v[40:43], v11 offset:16864
    v_and_b32 v32, v44, v16
    v_and_b32 v33, v44, v17
    v_and_b32 v34, v44, v18
    v_and_b32 v35, v44, v19
    s_waitcnt vmcnt(9)
    s_nop 0
    v_mfma_f32_16x16x32_bf16 v[20:23], v[32:35], v[88:91], v[20:23]
    global_load_dwordx4 v[88:91], v[60:61], off nt
    v_lshl_add_u64 v[60:61], v[60:61], 0, s[66:67]
    v_and_b32 v36, v45, v16
    v_and_b32 v37, v45, v17
    v_and_b32 v38, v45, v18
    v_and_b32 v39, v45, v19
    s_waitcnt vmcnt(9)
    s_nop 0
    v_mfma_f32_16x16x32_bf16 v[20:23], v[36:39], v[92:95], v[20:23]
    global_load_dwordx4 v[92:95], v[60:61], off nt
    v_lshl_add_u64 v[60:61], v[60:61], 0, s[66:67]
    v_and_b32 v32, v46, v16
    v_and_b32 v33, v46, v17
    v_and_b32 v34, v46, v18
    v_and_b32 v35, v46, v19
    s_waitcnt vmcnt(9)
    s_nop 0
    v_mfma_f32_16x16x32_bf16 v[20:23], v[32:35], v[96:99], v[20:23]
    global_load_dwordx4 v[96:99], v[60:61], off nt
    v_lshl_add_u64 v[60:61], v[60:61], 0, s[66:67]
    v_and_b32 v36, v47, v16
    v_and_b32 v37, v47, v17
    v_and_b32 v38, v47, v18
    v_and_b32 v39, v47, v19
    s_waitcnt vmcnt(9)
    s_nop 0
    v_mfma_f32_16x16x32_bf16 v[20:23], v[36:39], v[100:103], v[20:23]
    global_load_dwordx4 v[100:103], v[60:61], off nt
    v_lshl_add_u64 v[60:61], v[60:61], 0, s[66:67]
    s_waitcnt lgkmcnt(0)
    ds_read_b128 v[44:47], v11 offset:16880
    v_and_b32 v32, v40, v16
    v_and_b32 v33, v40, v17
    v_and_b32 v34, v40, v18
    v_and_b32 v35, v40, v19
    s_waitcnt vmcnt(9)
    s_nop 0
    v_mfma_f32_16x16x32_bf16 v[20:23], v[32:35], v[64:67], v[20:23]
    global_load_dwordx4 v[64:67], v[60:61], off nt
    v_lshl_add_u64 v[60:61], v[60:61], 0, s[66:67]
    v_and_b32 v36, v41, v16
    v_and_b32 v37, v41, v17
    v_and_b32 v38, v41, v18
    v_and_b32 v39, v41, v19
    s_waitcnt vmcnt(9)
    s_nop 0
    v_mfma_f32_16x16x32_bf16 v[20:23], v[36:39], v[68:71], v[20:23]
    global_load_dwordx4 v[68:71], v[60:61], off nt
    v_lshl_add_u64 v[60:61], v[60:61], 0, s[66:67]
    v_and_b32 v32, v42, v16
    v_and_b32 v33, v42, v17
    v_and_b32 v34, v42, v18
    v_and_b32 v35, v42, v19
    s_waitcnt vmcnt(9)
    s_nop 0
    v_mfma_f32_16x16x32_bf16 v[20:23], v[32:35], v[72:75], v[20:23]
    global_load_dwordx4 v[72:75], v[60:61], off nt
    v_lshl_add_u64 v[60:61], v[60:61], 0, s[66:67]
    v_and_b32 v36, v43, v16
    v_and_b32 v37, v43, v17
    v_and_b32 v38, v43, v18
    v_and_b32 v39, v43, v19
    s_waitcnt vmcnt(9)
    s_nop 0
    v_mfma_f32_16x16x32_bf16 v[20:23], v[36:39], v[76:79], v[20:23]
    global_load_dwordx4 v[76:79], v[60:61], off nt
    v_lshl_add_u64 v[60:61], v[60:61], 0, s[66:67]
    s_waitcnt lgkmcnt(0)
    ds_read_b128 v[40:43], v11 offset:16896
    v_and_b32 v32, v44, v16
    v_and_b32 v33, v44, v17
    v_and_b32 v34, v44, v18
    v_and_b32 v35, v44, v19
    s_waitcnt vmcnt(9)
    s_nop 0
    v_mfma_f32_16x16x32_bf16 v[20:23], v[32:35], v[80:83], v[20:23]
    global_load_dwordx4 v[80:83], v[60:61], off nt
    v_lshl_add_u64 v[60:61], v[60:61], 0, s[66:67]
    v_and_b32 v36, v45, v16
    v_and_b32 v37, v45, v17
    v_and_b32 v38, v45, v18
    v_and_b32 v39, v45, v19
    s_waitcnt vmcnt(9)
    s_nop 0
    v_mfma_f32_16x16x32_bf16 v[20:23], v[36:39], v[84:87], v[20:23]
    global_load_dwordx4 v[84:87], v[60:61], off nt
    v_lshl_add_u64 v[60:61], v[60:61], 0, s[66:67]
    v_and_b32 v32, v46, v16
    v_and_b32 v33, v46, v17
    v_and_b32 v34, v46, v18
    v_and_b32 v35, v46, v19
    s_waitcnt vmcnt(9)
    s_nop 0
    v_mfma_f32_16x16x32_bf16 v[20:23], v[32:35], v[88:91], v[20:23]
    global_load_dwordx4 v[88:91], v[60:61], off nt
    v_lshl_add_u64 v[60:61], v[60:61], 0, s[66:67]
    v_and_b32 v36, v47, v16
    v_and_b32 v37, v47, v17
    v_and_b32 v38, v47, v18
    v_and_b32 v39, v47, v19
    s_waitcnt vmcnt(9)
    s_nop 0
    v_mfma_f32_16x16x32_bf16 v[20:23], v[36:39], v[92:95], v[20:23]
    global_load_dwordx4 v[92:95], v[60:61], off nt
    v_lshl_add_u64 v[60:61], v[60:61], 0, s[66:67]
    s_waitcnt lgkmcnt(0)
    ds_read_b128 v[44:47], v11 offset:16912
    v_and_b32 v32, v40, v16
    v_and_b32 v33, v40, v17
    v_and_b32 v34, v40, v18
    v_and_b32 v35, v40, v19
    s_waitcnt vmcnt(9)
    s_nop 0
    v_mfma_f32_16x16x32_bf16 v[20:23], v[32:35], v[96:99], v[20:23]
    global_load_dwordx4 v[96:99], v[60:61], off nt
    v_lshl_add_u64 v[60:61], v[60:61], 0, s[66:67]
    v_and_b32 v36, v41, v16
    v_and_b32 v37, v41, v17
    v_and_b32 v38, v41, v18
    v_and_b32 v39, v41, v19
    s_waitcnt vmcnt(9)
    s_nop 0
    v_mfma_f32_16x16x32_bf16 v[20:23], v[36:39], v[100:103], v[20:23]
    global_load_dwordx4 v[100:103], v[60:61], off nt
    v_lshl_add_u64 v[60:61], v[60:61], 0, s[66:67]
    v_and_b32 v32, v42, v16
    v_and_b32 v33, v42, v17
    v_and_b32 v34, v42, v18
    v_and_b32 v35, v42, v19
    s_waitcnt vmcnt(9)
    s_nop 0
    v_mfma_f32_16x16x32_bf16 v[20:23], v[32:35], v[64:67], v[20:23]
    global_load_dwordx4 v[64:67], v[60:61], off nt
    v_lshl_add_u64 v[60:61], v[60:61], 0, s[66:67]
    v_and_b32 v36, v43, v16
    v_and_b32 v37, v43, v17
    v_and_b32 v38, v43, v18
    v_and_b32 v39, v43, v19
    s_waitcnt vmcnt(9)
    s_nop 0
    v_mfma_f32_16x16x32_bf16 v[20:23], v[36:39], v[68:71], v[20:23]
    global_load_dwordx4 v[68:71], v[60:61], off nt
    v_lshl_add_u64 v[60:61], v[60:61], 0, s[66:67]
    s_waitcnt lgkmcnt(0)
    ds_read_b128 v[40:43], v11 offset:16928
    v_and_b32 v32, v44, v16
    v_and_b32 v33, v44, v17
    v_and_b32 v34, v44, v18
    v_and_b32 v35, v44, v19
    s_waitcnt vmcnt(9)
    s_nop 0
    v_mfma_f32_16x16x32_bf16 v[20:23], v[32:35], v[72:75], v[20:23]
    global_load_dwordx4 v[72:75], v[60:61], off nt
    v_lshl_add_u64 v[60:61], v[60:61], 0, s[66:67]
    v_and_b32 v36, v45, v16
    v_and_b32 v37, v45, v17
    v_and_b32 v38, v45, v18
    v_and_b32 v39, v45, v19
    s_waitcnt vmcnt(9)
    s_nop 0
    v_mfma_f32_16x16x32_bf16 v[20:23], v[36:39], v[76:79], v[20:23]
    global_load_dwordx4 v[76:79], v[60:61], off nt
    v_lshl_add_u64 v[60:61], v[60:61], 0, s[66:67]
    v_and_b32 v32, v46, v16
    v_and_b32 v33, v46, v17
    v_and_b32 v34, v46, v18
    v_and_b32 v35, v46, v19
    s_waitcnt vmcnt(9)
    s_nop 0
    v_mfma_f32_16x16x32_bf16 v[20:23], v[32:35], v[80:83], v[20:23]
    buffer_load_dwordx4 v[80:83], v62, s[36:39], s69 offen offset:0 nt
    v_and_b32 v36, v47, v16
    v_and_b32 v37, v47, v17
    v_and_b32 v38, v47, v18
    v_and_b32 v39, v47, v19
    s_waitcnt vmcnt(9)
    s_nop 0
    v_mfma_f32_16x16x32_bf16 v[20:23], v[36:39], v[84:87], v[20:23]
    buffer_load_dwordx4 v[84:87], v62, s[36:39], s69 offen offset:256 nt
    s_waitcnt lgkmcnt(0)
    ds_read_b128 v[44:47], v11 offset:16944
    v_and_b32 v32, v40, v16
    v_and_b32 v33, v40, v17
    v_and_b32 v34, v40, v18
    v_and_b32 v35, v40, v19
    s_waitcnt vmcnt(9)
    s_nop 0
    v_mfma_f32_16x16x32_bf16 v[20:23], v[32:35], v[88:91], v[20:23]
    buffer_load_dwordx4 v[88:91], v62, s[36:39], s69 offen offset:512 nt
    v_and_b32 v36, v41, v16
    v_and_b32 v37, v41, v17
    v_and_b32 v38, v41, v18
    v_and_b32 v39, v41, v19
    s_waitcnt vmcnt(9)
    s_nop 0
    v_mfma_f32_16x16x32_bf16 v[20:23], v[36:39], v[92:95], v[20:23]
    buffer_load_dwordx4 v[92:95], v62, s[36:39], s69 offen offset:768 nt
    v_and_b32 v32, v42, v16
    v_and_b32 v33, v42, v17
    v_and_b32 v34, v42, v18
    v_and_b32 v35, v42, v19
    s_waitcnt vmcnt(9)
    s_nop 0
    v_mfma_f32_16x16x32_bf16 v[20:23], v[32:35], v[96:99], v[20:23]
    buffer_load_dwordx4 v[96:99], v63, s[36:39], s69 offen offset:1024 nt
    s_addk_i32 s69, 4608
    v_and_b32 v36, v43, v16
    v_and_b32 v37, v43, v17
    v_and_b32 v38, v43, v18
    v_and_b32 v39, v43, v19
    s_waitcnt vmcnt(9)
    s_nop 0
    v_mfma_f32_16x16x32_bf16 v[20:23], v[36:39], v[100:103], v[20:23]
    buffer_load_dwordx4 v[100:103], v62, s[36:39], s69 offen offset:0 nt
    s_waitcnt lgkmcnt(0)
    v_and_b32 v32, v44, v16
    v_and_b32 v33, v44, v17
    v_and_b32 v34, v44, v18
    v_and_b32 v35, v44, v19
    s_waitcnt vmcnt(9)
    s_nop 0
    v_mfma_f32_16x16x32_bf16 v[20:23], v[32:35], v[64:67], v[20:23]
    buffer_load_dwordx4 v[64:67], v62, s[36:39], s69 offen offset:256 nt
    v_and_b32 v36, v45, v16
    v_and_b32 v37, v45, v17
    v_and_b32 v38, v45, v18
    v_and_b32 v39, v45, v19
    s_waitcnt vmcnt(9)
    s_nop 0
    v_mfma_f32_16x16x32_bf16 v[20:23], v[36:39], v[68:71], v[20:23]
    buffer_load_dwordx4 v[68:71], v62, s[36:39], s69 offen offset:512 nt
    v_and_b32 v32, v46, v16
    v_and_b32 v33, v46, v17
    v_and_b32 v34, v46, v18
    v_and_b32 v35, v46, v19
    s_waitcnt vmcnt(9)
    s_nop 0
    v_mfma_f32_16x16x32_bf16 v[20:23], v[32:35], v[72:75], v[20:23]
    buffer_load_dwordx4 v[72:75], v62, s[36:39], s69 offen offset:768 nt
    v_and_b32 v36, v47, v16
    v_and_b32 v37, v47, v17
    v_and_b32 v38, v47, v18
    v_and_b32 v39, v47, v19
    s_waitcnt vmcnt(9)
    s_nop 0
    v_mfma_f32_16x16x32_bf16 v[20:23], v[36:39], v[76:79], v[20:23]
    buffer_load_dwordx4 v[76:79], v63, s[36:39], s69 offen offset:1024 nt
    s_addk_i32 s69, 4608
    s_nop 5
    v_cvt_pk_bf16_f32 v20, v20, v20
    v_and_b32 v20, 0xffff0000, v20
    v_cvt_pk_bf16_f32 v21, v21, v21
    v_and_b32 v21, 0xffff0000, v21
    v_cvt_pk_bf16_f32 v22, v22, v22
    v_and_b32 v22, 0xffff0000, v22
    v_cvt_pk_bf16_f32 v23, v23, v23
    v_and_b32 v23, 0xffff0000, v23
    v_mov_b32_dpp v24, v20 row_ror:8 row_mask:0xf bank_mask:0xf
    v_mov_b32_dpp v25, v21 row_ror:8 row_mask:0xf bank_mask:0xf
    v_mov_b32_dpp v26, v22 row_ror:8 row_mask:0xf bank_mask:0xf
    v_mov_b32_dpp v27, v23 row_ror:8 row_mask:0xf bank_mask:0xf
    v_mul_f32 v4, 0xbfb8aa3b, v20
    v_exp_f32 v4, v4
    s_nop 0
    v_add_f32 v4, 1.0, v4
    v_rcp_f32 v5, v4
    s_nop 0
    v_mul_f32 v20, v20, v5
    v_cvt_pk_bf16_f32 v20, v20, v20
    v_and_b32 v20, 0xffff0000, v20
    v_mul_f32 v20, v20, v24
    v_cvt_pk_bf16_f32 v20, v20, v20
    v_mul_f32 v4, 0xbfb8aa3b, v21
    v_exp_f32 v4, v4
    s_nop 0
    v_add_f32 v4, 1.0, v4
    v_rcp_f32 v5, v4
    s_nop 0
    v_mul_f32 v21, v21, v5
    v_cvt_pk_bf16_f32 v21, v21, v21
    v_and_b32 v21, 0xffff0000, v21
    v_mul_f32 v21, v21, v25
    v_cvt_pk_bf16_f32 v21, v21, v21
    v_mul_f32 v4, 0xbfb8aa3b, v22
    v_exp_f32 v4, v4
    s_nop 0
    v_add_f32 v4, 1.0, v4
    v_rcp_f32 v5, v4
    s_nop 0
    v_mul_f32 v22, v22, v5
    v_cvt_pk_bf16_f32 v22, v22, v22
    v_and_b32 v22, 0xffff0000, v22
    v_mul_f32 v22, v22, v26
    v_cvt_pk_bf16_f32 v22, v22, v22
    v_mul_f32 v4, 0xbfb8aa3b, v23
    v_exp_f32 v4, v4
    s_nop 0
    v_add_f32 v4, 1.0, v4
    v_rcp_f32 v5, v4
    s_nop 0
    v_mul_f32 v23, v23, v5
    v_cvt_pk_bf16_f32 v23, v23, v23
    v_and_b32 v23, 0xffff0000, v23
    v_mul_f32 v23, v23, v27
    v_cvt_pk_bf16_f32 v23, v23, v23
    v_lshrrev_b32 v4, 5, v0
    v_lshlrev_b32 v4, 8, v4
    v_and_b32 v5, 7, v0
    v_lshl_add_u32 v4, v5, 3, v4
    v_and_b32 v5, 1, v2
    v_lshl_add_u32 v4, v5, 2, v4
    v_add_u32 v4, s3, v4
    s_mov_b32 exec_lo, 0x00ff00ff
    s_mov_b32 exec_hi, 0x00ff00ff
    ds_write_b32 v4, v20 offset:20992
    ds_write_b32 v4, v21 offset:21056
    ds_write_b32 v4, v22 offset:21120
    ds_write_b32 v4, v23 offset:21184
    s_mov_b64 exec, -1
    s_waitcnt lgkmcnt(0)
    ds_read_b128 v[44:47], v10 offset:20992
    ds_read_b128 v[48:51], v10 offset:21008
    ds_read_b128 v[52:55], v10 offset:21024
    ds_read_b128 v[56:59], v10 offset:21040
    s_waitcnt lgkmcnt(0)
    v_and_b32 v32, v44, v16
    v_and_b32 v33, v44, v17
    v_and_b32 v34, v44, v18
    v_and_b32 v35, v44, v19
    s_waitcnt vmcnt(9)
    s_nop 0
    v_mfma_f32_16x16x32_bf16 v[20:23], v[32:35], v[80:83], 0
    buffer_load_dwordx4 v[80:83], v62, s[36:39], s69 offen offset:0 nt
    s_waitcnt vmcnt(9)
    v_mfma_f32_16x16x32_bf16 v[24:27], v[32:35], v[84:87], 0
    buffer_load_dwordx4 v[84:87], v62, s[36:39], s69 offen offset:256 nt
    s_waitcnt vmcnt(9)
    v_mfma_f32_16x16x32_bf16 v[28:31], v[32:35], v[88:91], 0
    buffer_load_dwordx4 v[88:91], v62, s[36:39], s69 offen offset:512 nt
    s_waitcnt vmcnt(9)
    v_mfma_f32_16x16x32_bf16 v[36:39], v[32:35], v[92:95], 0
    buffer_load_dwordx4 v[92:95], v62, s[36:39], s69 offen offset:768 nt
    s_waitcnt vmcnt(9)
    v_mfma_f32_16x16x32_bf16 v[40:43], v[32:35], v[96:99], 0
    buffer_load_dwordx4 v[96:99], v63, s[36:39], s69 offen offset:1024 nt
    s_addk_i32 s69, 4608
    v_and_b32 v32, v45, v16
    v_and_b32 v33, v45, v17
    v_and_b32 v34, v45, v18
    v_and_b32 v35, v45, v19
    s_waitcnt vmcnt(9)
    s_nop 0
    v_mfma_f32_16x16x32_bf16 v[20:23], v[32:35], v[100:103], v[20:23]
    buffer_load_dwordx4 v[100:103], v62, s[36:39], s69 offen offset:0 nt
    s_waitcnt vmcnt(9)
    v_mfma_f32_16x16x32_bf16 v[24:27], v[32:35], v[64:67], v[24:27]
    buffer_load_dwordx4 v[64:67], v62, s[36:39], s69 offen offset:256 nt
    s_waitcnt vmcnt(9)
    v_mfma_f32_16x16x32_bf16 v[28:31], v[32:35], v[68:71], v[28:31]
    buffer_load_dwordx4 v[68:71], v62, s[36:39], s69 offen offset:512 nt
    s_waitcnt vmcnt(9)
    v_mfma_f32_16x16x32_bf16 v[36:39], v[32:35], v[72:75], v[36:39]
    buffer_load_dwordx4 v[72:75], v62, s[36:39], s69 offen offset:768 nt
    s_waitcnt vmcnt(9)
    v_mfma_f32_16x16x32_bf16 v[40:43], v[32:35], v[76:79], v[40:43]
    buffer_load_dwordx4 v[76:79], v63, s[36:39], s69 offen offset:1024 nt
    s_addk_i32 s69, 4608
    v_and_b32 v32, v46, v16
    v_and_b32 v33, v46, v17
    v_and_b32 v34, v46, v18
    v_and_b32 v35, v46, v19
    s_waitcnt vmcnt(9)
    s_nop 0
    v_mfma_f32_16x16x32_bf16 v[20:23], v[32:35], v[80:83], v[20:23]
    buffer_load_dwordx4 v[80:83], v62, s[36:39], s69 offen offset:0 nt
    s_waitcnt vmcnt(9)
    v_mfma_f32_16x16x32_bf16 v[24:27], v[32:35], v[84:87], v[24:27]
    buffer_load_dwordx4 v[84:87], v62, s[36:39], s69 offen offset:256 nt
    s_waitcnt vmcnt(9)
    v_mfma_f32_16x16x32_bf16 v[28:31], v[32:35], v[88:91], v[28:31]
    buffer_load_dwordx4 v[88:91], v62, s[36:39], s69 offen offset:512 nt
    s_waitcnt vmcnt(9)
    v_mfma_f32_16x16x32_bf16 v[36:39], v[32:35], v[92:95], v[36:39]
    buffer_load_dwordx4 v[92:95], v62, s[36:39], s69 offen offset:768 nt
    s_waitcnt vmcnt(9)
    v_mfma_f32_16x16x32_bf16 v[40:43], v[32:35], v[96:99], v[40:43]
    buffer_load_dwordx4 v[96:99], v63, s[36:39], s69 offen offset:1024 nt
    s_addk_i32 s69, 4608
    v_and_b32 v32, v47, v16
    v_and_b32 v33, v47, v17
    v_and_b32 v34, v47, v18
    v_and_b32 v35, v47, v19
    s_waitcnt vmcnt(9)
    s_nop 0
    v_mfma_f32_16x16x32_bf16 v[20:23], v[32:35], v[100:103], v[20:23]
    buffer_load_dwordx4 v[100:103], v62, s[36:39], s69 offen offset:0 nt
    s_waitcnt vmcnt(9)
    v_mfma_f32_16x16x32_bf16 v[24:27], v[32:35], v[64:67], v[24:27]
    buffer_load_dwordx4 v[64:67], v62, s[36:39], s69 offen offset:256 nt
    s_waitcnt vmcnt(9)
    v_mfma_f32_16x16x32_bf16 v[28:31], v[32:35], v[68:71], v[28:31]
    buffer_load_dwordx4 v[68:71], v62, s[36:39], s69 offen offset:512 nt
    s_waitcnt vmcnt(9)
    v_mfma_f32_16x16x32_bf16 v[36:39], v[32:35], v[72:75], v[36:39]
    buffer_load_dwordx4 v[72:75], v62, s[36:39], s69 offen offset:768 nt
    s_waitcnt vmcnt(9)
    v_mfma_f32_16x16x32_bf16 v[40:43], v[32:35], v[76:79], v[40:43]
    buffer_load_dwordx4 v[76:79], v63, s[36:39], s69 offen offset:1024 nt
    s_addk_i32 s69, 4608
    v_and_b32 v32, v48, v16
    v_and_b32 v33, v48, v17
    v_and_b32 v34, v48, v18
    v_and_b32 v35, v48, v19
    s_waitcnt vmcnt(9)
    s_nop 0
    v_mfma_f32_16x16x32_bf16 v[20:23], v[32:35], v[80:83], v[20:23]
    buffer_load_dwordx4 v[80:83], v62, s[36:39], s69 offen offset:0 nt
    s_waitcnt vmcnt(9)
    v_mfma_f32_16x16x32_bf16 v[24:27], v[32:35], v[84:87], v[24:27]
    buffer_load_dwordx4 v[84:87], v62, s[36:39], s69 offen offset:256 nt
    s_waitcnt vmcnt(9)
    v_mfma_f32_16x16x32_bf16 v[28:31], v[32:35], v[88:91], v[28:31]
    buffer_load_dwordx4 v[88:91], v62, s[36:39], s69 offen offset:512 nt
    s_waitcnt vmcnt(9)
    v_mfma_f32_16x16x32_bf16 v[36:39], v[32:35], v[92:95], v[36:39]
    buffer_load_dwordx4 v[92:95], v62, s[36:39], s69 offen offset:768 nt
    s_waitcnt vmcnt(9)
    v_mfma_f32_16x16x32_bf16 v[40:43], v[32:35], v[96:99], v[40:43]
    buffer_load_dwordx4 v[96:99], v63, s[36:39], s69 offen offset:1024 nt
    s_addk_i32 s69, 4608
    v_and_b32 v32, v49, v16
    v_and_b32 v33, v49, v17
    v_and_b32 v34, v49, v18
    v_and_b32 v35, v49, v19
    s_waitcnt vmcnt(9)
    s_nop 0
    v_mfma_f32_16x16x32_bf16 v[20:23], v[32:35], v[100:103], v[20:23]
    buffer_load_dwordx4 v[100:103], v62, s[36:39], s69 offen offset:0 nt
    s_waitcnt vmcnt(9)
    v_mfma_f32_16x16x32_bf16 v[24:27], v[32:35], v[64:67], v[24:27]
    buffer_load_dwordx4 v[64:67], v62, s[36:39], s69 offen offset:256 nt
    s_waitcnt vmcnt(9)
    v_mfma_f32_16x16x32_bf16 v[28:31], v[32:35], v[68:71], v[28:31]
    buffer_load_dwordx4 v[68:71], v62, s[36:39], s69 offen offset:512 nt
    s_waitcnt vmcnt(9)
    v_mfma_f32_16x16x32_bf16 v[36:39], v[32:35], v[72:75], v[36:39]
    buffer_load_dwordx4 v[72:75], v62, s[36:39], s69 offen offset:768 nt
    s_waitcnt vmcnt(9)
    v_mfma_f32_16x16x32_bf16 v[40:43], v[32:35], v[76:79], v[40:43]
    buffer_load_dwordx4 v[76:79], v63, s[36:39], s69 offen offset:1024 nt
    s_addk_i32 s69, 4608
    v_and_b32 v32, v50, v16
    v_and_b32 v33, v50, v17
    v_and_b32 v34, v50, v18
    v_and_b32 v35, v50, v19
    s_waitcnt vmcnt(9)
    s_nop 0
    v_mfma_f32_16x16x32_bf16 v[20:23], v[32:35], v[80:83], v[20:23]
    buffer_load_dwordx4 v[80:83], v62, s[36:39], s69 offen offset:0 nt
    s_waitcnt vmcnt(9)
    v_mfma_f32_16x16x32_bf16 v[24:27], v[32:35], v[84:87], v[24:27]
    buffer_load_dwordx4 v[84:87], v62, s[36:39], s69 offen offset:256 nt
    s_waitcnt vmcnt(9)
    v_mfma_f32_16x16x32_bf16 v[28:31], v[32:35], v[88:91], v[28:31]
    buffer_load_dwordx4 v[88:91], v62, s[36:39], s69 offen offset:512 nt
    s_waitcnt vmcnt(9)
    v_mfma_f32_16x16x32_bf16 v[36:39], v[32:35], v[92:95], v[36:39]
    buffer_load_dwordx4 v[92:95], v62, s[36:39], s69 offen offset:768 nt
    s_waitcnt vmcnt(9)
    v_mfma_f32_16x16x32_bf16 v[40:43], v[32:35], v[96:99], v[40:43]
    buffer_load_dwordx4 v[96:99], v63, s[36:39], s69 offen offset:1024 nt
    s_addk_i32 s69, 4608
    v_and_b32 v32, v51, v16
    v_and_b32 v33, v51, v17
    v_and_b32 v34, v51, v18
    v_and_b32 v35, v51, v19
    s_waitcnt vmcnt(9)
    s_nop 0
    v_mfma_f32_16x16x32_bf16 v[20:23], v[32:35], v[100:103], v[20:23]
    buffer_load_dwordx4 v[100:103], v62, s[36:39], s69 offen offset:0 nt
    s_waitcnt vmcnt(9)
    v_mfma_f32_16x16x32_bf16 v[24:27], v[32:35], v[64:67], v[24:27]
    buffer_load_dwordx4 v[64:67], v62, s[36:39], s69 offen offset:256 nt
    s_waitcnt vmcnt(9)
    v_mfma_f32_16x16x32_bf16 v[28:31], v[32:35], v[68:71], v[28:31]
    buffer_load_dwordx4 v[68:71], v62, s[36:39], s69 offen offset:512 nt
    s_waitcnt vmcnt(9)
    v_mfma_f32_16x16x32_bf16 v[36:39], v[32:35], v[72:75], v[36:39]
    buffer_load_dwordx4 v[72:75], v62, s[36:39], s69 offen offset:768 nt
    s_waitcnt vmcnt(9)
    v_mfma_f32_16x16x32_bf16 v[40:43], v[32:35], v[76:79], v[40:43]
    buffer_load_dwordx4 v[76:79], v63, s[36:39], s69 offen offset:1024 nt
    s_addk_i32 s69, 4608
    v_and_b32 v32, v52, v16
    v_and_b32 v33, v52, v17
    v_and_b32 v34, v52, v18
    v_and_b32 v35, v52, v19
    s_waitcnt vmcnt(9)
    s_nop 0
    v_mfma_f32_16x16x32_bf16 v[20:23], v[32:35], v[80:83], v[20:23]
    buffer_load_dwordx4 v[80:83], v62, s[36:39], s69 offen offset:0 nt
    s_waitcnt vmcnt(9)
    v_mfma_f32_16x16x32_bf16 v[24:27], v[32:35], v[84:87], v[24:27]
    buffer_load_dwordx4 v[84:87], v62, s[36:39], s69 offen offset:256 nt
    s_waitcnt vmcnt(9)
    v_mfma_f32_16x16x32_bf16 v[28:31], v[32:35], v[88:91], v[28:31]
    buffer_load_dwordx4 v[88:91], v62, s[36:39], s69 offen offset:512 nt
    s_waitcnt vmcnt(9)
    v_mfma_f32_16x16x32_bf16 v[36:39], v[32:35], v[92:95], v[36:39]
    buffer_load_dwordx4 v[92:95], v62, s[36:39], s69 offen offset:768 nt
    s_waitcnt vmcnt(9)
    v_mfma_f32_16x16x32_bf16 v[40:43], v[32:35], v[96:99], v[40:43]
    buffer_load_dwordx4 v[96:99], v63, s[36:39], s69 offen offset:1024 nt
    s_addk_i32 s69, 4608
    v_and_b32 v32, v53, v16
    v_and_b32 v33, v53, v17
    v_and_b32 v34, v53, v18
    v_and_b32 v35, v53, v19
    s_waitcnt vmcnt(9)
    s_nop 0
    v_mfma_f32_16x16x32_bf16 v[20:23], v[32:35], v[100:103], v[20:23]
    buffer_load_dwordx4 v[100:103], v62, s[36:39], s69 offen offset:0 nt
    s_waitcnt vmcnt(9)
    v_mfma_f32_16x16x32_bf16 v[24:27], v[32:35], v[64:67], v[24:27]
    buffer_load_dwordx4 v[64:67], v62, s[36:39], s69 offen offset:256 nt
    s_waitcnt vmcnt(9)
    v_mfma_f32_16x16x32_bf16 v[28:31], v[32:35], v[68:71], v[28:31]
    buffer_load_dwordx4 v[68:71], v62, s[36:39], s69 offen offset:512 nt
    s_waitcnt vmcnt(9)
    v_mfma_f32_16x16x32_bf16 v[36:39], v[32:35], v[72:75], v[36:39]
    buffer_load_dwordx4 v[72:75], v62, s[36:39], s69 offen offset:768 nt
    s_waitcnt vmcnt(9)
    v_mfma_f32_16x16x32_bf16 v[40:43], v[32:35], v[76:79], v[40:43]
    buffer_load_dwordx4 v[76:79], v63, s[36:39], s69 offen offset:1024 nt
    s_addk_i32 s69, 4608
    v_and_b32 v32, v54, v16
    v_and_b32 v33, v54, v17
    v_and_b32 v34, v54, v18
    v_and_b32 v35, v54, v19
    s_waitcnt vmcnt(9)
    s_nop 0
    v_mfma_f32_16x16x32_bf16 v[20:23], v[32:35], v[80:83], v[20:23]
    buffer_load_dwordx4 v[80:83], v62, s[36:39], s69 offen offset:0 nt
    s_waitcnt vmcnt(9)
    v_mfma_f32_16x16x32_bf16 v[24:27], v[32:35], v[84:87], v[24:27]
    buffer_load_dwordx4 v[84:87], v62, s[36:39], s69 offen offset:256 nt
    s_waitcnt vmcnt(9)
    v_mfma_f32_16x16x32_bf16 v[28:31], v[32:35], v[88:91], v[28:31]
    buffer_load_dwordx4 v[88:91], v62, s[36:39], s69 offen offset:512 nt
    s_waitcnt vmcnt(9)
    v_mfma_f32_16x16x32_bf16 v[36:39], v[32:35], v[92:95], v[36:39]
    buffer_load_dwordx4 v[92:95], v62, s[36:39], s69 offen offset:768 nt
    s_waitcnt vmcnt(9)
    v_mfma_f32_16x16x32_bf16 v[40:43], v[32:35], v[96:99], v[40:43]
    buffer_load_dwordx4 v[96:99], v63, s[36:39], s69 offen offset:1024 nt
    s_addk_i32 s69, 4608
    v_and_b32 v32, v55, v16
    v_and_b32 v33, v55, v17
    v_and_b32 v34, v55, v18
    v_and_b32 v35, v55, v19
    s_waitcnt vmcnt(9)
    s_nop 0
    v_mfma_f32_16x16x32_bf16 v[20:23], v[32:35], v[100:103], v[20:23]
    buffer_load_dwordx4 v[100:103], v62, s[36:39], s69 offen offset:0 nt
    s_waitcnt vmcnt(9)
    v_mfma_f32_16x16x32_bf16 v[24:27], v[32:35], v[64:67], v[24:27]
    buffer_load_dwordx4 v[64:67], v62, s[36:39], s69 offen offset:256 nt
    s_waitcnt vmcnt(9)
    v_mfma_f32_16x16x32_bf16 v[28:31], v[32:35], v[68:71], v[28:31]
    buffer_load_dwordx4 v[68:71], v62, s[36:39], s69 offen offset:512 nt
    s_waitcnt vmcnt(9)
    v_mfma_f32_16x16x32_bf16 v[36:39], v[32:35], v[72:75], v[36:39]
    buffer_load_dwordx4 v[72:75], v62, s[36:39], s69 offen offset:768 nt
    s_waitcnt vmcnt(9)
    v_mfma_f32_16x16x32_bf16 v[40:43], v[32:35], v[76:79], v[40:43]
    buffer_load_dwordx4 v[76:79], v63, s[36:39], s69 offen offset:1024 nt
    s_addk_i32 s69, 4608
    v_and_b32 v32, v56, v16
    v_and_b32 v33, v56, v17
    v_and_b32 v34, v56, v18
    v_and_b32 v35, v56, v19
    s_waitcnt vmcnt(9)
    s_nop 0
    v_mfma_f32_16x16x32_bf16 v[20:23], v[32:35], v[80:83], v[20:23]
    buffer_load_dwordx4 v[80:83], v62, s[36:39], s69 offen offset:0 nt
    s_waitcnt vmcnt(9)
    v_mfma_f32_16x16x32_bf16 v[24:27], v[32:35], v[84:87], v[24:27]
    buffer_load_dwordx4 v[84:87], v62, s[36:39], s69 offen offset:256 nt
    s_waitcnt vmcnt(9)
    v_mfma_f32_16x16x32_bf16 v[28:31], v[32:35], v[88:91], v[28:31]
    buffer_load_dwordx4 v[88:91], v62, s[36:39], s69 offen offset:512 nt
    s_waitcnt vmcnt(9)
    v_mfma_f32_16x16x32_bf16 v[36:39], v[32:35], v[92:95], v[36:39]
    buffer_load_dwordx4 v[92:95], v62, s[36:39], s69 offen offset:768 nt
    s_waitcnt vmcnt(9)
    v_mfma_f32_16x16x32_bf16 v[40:43], v[32:35], v[96:99], v[40:43]
    buffer_load_dwordx4 v[96:99], v63, s[36:39], s69 offen offset:1024 nt
    s_addk_i32 s69, 4608
    v_and_b32 v32, v57, v16
    v_and_b32 v33, v57, v17
    v_and_b32 v34, v57, v18
    v_and_b32 v35, v57, v19
    s_waitcnt vmcnt(9)
    s_nop 0
    v_mfma_f32_16x16x32_bf16 v[20:23], v[32:35], v[100:103], v[20:23]
    buffer_load_dwordx4 v[100:103], v62, s[36:39], s69 offen offset:0 nt
    s_waitcnt vmcnt(9)
    v_mfma_f32_16x16x32_bf16 v[24:27], v[32:35], v[64:67], v[24:27]
    buffer_load_dwordx4 v[64:67], v62, s[36:39], s69 offen offset:256 nt
    s_waitcnt vmcnt(9)
    v_mfma_f32_16x16x32_bf16 v[28:31], v[32:35], v[68:71], v[28:31]
    buffer_load_dwordx4 v[68:71], v62, s[36:39], s69 offen offset:512 nt
    s_waitcnt vmcnt(9)
    v_mfma_f32_16x16x32_bf16 v[36:39], v[32:35], v[72:75], v[36:39]
    buffer_load_dwordx4 v[72:75], v62, s[36:39], s69 offen offset:768 nt
    s_waitcnt vmcnt(9)
    v_mfma_f32_16x16x32_bf16 v[40:43], v[32:35], v[76:79], v[40:43]
    buffer_load_dwordx4 v[76:79], v63, s[36:39], s69 offen offset:1024 nt
    s_addk_i32 s69, 4608
    v_and_b32 v32, v58, v16
    v_and_b32 v33, v58, v17
    v_and_b32 v34, v58, v18
    v_and_b32 v35, v58, v19
    s_waitcnt vmcnt(9)
    s_nop 0
    v_mfma_f32_16x16x32_bf16 v[20:23], v[32:35], v[80:83], v[20:23]
    s_waitcnt vmcnt(8)
    v_mfma_f32_16x16x32_bf16 v[24:27], v[32:35], v[84:87], v[24:27]
    s_waitcnt vmcnt(7)
    v_mfma_f32_16x16x32_bf16 v[28:31], v[32:35], v[88:91], v[28:31]
    s_waitcnt vmcnt(6)
    v_mfma_f32_16x16x32_bf16 v[36:39], v[32:35], v[92:95], v[36:39]
    s_waitcnt vmcnt(5)
    v_mfma_f32_16x16x32_bf16 v[40:43], v[32:35], v[96:99], v[40:43]
    v_and_b32 v32, v59, v16
    v_and_b32 v33, v59, v17
    v_and_b32 v34, v59, v18
    v_and_b32 v35, v59, v19
    s_waitcnt vmcnt(4)
    s_nop 0
    v_mfma_f32_16x16x32_bf16 v[20:23], v[32:35], v[100:103], v[20:23]
    s_waitcnt vmcnt(3)
    v_mfma_f32_16x16x32_bf16 v[24:27], v[32:35], v[64:67], v[24:27]
    s_waitcnt vmcnt(2)
    v_mfma_f32_16x16x32_bf16 v[28:31], v[32:35], v[68:71], v[28:31]
    s_waitcnt vmcnt(1)
    v_mfma_f32_16x16x32_bf16 v[36:39], v[32:35], v[72:75], v[36:39]
    s_waitcnt vmcnt(0)
    v_mfma_f32_16x16x32_bf16 v[40:43], v[32:35], v[76:79], v[40:43]
L_ffn_pub:
    s_mul_i32 s3, s28, 5120
    v_lshl_add_u32 v4, v0, 4, s3
    ds_write_b128 v4, v[20:23] offset:22528
    ds_write_b128 v4, v[24:27] offset:23552
    ds_write_b128 v4, v[28:31] offset:24576
    s_nop 0
    ds_write_b128 v4, v[36:39] offset:25600
    s_nop 0
    ds_write_b128 v4, v[40:43] offset:26624
    s_waitcnt lgkmcnt(0)
L_lo_end:
    s_barrier
L_end:
    s_endpgm
.section .rodata,"a"
.p2align 6
.amdhsa_kernel recurrent_scan__mha_block_cached__swiglu_ffn__decode_kernel
  .amdhsa_next_free_vgpr 256
  .amdhsa_next_free_sgpr 100
  .amdhsa_accum_offset 256
  .amdhsa_group_segment_fixed_size 0
  .amdhsa_kernarg_size 96
  .amdhsa_user_sgpr_count 2
  .amdhsa_user_sgpr_kernarg_segment_ptr 1
  .amdhsa_system_sgpr_workgroup_id_x 1
  .amdhsa_float_denorm_mode_32 3
.end_amdhsa_kernel
```
